```python
import torch

def _softmax(x, axis=-1):
    return torch.softmax(x, dim=axis)
def _gelu(x):
    return torch.nn.functional.gelu(x, approximate="tanh")
def _silu(x):
    return torch.nn.functional.silu(x)
def _sigmoid(x):
    return torch.sigmoid(x)
def _layernorm(x, axis=-1, eps=1e-5):
    m = x.mean(dim=axis, keepdim=True)
    v = x.var(dim=axis, keepdim=True, unbiased=False)
    return (x - m) / torch.sqrt(v + eps)
def _scatter_add(tgt, idx, src, axis=0):
    return tgt.clone().index_add_(axis, idx, src)
def _segment_sum(src, seg, n):
    out = torch.zeros((n,) + src.shape[1:], dtype=src.dtype)
    return out.index_add_(0, seg, src)
def _pad(x, pw):
    flat = tuple(v for pair in reversed(pw) for v in pair)
    return torch.nn.functional.pad(x, flat)

kernel_name = 'standalone__gqa_block_cached__near_ridge'

def setup_inputs():

    _w = (lambda a: (lambda t: t.to(torch.bfloat16) if t.is_floating_point() else t)(torch.as_tensor(a)))
    B, Sq, D = 8, 240, 640
    Hq, Hkv, Sk, Dh = 32, 32, 1024, 192
    assert Hq % Hkv == 0, (Hq, Hkv)
    return {
        "x": _w((lambda *s: torch.randn(*s, dtype=torch.bfloat16) * 0.8)(B, Sq, D)),
        "k_cache": _w((lambda *s: torch.randn(*s, dtype=torch.bfloat16) * 0.8)(B, Hkv, Sk, Dh)),
        "v_cache": _w((lambda *s: torch.randn(*s, dtype=torch.bfloat16) * 0.05)(B, Hkv, Sk, Dh)),
        "wq": _w((lambda *s: torch.randn(*s, dtype=torch.bfloat16) * 0.8)(D, Hq * Dh) * (D ** -0.5)),
        "wo": _w((lambda *s: torch.randn(*s, dtype=torch.bfloat16) * 0.05)(Hq * Dh, D) * ((Hq * Dh) ** -0.5)),
    }

def reference(x, k_cache, v_cache, wq, wo):
    B, Sq, D = x.shape
    Hq, Dh = 32, 192
    Hkv = k_cache.shape[1]
    rep = Hq // Hkv
    q = (lambda x, *d: x.permute(*d))((x @ wq).reshape(B, Sq, Hq, Dh), 0, 2, 1, 3)
    k = (lambda x, n, axis: torch.repeat_interleave(x, n, dim=axis))(k_cache, rep, axis=1)
    v = (lambda x, n, axis: torch.repeat_interleave(x, n, dim=axis))(v_cache, rep, axis=1)
    scores = torch.einsum("bhqd,bhkd->bhqk", q, k) * (Dh ** -0.5)
    p = _softmax(scores, axis=-1)
    o = torch.einsum("bhqk,bhkd->bhqd", p, v)
    return (lambda x, *d: x.permute(*d))(o, 0, 2, 1, 3).reshape(B, Sq, Hq * Dh) @ wo
```

```asm
; @launch kernel=standalone__gqa_block_cached__near_ridge_kernel grid=(256,1,1) block=(256,1,1) lds=163840
; @launch kernel=reduce_kernel grid=(600,1,1) block=(256,1,1) lds=0
.amdgcn_target "amdgcn-amd-amdhsa--gfx950"
.text
.globl standalone__gqa_block_cached__near_ridge_kernel
.p2align 8
.type standalone__gqa_block_cached__near_ridge_kernel,@function
standalone__gqa_block_cached__near_ridge_kernel:
s_cmp_ge_u32 s2, 256
s_cbranch_scc1 L1_end
s_load_dwordx8 s[40:47], s[0:1], 0
s_load_dwordx8 s[92:99], s[0:1], 32
v_lshrrev_b32 v32, 6, v0
v_lshlrev_b32 v30, 3, v0
v_and_b32 v0, 63, v0
v_readfirstlane_b32 s24, v32
s_and_b32 s50, s2, 7
s_lshr_b32 s51, s2, 3
s_lshl_b32 s50, s50, 2
s_getpc_b64 s[58:59]
L1_pc:
v_lshl_add_u32 v30, s51, 11, v30
v_min_u32 v30, L1_end-L1_pc, v30
global_load_dwordx2 v[56:57], v30, s[58:59]
s_and_b32 s52, s51, 3
s_add_u32 s50, s50, s52
s_lshr_b32 s51, s51, 2
s_mul_i32 s26, s24, 3072
s_lshl_b32 s3, s24, 13
s_add_u32 s3, s3, 96256
s_lshl_b32 s53, s24, 3
v_add_u32 v32, 0, v0
v_mul_u32_u24 v40, 2731, v32
v_lshrrev_b32 v40, 16, v40
v_mul_u32_u24 v34, 24, v40
v_sub_u32 v32, v32, v34
v_add_u32 v40, s53, v40
v_and_b32 v34, 6, v40
v_xor_b32 v32, v32, v34
v_lshlrev_b32 v32, 4, v32
v_and_b32 v35, 12, v40
v_lshlrev_b32 v35, 1, v35
v_and_or_b32 v35, v40, 3, v35
v_lshrrev_b32 v23, 4, v40
v_lshl_add_u32 v35, v23, 2, v35
v_mul_u32_u24 v35, 12288, v35
v_add_u32 v35, v35, v32
v_subrev_u32 v23, 0, v35
v_add_u32 v32, 64, v0
v_mul_u32_u24 v41, 2731, v32
v_lshrrev_b32 v41, 16, v41
v_mul_u32_u24 v34, 24, v41
v_sub_u32 v32, v32, v34
v_add_u32 v41, s53, v41
v_and_b32 v34, 6, v41
v_xor_b32 v32, v32, v34
v_lshlrev_b32 v32, 4, v32
v_and_b32 v35, 12, v41
v_lshlrev_b32 v35, 1, v35
v_and_or_b32 v35, v41, 3, v35
v_lshrrev_b32 v24, 4, v41
v_lshl_add_u32 v35, v24, 2, v35
v_mul_u32_u24 v35, 12288, v35
v_add_u32 v35, v35, v32
v_subrev_u32 v24, 1024, v35
v_add_u32 v32, 128, v0
v_mul_u32_u24 v42, 2731, v32
v_lshrrev_b32 v42, 16, v42
v_mul_u32_u24 v34, 24, v42
v_sub_u32 v32, v32, v34
v_add_u32 v42, s53, v42
v_and_b32 v34, 6, v42
v_xor_b32 v32, v32, v34
v_lshlrev_b32 v32, 4, v32
v_and_b32 v35, 12, v42
v_lshlrev_b32 v35, 1, v35
v_and_or_b32 v35, v42, 3, v35
v_lshrrev_b32 v25, 4, v42
v_lshl_add_u32 v35, v25, 2, v35
v_mul_u32_u24 v35, 12288, v35
v_add_u32 v35, v35, v32
v_subrev_u32 v25, 2048, v35
v_lshrrev_b32 v32, 3, v0
s_lshl_b32 s53, s24, 6
v_add_u32 v32, s53, v32
v_mul_u32_u24 v32, 1280, v32
v_lshrrev_b32 v33, 4, v0
v_and_b32 v34, 7, v0
v_xor_b32 v33, v33, v34
v_lshl_add_u32 v26, v33, 4, v32
v_xor_b32 v33, 4, v33
v_lshl_add_u32 v27, v33, 4, v32
v_add_u32 v27, 9216, v27
s_add_u32 s55, s52, s51
s_and_b32 s53, s55, 1
s_lshl_b32 s30, s53, 7
s_mul_i32 s29, s53, 786432
s_lshl_b32 s54, s53, 8
s_sub_u32 s56, 128, s54
s_add_u32 s57, s54, 128
s_lshl_b32 s54, s29, 1
s_sub_u32 s100, 393216, s54
s_add_u32 s101, s54, 393216
s_and_b32 s53, s55, 2
s_mul_i32 s54, s53, 20480
s_sub_u32 s32, s30, s54
s_add_u32 s30, s30, s54
s_add_u32 s32, s32, 40960
s_add_u32 s31, s30, 20480
s_add_u32 s33, s32, 20480
s_lshl_b32 s54, s53, 11
s_add_u32 s39, s3, s54
s_sub_u32 s88, s3, s54
s_mul_i32 s54, s53, 6144
s_add_u32 s90, s26, s54
s_sub_u32 s91, s26, s54
s_mul_i32 s54, s53, 196608
s_add_u32 s29, s29, s54
s_lshl_b32 s54, s54, 1
s_sub_u32 s38, 393216, s54
s_add_u32 s100, s100, s54
s_add_u32 s101, s101, s54
s_mul_i32 s53, s50, 384
s_mul_i32 s54, s51, 307200
s_sub_u32 s18, 7864320, s53
s_mov_b32 s19, 0x20000
s_mov_b32 s6, 307200
s_mov_b32 s7, 0x20000
s_waitcnt lgkmcnt(0)
s_add_u32 s16, s46, s53
s_addc_u32 s17, s47, 0
s_add_u32 s4, s40, s54
s_addc_u32 s5, s41, 0
s_add_u32 m0, s90, 0
s_nop 0
buffer_load_dwordx4 v23, s[16:19], s29 offen offset:0 nt lds
buffer_load_dwordx4 v24, s[16:19], s29 offen offset:1024 nt lds
buffer_load_dwordx4 v25, s[16:19], s29 offen offset:2048 nt lds
s_add_u32 s29, s29, s38
s_add_u32 m0, s39, 2048
s_nop 0
buffer_load_dwordx4 v26, s[4:7], s30 offen offset:0 lds
buffer_load_dwordx4 v27, s[4:7], s30 offen offset:1024 lds
s_add_u32 m0, s39, 4096
s_nop 0
buffer_load_dwordx4 v26, s[4:7], s31 offen offset:0 lds
buffer_load_dwordx4 v27, s[4:7], s31 offen offset:1024 lds
s_add_u32 s25, s26, 73728
v_and_b32 v34, 6, v40
v_xor_b32 v34, v0, v34
v_lshlrev_b32 v34, 4, v34
v_add_u32 v20, s26, v34
v_bfe_u32 v34, v40, 1, 3
v_xor_b32 v34, v0, v34
v_lshlrev_b32 v34, 4, v34
v_add_u32 v17, s26, v34
v_mul_u32_u24 v34, 384, v40
v_sub_u32 v34, v20, v34
v_cmp_gt_i32 vcc, 320, v34
v_mul_u32_u24 v35, 1280, v40
v_add_u32 v34, v34, v35
v_mov_b32 v35, 2.0
v_cndmask_b32 v34, v35, v34
v_accvgpr_write_b32 a240, v34
v_and_b32 v34, 6, v41
v_xor_b32 v34, v0, v34
v_lshlrev_b32 v34, 4, v34
v_add_u32 v21, s26, v34
v_bfe_u32 v34, v41, 1, 3
v_xor_b32 v34, v0, v34
v_lshlrev_b32 v34, 4, v34
v_add_u32 v18, s26, v34
v_mul_u32_u24 v34, 384, v41
v_sub_u32 v34, v21, v34
v_cmp_gt_i32 vcc, -704, v34
v_mul_u32_u24 v35, 1280, v41
v_add_u32 v34, v34, v35
v_mov_b32 v35, 2.0
v_cndmask_b32 v34, v35, v34
v_accvgpr_write_b32 a241, v34
v_and_b32 v34, 6, v42
v_xor_b32 v34, v0, v34
v_lshlrev_b32 v34, 4, v34
v_add_u32 v22, s26, v34
v_bfe_u32 v34, v42, 1, 3
v_xor_b32 v34, v0, v34
v_lshlrev_b32 v34, 4, v34
v_add_u32 v19, s26, v34
v_mul_u32_u24 v34, 384, v42
v_sub_u32 v34, v22, v34
v_cmp_gt_i32 vcc, -1728, v34
v_mul_u32_u24 v35, 1280, v42
v_add_u32 v34, v34, v35
v_mov_b32 v35, 2.0
v_cndmask_b32 v34, v35, v34
v_accvgpr_write_b32 a242, v34
s_mov_b32 s27, 0
s_mov_b32 s28, 0
s_lshl_b32 s52, s51, 5
s_add_u32 s52, s52, s50
s_mul_i32 s53, s52, 393216
s_add_u32 s8, s42, s53
s_addc_u32 s9, s43, 0
s_mov_b32 s10, 393216
s_mov_b32 s11, 0x20000
s_add_u32 s12, s44, s53
s_addc_u32 s13, s45, 0
s_mov_b32 s14, 393216
s_mov_b32 s15, 0x20000
s_and_b32 s48, s50, 3
s_lshr_b32 s49, s50, 2
s_sub_u32 s53, s52, s48
s_mul_i32 s53, s53, 92160
s_add_u32 s20, s98, s53
s_addc_u32 s21, s99, 0
s_mov_b32 s22, 368640
s_mov_b32 s23, 0x20000
s_mul_i32 s53, s49, 983040
s_mul_i32 s54, s48, 320
s_add_u32 s53, s53, s54
s_add_u32 s64, s92, s53
s_addc_u32 s65, s93, 0
s_sub_u32 s66, 7864320, s53
s_mov_b32 s67, 0x20000
s_add_u32 s53, s48, 0
s_and_b32 s53, s53, 3
s_mul_i32 s80, s53, 245760
s_mul_i32 s84, s53, 92160
s_add_u32 s53, s48, 1
s_and_b32 s53, s53, 3
s_mul_i32 s81, s53, 245760
s_mul_i32 s85, s53, 92160
s_add_u32 s53, s48, 2
s_and_b32 s53, s53, 3
s_mul_i32 s82, s53, 245760
s_mul_i32 s86, s53, 92160
s_add_u32 s53, s48, 3
s_and_b32 s53, s53, 3
s_mul_i32 s83, s53, 245760
s_mul_i32 s87, s53, 92160
s_lshl_b32 s53, s49, 3
s_add_u32 s53, s53, s51
s_lshl_b32 s53, s53, 2
s_add_u32 s53, s53, s48
s_mul_i32 s53, s53, 76800
s_add_u32 s53, s53, 23592960
s_add_u32 s68, s98, s53
s_addc_u32 s69, s99, 0
s_mov_b32 s70, 76800
s_mov_b32 s71, 0x20000
s_lshr_b32 s54, s52, 2
s_lshl_b32 s53, s54, 7
s_add_u32 s53, s53, 43253760
s_add_u32 s72, s98, s53
s_addc_u32 s73, s99, 0
s_mov_b32 s74, 16
s_mov_b32 s75, 0x20000
s_lshl_b32 s53, s54, 2
s_add_u32 s76, s96, s53
s_addc_u32 s77, s97, 0
s_mov_b32 s78, 4
s_mov_b32 s79, 0x20000
s_lshl_b32 s53, s51, 2
s_add_u32 s53, s53, s48
s_lshl_b32 s53, s53, 2
s_add_u32 s53, s53, s24
s_mul_i32 s53, s53, 7680
s_mul_i32 s54, s48, 320
s_sub_u32 s53, s53, s54
s_mov_b32 s89, s53
v_min_u32 v32, 14, v0
v_mul_u32_u24 v59, 128, v32
v_min_u32 v32, 59, v0
v_lshlrev_b32 v32, 7, v32
v_add_u32 v58, s89, v32
v_or_b32 v32, s24, v0
v_lshlrev_b32 v32, 8, v32
v_lshl_add_u32 v30, s48, 2, v32
v_lshl_add_u32 v60, s49, 2, v32
v_and_b32 v32, 15, v0
v_lshrrev_b32 v33, 4, v0
v_lshrrev_b32 v34, 1, v32
v_xor_b32 v34, v33, v34
v_lshlrev_b32 v35, 7, v32
v_lshl_add_u32 v35, v34, 4, v35
v_add_u32 v35, s3, v35
v_add_u32 v28, 2048, v35
v_xor_b32 v29, 64, v28
v_mul_u32_u24 v32, 384, v32
v_add_u32 v32, 73728, v32
v_lshl_add_u32 v1, v34, 4, v32
v_xor_b32 v2, 64, v1
v_add_u32 v3, 36864, v1
v_add_u32 v4, 36864, v2
v_lshrrev_b32 v32, 2, v0
v_and_b32 v33, 3, v0
v_bfe_u32 v34, v0, 3, 2
v_mul_u32_u24 v32, 384, v32
v_lshl_add_u32 v35, v33, 3, v32
v_xor_b32 v36, 0, v34
v_lshl_add_u32 v5, v36, 5, v35
v_add_u32 v9, 36864, v5
v_xor_b32 v36, 1, v34
v_lshl_add_u32 v6, v36, 5, v35
v_add_u32 v10, 36864, v6
v_xor_b32 v36, 2, v34
v_lshl_add_u32 v7, v36, 5, v35
v_add_u32 v11, 36864, v7
v_xor_b32 v36, 3, v34
v_lshl_add_u32 v8, v36, 5, v35
v_add_u32 v12, 36864, v8
v_lshlrev_b32 v34, 1, v34
v_xor_b32 v33, v33, v34
v_lshl_add_u32 v13, v33, 4, v32
v_xor_b32 v33, 4, v33
v_lshl_add_u32 v14, v33, 4, v32
v_add_u32 v15, 36864, v13
v_add_u32 v16, 36864, v14
s_mov_b32 s37, 0x3dd53b95
s_mov_b32 s35, 0xff7fffff
s_mov_b32 s34, 4
s_add_u32 m0, s91, 12288
s_nop 0
buffer_load_dwordx4 v23, s[16:19], s29 offen offset:0 nt lds
buffer_load_dwordx4 v24, s[16:19], s29 offen offset:1024 nt lds
buffer_load_dwordx4 v25, s[16:19], s29 offen offset:2048 nt lds
s_add_u32 s29, s29, s100
s_add_u32 m0, s88, 6144
s_nop 0
buffer_load_dwordx4 v26, s[4:7], s32 offen offset:0 lds
buffer_load_dwordx4 v27, s[4:7], s32 offen offset:1024 lds
s_add_u32 m0, s88, 8192
s_nop 0
buffer_load_dwordx4 v26, s[4:7], s33 offen offset:0 lds
buffer_load_dwordx4 v27, s[4:7], s33 offen offset:1024 lds
s_add_u32 m0, s90, 24576
s_nop 0
buffer_load_dwordx4 v23, s[16:19], s29 offen offset:0 nt lds
buffer_load_dwordx4 v24, s[16:19], s29 offen offset:1024 nt lds
buffer_load_dwordx4 v25, s[16:19], s29 offen offset:2048 nt lds
s_add_u32 s29, s29, s38
s_add_u32 m0, s91, 36864
s_nop 0
buffer_load_dwordx4 v23, s[16:19], s29 offen offset:0 nt lds
buffer_load_dwordx4 v24, s[16:19], s29 offen offset:1024 nt lds
buffer_load_dwordx4 v25, s[16:19], s29 offen offset:2048 nt lds
s_add_u32 s29, s29, s101
s_add_u32 m0, s39, 34816
s_add_u32 s30, s30, s56
buffer_load_dwordx4 v26, s[4:7], s30 offen offset:0 lds
buffer_load_dwordx4 v27, s[4:7], s30 offen offset:1024 lds
s_add_u32 m0, s39, 36864
s_add_u32 s31, s31, s56
buffer_load_dwordx4 v26, s[4:7], s31 offen offset:0 lds
buffer_load_dwordx4 v27, s[4:7], s31 offen offset:1024 lds
s_add_u32 m0, s88, 38912
s_add_u32 s32, s32, s56
buffer_load_dwordx4 v26, s[4:7], s32 offen offset:0 lds
buffer_load_dwordx4 v27, s[4:7], s32 offen offset:1024 lds
s_add_u32 m0, s88, 40960
s_add_u32 s33, s33, s56
buffer_load_dwordx4 v26, s[4:7], s33 offen offset:0 lds
buffer_load_dwordx4 v27, s[4:7], s33 offen offset:1024 lds
s_waitcnt vmcnt(14)
s_barrier
ds_read_b128 a[0:3], v28 offset:0
ds_read_b128 a[4:7], v28 offset:2048
ds_read_b128 a[8:11], v28 offset:4096
ds_read_b128 a[12:15], v28 offset:6144
ds_read_b128 a[16:19], v29 offset:0
ds_read_b128 a[20:23], v29 offset:2048
ds_read_b128 a[24:27], v29 offset:4096
ds_read_b128 a[28:31], v29 offset:6144
ds_read_b64_tr_b16 a[192:193], v13 offset:0
ds_read_b64_tr_b16 a[194:195], v13 offset:6144
ds_read_b64_tr_b16 a[196:197], v13 offset:12288
ds_read_b64_tr_b16 a[198:199], v13 offset:18432
ds_read_b64_tr_b16 a[200:201], v13 offset:8
ds_read_b64_tr_b16 a[202:203], v13 offset:6152
ds_read_b64_tr_b16 a[204:205], v13 offset:12296
ds_read_b64_tr_b16 a[206:207], v13 offset:18440
ds_read_b64_tr_b16 a[208:209], v14 offset:0
ds_read_b64_tr_b16 a[210:211], v14 offset:6144
ds_read_b64_tr_b16 a[212:213], v14 offset:12288
ds_read_b64_tr_b16 a[214:215], v14 offset:18432
ds_read_b64_tr_b16 a[216:217], v14 offset:8
ds_read_b64_tr_b16 a[218:219], v14 offset:6152
ds_read_b64_tr_b16 a[220:221], v14 offset:12296
ds_read_b64_tr_b16 a[222:223], v14 offset:18440
s_waitcnt lgkmcnt(14)
v_mfma_f32_16x16x32_bf16 v[64:67], a[192:195], a[0:3], 0
s_waitcnt lgkmcnt(12)
ds_read_b64_tr_b16 a[224:225], v13 offset:128
v_mfma_f32_16x16x32_bf16 v[64:67], a[196:199], a[16:19], v[64:67]
s_add_u32 m0, s90, 49152
ds_read_b64_tr_b16 a[226:227], v13 offset:6272
v_mfma_f32_16x16x32_bf16 v[72:75], a[192:195], a[4:7], 0
buffer_load_dwordx4 v23, s[16:19], s29 offen offset:0 nt lds
v_mfma_f32_16x16x32_bf16 v[72:75], a[196:199], a[20:23], v[72:75]
ds_read_b64_tr_b16 a[228:229], v13 offset:12416
v_mfma_f32_16x16x32_bf16 v[80:83], a[192:195], a[8:11], 0
buffer_load_dwordx4 v24, s[16:19], s29 offen offset:1024 nt lds
v_mfma_f32_16x16x32_bf16 v[80:83], a[196:199], a[24:27], v[80:83]
ds_read_b64_tr_b16 a[230:231], v13 offset:18560
v_mfma_f32_16x16x32_bf16 v[88:91], a[192:195], a[12:15], 0
buffer_load_dwordx4 v25, s[16:19], s29 offen offset:2048 nt lds
s_add_u32 s29, s29, s38
v_mfma_f32_16x16x32_bf16 v[88:91], a[196:199], a[28:31], v[88:91]
s_waitcnt lgkmcnt(2)
s_add_u32 m0, s39, 2048
s_add_u32 s30, s30, s57
ds_read_b64_tr_b16 a[232:233], v13 offset:136
v_mfma_f32_16x16x32_bf16 v[68:71], a[200:203], a[0:3], 0
buffer_load_dwordx4 v26, s[4:7], s30 offen offset:0 lds
v_mfma_f32_16x16x32_bf16 v[68:71], a[204:207], a[16:19], v[68:71]
ds_read_b64_tr_b16 a[234:235], v13 offset:6280
v_mfma_f32_16x16x32_bf16 v[76:79], a[200:203], a[4:7], 0
buffer_load_dwordx4 v27, s[4:7], s30 offen offset:1024 lds
v_mfma_f32_16x16x32_bf16 v[76:79], a[204:207], a[20:23], v[76:79]
s_add_u32 m0, s39, 4096
s_add_u32 s31, s31, s57
ds_read_b64_tr_b16 a[236:237], v13 offset:12424
v_mfma_f32_16x16x32_bf16 v[84:87], a[200:203], a[8:11], 0
buffer_load_dwordx4 v26, s[4:7], s31 offen offset:0 lds
v_mfma_f32_16x16x32_bf16 v[84:87], a[204:207], a[24:27], v[84:87]
ds_read_b64_tr_b16 a[238:239], v13 offset:18568
v_mfma_f32_16x16x32_bf16 v[92:95], a[200:203], a[12:15], 0
buffer_load_dwordx4 v27, s[4:7], s31 offen offset:1024 lds
v_mfma_f32_16x16x32_bf16 v[92:95], a[204:207], a[28:31], v[92:95]
s_add_u32 m0, s25, 0
ds_read_b64_tr_b16 a[192:193], v14 offset:128
v_mfma_f32_16x16x32_bf16 v[96:99], a[208:211], a[0:3], 0
buffer_load_dwordx4 v17, s[8:11], s27 offen offset:0 nt lds
v_mfma_f32_16x16x32_bf16 v[96:99], a[212:215], a[16:19], v[96:99]
ds_read_b64_tr_b16 a[194:195], v14 offset:6272
v_mfma_f32_16x16x32_bf16 v[104:107], a[208:211], a[4:7], 0
buffer_load_dword a255, v59, s[64:67], s89 offen
s_add_u32 s89, s89, 1920
v_mfma_f32_16x16x32_bf16 v[104:107], a[212:215], a[20:23], v[104:107]
ds_read_b64_tr_b16 a[196:197], v14 offset:12416
v_mfma_f32_16x16x32_bf16 v[112:115], a[208:211], a[8:11], 0
ds_read_b64_tr_b16 a[198:199], v14 offset:18560
v_mfma_f32_16x16x32_bf16 v[112:115], a[212:215], a[24:27], v[112:115]
ds_read_b64_tr_b16 a[200:201], v14 offset:136
v_mfma_f32_16x16x32_bf16 v[120:123], a[208:211], a[12:15], 0
ds_read_b64_tr_b16 a[202:203], v14 offset:6280
v_mfma_f32_16x16x32_bf16 v[120:123], a[212:215], a[28:31], v[120:123]
ds_read_b64_tr_b16 a[204:205], v14 offset:12424
v_mfma_f32_16x16x32_bf16 v[100:103], a[216:219], a[0:3], 0
ds_read_b64_tr_b16 a[206:207], v14 offset:18568
v_mfma_f32_16x16x32_bf16 v[100:103], a[220:223], a[16:19], v[100:103]
ds_read_b64_tr_b16 a[208:209], v13 offset:256
v_mfma_f32_16x16x32_bf16 v[108:111], a[216:219], a[4:7], 0
ds_read_b64_tr_b16 a[210:211], v13 offset:6400
v_mfma_f32_16x16x32_bf16 v[108:111], a[220:223], a[20:23], v[108:111]
ds_read_b64_tr_b16 a[212:213], v13 offset:12544
v_mfma_f32_16x16x32_bf16 v[116:119], a[216:219], a[8:11], 0
ds_read_b64_tr_b16 a[214:215], v13 offset:18688
v_mfma_f32_16x16x32_bf16 v[116:119], a[220:223], a[24:27], v[116:119]
v_mfma_f32_16x16x32_bf16 v[124:127], a[216:219], a[12:15], 0
ds_read_b64_tr_b16 a[216:217], v13 offset:264
v_mfma_f32_16x16x32_bf16 v[124:127], a[220:223], a[28:31], v[124:127]
ds_read_b64_tr_b16 a[218:219], v13 offset:6408
v_mfma_f32_16x16x32_bf16 v[128:131], a[224:227], a[0:3], 0
s_waitcnt lgkmcnt(4)
ds_read_b64_tr_b16 a[220:221], v13 offset:12552
v_mfma_f32_16x16x32_bf16 v[128:131], a[228:231], a[16:19], v[128:131]
ds_read_b64_tr_b16 a[222:223], v13 offset:18696
v_mfma_f32_16x16x32_bf16 v[136:139], a[224:227], a[4:7], 0
v_mfma_f32_16x16x32_bf16 v[136:139], a[228:231], a[20:23], v[136:139]
v_mfma_f32_16x16x32_bf16 v[144:147], a[224:227], a[8:11], 0
v_mfma_f32_16x16x32_bf16 v[144:147], a[228:231], a[24:27], v[144:147]
v_mfma_f32_16x16x32_bf16 v[152:155], a[224:227], a[12:15], 0
ds_read_b64_tr_b16 a[224:225], v14 offset:256
v_mfma_f32_16x16x32_bf16 v[152:155], a[228:231], a[28:31], v[152:155]
ds_read_b64_tr_b16 a[226:227], v14 offset:6400
v_mfma_f32_16x16x32_bf16 v[132:135], a[232:235], a[0:3], 0
ds_read_b64_tr_b16 a[228:229], v14 offset:12544
v_mfma_f32_16x16x32_bf16 v[132:135], a[236:239], a[16:19], v[132:135]
ds_read_b64_tr_b16 a[230:231], v14 offset:18688
v_mfma_f32_16x16x32_bf16 v[140:143], a[232:235], a[4:7], 0
v_mfma_f32_16x16x32_bf16 v[140:143], a[236:239], a[20:23], v[140:143]
v_mfma_f32_16x16x32_bf16 v[148:151], a[232:235], a[8:11], 0
v_mfma_f32_16x16x32_bf16 v[148:151], a[236:239], a[24:27], v[148:151]
v_mfma_f32_16x16x32_bf16 v[156:159], a[232:235], a[12:15], 0
ds_read_b64_tr_b16 a[232:233], v14 offset:264
v_mfma_f32_16x16x32_bf16 v[156:159], a[236:239], a[28:31], v[156:159]
ds_read_b64_tr_b16 a[234:235], v14 offset:6408
v_mfma_f32_16x16x32_bf16 v[160:163], a[192:195], a[0:3], 0
ds_read_b64_tr_b16 a[236:237], v14 offset:12552
v_mfma_f32_16x16x32_bf16 v[160:163], a[196:199], a[16:19], v[160:163]
ds_read_b64_tr_b16 a[238:239], v14 offset:18696
v_mfma_f32_16x16x32_bf16 v[168:171], a[192:195], a[4:7], 0
v_mfma_f32_16x16x32_bf16 v[168:171], a[196:199], a[20:23], v[168:171]
v_mfma_f32_16x16x32_bf16 v[176:179], a[192:195], a[8:11], 0
v_mfma_f32_16x16x32_bf16 v[176:179], a[196:199], a[24:27], v[176:179]
s_waitcnt vmcnt(17) lgkmcnt(0)
v_mfma_f32_16x16x32_bf16 v[184:187], a[192:195], a[12:15], 0
s_barrier
v_mfma_f32_16x16x32_bf16 v[184:187], a[196:199], a[28:31], v[184:187]
ds_read_b64_tr_b16 a[192:193], v13 offset:24576
v_mfma_f32_16x16x32_bf16 v[164:167], a[200:203], a[0:3], 0
ds_read_b64_tr_b16 a[194:195], v13 offset:30720
v_mfma_f32_16x16x32_bf16 v[164:167], a[204:207], a[16:19], v[164:167]
ds_read_b64_tr_b16 a[196:197], v15 offset:0
v_mfma_f32_16x16x32_bf16 v[172:175], a[200:203], a[4:7], 0
ds_read_b64_tr_b16 a[198:199], v15 offset:6144
v_mfma_f32_16x16x32_bf16 v[172:175], a[204:207], a[20:23], v[172:175]
s_add_u32 m0, s91, 61440
v_mfma_f32_16x16x32_bf16 v[180:183], a[200:203], a[8:11], 0
buffer_load_dwordx4 v23, s[16:19], s29 offen offset:0 nt lds
v_mfma_f32_16x16x32_bf16 v[180:183], a[204:207], a[24:27], v[180:183]
s_waitcnt vmcnt(10)
ds_read_b128 a[32:35], v28 offset:32768
v_mfma_f32_16x16x32_bf16 v[188:191], a[200:203], a[12:15], 0
ds_read_b64_tr_b16 a[200:201], v13 offset:24584
v_mfma_f32_16x16x32_bf16 v[188:191], a[204:207], a[28:31], v[188:191]
ds_read_b64_tr_b16 a[202:203], v13 offset:30728
v_mfma_f32_16x16x32_bf16 v[192:195], a[208:211], a[0:3], 0
ds_read_b64_tr_b16 a[204:205], v15 offset:8
v_mfma_f32_16x16x32_bf16 v[192:195], a[212:215], a[16:19], v[192:195]
buffer_load_dwordx4 v24, s[16:19], s29 offen offset:1024 nt lds
v_mfma_f32_16x16x32_bf16 v[200:203], a[208:211], a[4:7], 0
ds_read_b128 a[36:39], v28 offset:34816
v_mfma_f32_16x16x32_bf16 v[200:203], a[212:215], a[20:23], v[200:203]
ds_read_b64_tr_b16 a[206:207], v15 offset:6152
v_mfma_f32_16x16x32_bf16 v[208:211], a[208:211], a[8:11], 0
v_mfma_f32_16x16x32_bf16 v[208:211], a[212:215], a[24:27], v[208:211]
v_mfma_f32_16x16x32_bf16 v[216:219], a[208:211], a[12:15], 0
buffer_load_dwordx4 v25, s[16:19], s29 offen offset:2048 nt lds
s_add_u32 s29, s29, s100
v_mfma_f32_16x16x32_bf16 v[216:219], a[212:215], a[28:31], v[216:219]
ds_read_b128 a[40:43], v28 offset:36864
v_mfma_f32_16x16x32_bf16 v[196:199], a[216:219], a[0:3], 0
ds_read_b64_tr_b16 a[208:209], v14 offset:24576
v_mfma_f32_16x16x32_bf16 v[196:199], a[220:223], a[16:19], v[196:199]
ds_read_b64_tr_b16 a[210:211], v14 offset:30720
v_mfma_f32_16x16x32_bf16 v[204:207], a[216:219], a[4:7], 0
s_add_u32 m0, s88, 6144
s_add_u32 s32, s32, s57
ds_read_b64_tr_b16 a[212:213], v16 offset:0
v_mfma_f32_16x16x32_bf16 v[204:207], a[220:223], a[20:23], v[204:207]
buffer_load_dwordx4 v26, s[4:7], s32 offen offset:0 lds
v_mfma_f32_16x16x32_bf16 v[212:215], a[216:219], a[8:11], 0
ds_read_b128 a[44:47], v28 offset:38912
v_mfma_f32_16x16x32_bf16 v[212:215], a[220:223], a[24:27], v[212:215]
ds_read_b64_tr_b16 a[214:215], v16 offset:6144
v_mfma_f32_16x16x32_bf16 v[220:223], a[216:219], a[12:15], 0
ds_read_b64_tr_b16 a[216:217], v14 offset:24584
v_mfma_f32_16x16x32_bf16 v[220:223], a[220:223], a[28:31], v[220:223]
ds_read_b64_tr_b16 a[218:219], v14 offset:30728
v_mfma_f32_16x16x32_bf16 v[224:227], a[224:227], a[0:3], 0
buffer_load_dwordx4 v27, s[4:7], s32 offen offset:1024 lds
v_mfma_f32_16x16x32_bf16 v[224:227], a[228:231], a[16:19], v[224:227]
ds_read_b128 a[48:51], v29 offset:32768
v_mfma_f32_16x16x32_bf16 v[232:235], a[224:227], a[4:7], 0
ds_read_b64_tr_b16 a[220:221], v16 offset:8
v_mfma_f32_16x16x32_bf16 v[232:235], a[228:231], a[20:23], v[232:235]
ds_read_b64_tr_b16 a[222:223], v16 offset:6152
v_mfma_f32_16x16x32_bf16 v[240:243], a[224:227], a[8:11], 0
s_add_u32 m0, s88, 8192
s_add_u32 s33, s33, s57
v_mfma_f32_16x16x32_bf16 v[240:243], a[228:231], a[24:27], v[240:243]
buffer_load_dwordx4 v26, s[4:7], s33 offen offset:0 lds
v_mfma_f32_16x16x32_bf16 v[248:251], a[224:227], a[12:15], 0
ds_read_b128 a[52:55], v29 offset:34816
v_mfma_f32_16x16x32_bf16 v[248:251], a[228:231], a[28:31], v[248:251]
ds_read_b64_tr_b16 a[224:225], v13 offset:24704
v_mfma_f32_16x16x32_bf16 v[228:231], a[232:235], a[0:3], 0
ds_read_b64_tr_b16 a[226:227], v13 offset:30848
v_mfma_f32_16x16x32_bf16 v[228:231], a[236:239], a[16:19], v[228:231]
ds_read_b64_tr_b16 a[228:229], v15 offset:128
v_mfma_f32_16x16x32_bf16 v[236:239], a[232:235], a[4:7], 0
buffer_load_dwordx4 v27, s[4:7], s33 offen offset:1024 lds
v_mfma_f32_16x16x32_bf16 v[236:239], a[236:239], a[20:23], v[236:239]
ds_read_b128 a[56:59], v29 offset:36864
v_mfma_f32_16x16x32_bf16 v[244:247], a[232:235], a[8:11], 0
ds_read_b64_tr_b16 a[230:231], v15 offset:6272
v_mfma_f32_16x16x32_bf16 v[244:247], a[236:239], a[24:27], v[244:247]
v_mfma_f32_16x16x32_bf16 v[252:255], a[232:235], a[12:15], 0
ds_read_b64_tr_b16 a[232:233], v13 offset:24712
v_mfma_f32_16x16x32_bf16 v[252:255], a[236:239], a[28:31], v[252:255]
s_waitcnt lgkmcnt(3)
ds_read_b128 a[60:63], v29 offset:38912
v_mfma_f32_16x16x32_bf16 v[64:67], a[192:195], a[32:35], v[64:67]
ds_read_b64_tr_b16 a[234:235], v13 offset:30856
v_mfma_f32_16x16x32_bf16 v[64:67], a[196:199], a[48:51], v[64:67]
s_add_u32 m0, s90, 0
ds_read_b64_tr_b16 a[236:237], v15 offset:136
v_mfma_f32_16x16x32_bf16 v[72:75], a[192:195], a[36:39], v[72:75]
buffer_load_dwordx4 v23, s[16:19], s29 offen offset:0 nt lds
v_mfma_f32_16x16x32_bf16 v[72:75], a[196:199], a[52:55], v[72:75]
ds_read_b64_tr_b16 a[238:239], v15 offset:6280
v_mfma_f32_16x16x32_bf16 v[80:83], a[192:195], a[40:43], v[80:83]
s_waitcnt lgkmcnt(4)
v_mfma_f32_16x16x32_bf16 v[80:83], a[196:199], a[56:59], v[80:83]
v_mfma_f32_16x16x32_bf16 v[88:91], a[192:195], a[44:47], v[88:91]
s_waitcnt lgkmcnt(2)
ds_read_b64_tr_b16 a[192:193], v14 offset:24704
v_mfma_f32_16x16x32_bf16 v[88:91], a[196:199], a[60:63], v[88:91]
buffer_load_dwordx4 v24, s[16:19], s29 offen offset:1024 nt lds
v_mfma_f32_16x16x32_bf16 v[92:95], a[200:203], a[44:47], v[92:95]
ds_read_b64_tr_b16 a[194:195], v14 offset:30848
v_mfma_f32_16x16x32_bf16 v[92:95], a[204:207], a[60:63], v[92:95]
ds_read_b64_tr_b16 a[196:197], v16 offset:128
v_mfma_f32_16x16x32_bf16 v[84:87], a[200:203], a[40:43], v[84:87]
ds_read_b64_tr_b16 a[198:199], v16 offset:6272
v_mfma_f32_16x16x32_bf16 v[84:87], a[204:207], a[56:59], v[84:87]
v_mfma_f32_16x16x32_bf16 v[76:79], a[200:203], a[36:39], v[76:79]
buffer_load_dwordx4 v25, s[16:19], s29 offen offset:2048 nt lds
s_add_u32 s29, s29, s38
v_mfma_f32_16x16x32_bf16 v[76:79], a[204:207], a[52:55], v[76:79]
v_mfma_f32_16x16x32_bf16 v[68:71], a[200:203], a[32:35], v[68:71]
ds_read_b64_tr_b16 a[200:201], v14 offset:24712
v_mfma_f32_16x16x32_bf16 v[68:71], a[204:207], a[48:51], v[68:71]
ds_read_b64_tr_b16 a[202:203], v14 offset:30856
v_mfma_f32_16x16x32_bf16 v[96:99], a[208:211], a[32:35], v[96:99]
s_add_u32 m0, s91, 12288
ds_read_b64_tr_b16 a[204:205], v16 offset:136
v_mfma_f32_16x16x32_bf16 v[96:99], a[212:215], a[48:51], v[96:99]
buffer_load_dwordx4 v23, s[16:19], s29 offen offset:0 nt lds
v_mfma_f32_16x16x32_bf16 v[104:107], a[208:211], a[36:39], v[104:107]
ds_read_b64_tr_b16 a[206:207], v16 offset:6280
v_mfma_f32_16x16x32_bf16 v[104:107], a[212:215], a[52:55], v[104:107]
v_mfma_f32_16x16x32_bf16 v[112:115], a[208:211], a[40:43], v[112:115]
v_mfma_f32_16x16x32_bf16 v[112:115], a[212:215], a[56:59], v[112:115]
v_mfma_f32_16x16x32_bf16 v[120:123], a[208:211], a[44:47], v[120:123]
buffer_load_dwordx4 v24, s[16:19], s29 offen offset:1024 nt lds
v_mfma_f32_16x16x32_bf16 v[120:123], a[212:215], a[60:63], v[120:123]
ds_read_b64_tr_b16 a[208:209], v13 offset:24832
v_mfma_f32_16x16x32_bf16 v[124:127], a[216:219], a[44:47], v[124:127]
ds_read_b64_tr_b16 a[210:211], v13 offset:30976
v_mfma_f32_16x16x32_bf16 v[124:127], a[220:223], a[60:63], v[124:127]
ds_read_b64_tr_b16 a[212:213], v15 offset:256
v_mfma_f32_16x16x32_bf16 v[116:119], a[216:219], a[40:43], v[116:119]
ds_read_b64_tr_b16 a[214:215], v15 offset:6400
v_mfma_f32_16x16x32_bf16 v[116:119], a[220:223], a[56:59], v[116:119]
buffer_load_dwordx4 v25, s[16:19], s29 offen offset:2048 nt lds
s_add_u32 s29, s29, s101
v_mfma_f32_16x16x32_bf16 v[108:111], a[216:219], a[36:39], v[108:111]
v_mfma_f32_16x16x32_bf16 v[108:111], a[220:223], a[52:55], v[108:111]
v_mfma_f32_16x16x32_bf16 v[100:103], a[216:219], a[32:35], v[100:103]
ds_read_b64_tr_b16 a[216:217], v13 offset:24840
v_mfma_f32_16x16x32_bf16 v[100:103], a[220:223], a[48:51], v[100:103]
s_add_u32 m0, s39, 34816
s_add_u32 s30, s30, s56
ds_read_b64_tr_b16 a[218:219], v13 offset:30984
v_mfma_f32_16x16x32_bf16 v[128:131], a[224:227], a[32:35], v[128:131]
buffer_load_dwordx4 v26, s[4:7], s30 offen offset:0 lds
v_mfma_f32_16x16x32_bf16 v[128:131], a[228:231], a[48:51], v[128:131]
ds_read_b64_tr_b16 a[220:221], v15 offset:264
v_mfma_f32_16x16x32_bf16 v[136:139], a[224:227], a[36:39], v[136:139]
ds_read_b64_tr_b16 a[222:223], v15 offset:6408
v_mfma_f32_16x16x32_bf16 v[136:139], a[228:231], a[52:55], v[136:139]
v_mfma_f32_16x16x32_bf16 v[144:147], a[224:227], a[40:43], v[144:147]
v_mfma_f32_16x16x32_bf16 v[144:147], a[228:231], a[56:59], v[144:147]
buffer_load_dwordx4 v27, s[4:7], s30 offen offset:1024 lds
v_mfma_f32_16x16x32_bf16 v[152:155], a[224:227], a[44:47], v[152:155]
ds_read_b64_tr_b16 a[224:225], v14 offset:24832
v_mfma_f32_16x16x32_bf16 v[152:155], a[228:231], a[60:63], v[152:155]
ds_read_b64_tr_b16 a[226:227], v14 offset:30976
v_mfma_f32_16x16x32_bf16 v[156:159], a[232:235], a[44:47], v[156:159]
s_waitcnt lgkmcnt(2)
ds_read_b64_tr_b16 a[228:229], v16 offset:256
v_mfma_f32_16x16x32_bf16 v[156:159], a[236:239], a[60:63], v[156:159]
s_add_u32 m0, s39, 36864
s_add_u32 s31, s31, s56
ds_read_b64_tr_b16 a[230:231], v16 offset:6400
v_mfma_f32_16x16x32_bf16 v[148:151], a[232:235], a[40:43], v[148:151]
buffer_load_dwordx4 v26, s[4:7], s31 offen offset:0 lds
v_mfma_f32_16x16x32_bf16 v[148:151], a[236:239], a[56:59], v[148:151]
v_mfma_f32_16x16x32_bf16 v[140:143], a[232:235], a[36:39], v[140:143]
v_mfma_f32_16x16x32_bf16 v[140:143], a[236:239], a[52:55], v[140:143]
v_mfma_f32_16x16x32_bf16 v[132:135], a[232:235], a[32:35], v[132:135]
ds_read_b64_tr_b16 a[232:233], v14 offset:24840
v_mfma_f32_16x16x32_bf16 v[132:135], a[236:239], a[48:51], v[132:135]
buffer_load_dwordx4 v27, s[4:7], s31 offen offset:1024 lds
v_mfma_f32_16x16x32_bf16 v[160:163], a[192:195], a[32:35], v[160:163]
ds_read_b64_tr_b16 a[234:235], v14 offset:30984
v_mfma_f32_16x16x32_bf16 v[160:163], a[196:199], a[48:51], v[160:163]
ds_read_b64_tr_b16 a[236:237], v16 offset:264
v_mfma_f32_16x16x32_bf16 v[168:171], a[192:195], a[36:39], v[168:171]
ds_read_b64_tr_b16 a[238:239], v16 offset:6408
v_mfma_f32_16x16x32_bf16 v[168:171], a[196:199], a[52:55], v[168:171]
v_mfma_f32_16x16x32_bf16 v[176:179], a[192:195], a[40:43], v[176:179]
v_mfma_f32_16x16x32_bf16 v[176:179], a[196:199], a[56:59], v[176:179]
s_waitcnt vmcnt(14) lgkmcnt(0)
v_mfma_f32_16x16x32_bf16 v[184:187], a[192:195], a[44:47], v[184:187]
s_barrier
s_add_u32 m0, s88, 38912
s_add_u32 s32, s32, s56
v_mfma_f32_16x16x32_bf16 v[184:187], a[196:199], a[60:63], v[184:187]
buffer_load_dwordx4 v26, s[4:7], s32 offen offset:0 lds
v_mfma_f32_16x16x32_bf16 v[188:191], a[200:203], a[44:47], v[188:191]
ds_read_b64_tr_b16 a[192:193], v15 offset:12288
v_mfma_f32_16x16x32_bf16 v[188:191], a[204:207], a[60:63], v[188:191]
ds_read_b64_tr_b16 a[194:195], v15 offset:18432
v_mfma_f32_16x16x32_bf16 v[180:183], a[200:203], a[40:43], v[180:183]
ds_read_b64_tr_b16 a[196:197], v15 offset:24576
v_mfma_f32_16x16x32_bf16 v[180:183], a[204:207], a[56:59], v[180:183]
ds_read_b64_tr_b16 a[198:199], v15 offset:30720
v_mfma_f32_16x16x32_bf16 v[172:175], a[200:203], a[36:39], v[172:175]
buffer_load_dwordx4 v27, s[4:7], s32 offen offset:1024 lds
v_mfma_f32_16x16x32_bf16 v[172:175], a[204:207], a[52:55], v[172:175]
s_waitcnt vmcnt(12)
ds_read_b128 a[0:3], v28 offset:0
v_mfma_f32_16x16x32_bf16 v[164:167], a[200:203], a[32:35], v[164:167]
ds_read_b64_tr_b16 a[200:201], v15 offset:12296
v_mfma_f32_16x16x32_bf16 v[164:167], a[204:207], a[48:51], v[164:167]
ds_read_b64_tr_b16 a[202:203], v15 offset:18440
v_mfma_f32_16x16x32_bf16 v[192:195], a[208:211], a[32:35], v[192:195]
s_add_u32 m0, s88, 40960
s_add_u32 s33, s33, s56
ds_read_b64_tr_b16 a[204:205], v15 offset:24584
v_mfma_f32_16x16x32_bf16 v[192:195], a[212:215], a[48:51], v[192:195]
buffer_load_dwordx4 v26, s[4:7], s33 offen offset:0 lds
v_mfma_f32_16x16x32_bf16 v[200:203], a[208:211], a[36:39], v[200:203]
ds_read_b128 a[4:7], v28 offset:2048
v_mfma_f32_16x16x32_bf16 v[200:203], a[212:215], a[52:55], v[200:203]
ds_read_b64_tr_b16 a[206:207], v15 offset:30728
v_mfma_f32_16x16x32_bf16 v[208:211], a[208:211], a[40:43], v[208:211]
v_mfma_f32_16x16x32_bf16 v[208:211], a[212:215], a[56:59], v[208:211]
v_mfma_f32_16x16x32_bf16 v[216:219], a[208:211], a[44:47], v[216:219]
buffer_load_dwordx4 v27, s[4:7], s33 offen offset:1024 lds
v_mfma_f32_16x16x32_bf16 v[216:219], a[212:215], a[60:63], v[216:219]
ds_read_b128 a[8:11], v28 offset:4096
v_mfma_f32_16x16x32_bf16 v[220:223], a[216:219], a[44:47], v[220:223]
ds_read_b64_tr_b16 a[208:209], v16 offset:12288
v_mfma_f32_16x16x32_bf16 v[220:223], a[220:223], a[60:63], v[220:223]
ds_read_b64_tr_b16 a[210:211], v16 offset:18432
v_mfma_f32_16x16x32_bf16 v[212:215], a[216:219], a[40:43], v[212:215]
ds_read_b64_tr_b16 a[212:213], v16 offset:24576
v_mfma_f32_16x16x32_bf16 v[212:215], a[220:223], a[56:59], v[212:215]
ds_read_b128 a[12:15], v28 offset:6144
v_mfma_f32_16x16x32_bf16 v[204:207], a[216:219], a[36:39], v[204:207]
ds_read_b64_tr_b16 a[214:215], v16 offset:30720
v_mfma_f32_16x16x32_bf16 v[204:207], a[220:223], a[52:55], v[204:207]
v_mfma_f32_16x16x32_bf16 v[196:199], a[216:219], a[32:35], v[196:199]
ds_read_b64_tr_b16 a[216:217], v16 offset:12296
v_mfma_f32_16x16x32_bf16 v[196:199], a[220:223], a[48:51], v[196:199]
s_add_u32 m0, s90, 24576
ds_read_b128 a[16:19], v29 offset:0
v_mfma_f32_16x16x32_bf16 v[224:227], a[224:227], a[32:35], v[224:227]
buffer_load_dwordx4 v23, s[16:19], s29 offen offset:0 nt lds
v_mfma_f32_16x16x32_bf16 v[224:227], a[228:231], a[48:51], v[224:227]
ds_read_b64_tr_b16 a[218:219], v16 offset:18440
v_mfma_f32_16x16x32_bf16 v[232:235], a[224:227], a[36:39], v[232:235]
ds_read_b64_tr_b16 a[220:221], v16 offset:24584
v_mfma_f32_16x16x32_bf16 v[232:235], a[228:231], a[52:55], v[232:235]
buffer_load_dwordx4 v24, s[16:19], s29 offen offset:1024 nt lds
v_mfma_f32_16x16x32_bf16 v[240:243], a[224:227], a[40:43], v[240:243]
ds_read_b128 a[20:23], v29 offset:2048
v_mfma_f32_16x16x32_bf16 v[240:243], a[228:231], a[56:59], v[240:243]
ds_read_b64_tr_b16 a[222:223], v16 offset:30728
v_mfma_f32_16x16x32_bf16 v[248:251], a[224:227], a[44:47], v[248:251]
buffer_load_dwordx4 v25, s[16:19], s29 offen offset:2048 nt lds
s_add_u32 s29, s29, s38
v_mfma_f32_16x16x32_bf16 v[248:251], a[228:231], a[60:63], v[248:251]
ds_read_b64_tr_b16 a[224:225], v15 offset:12416
v_mfma_f32_16x16x32_bf16 v[252:255], a[232:235], a[44:47], v[252:255]
ds_read_b128 a[24:27], v29 offset:4096
v_mfma_f32_16x16x32_bf16 v[252:255], a[236:239], a[60:63], v[252:255]
ds_read_b64_tr_b16 a[226:227], v15 offset:18560
v_mfma_f32_16x16x32_bf16 v[244:247], a[232:235], a[40:43], v[244:247]
ds_read_b64_tr_b16 a[228:229], v15 offset:24704
v_mfma_f32_16x16x32_bf16 v[244:247], a[236:239], a[56:59], v[244:247]
ds_read_b64_tr_b16 a[230:231], v15 offset:30848
v_mfma_f32_16x16x32_bf16 v[236:239], a[232:235], a[36:39], v[236:239]
ds_read_b128 a[28:31], v29 offset:6144
v_mfma_f32_16x16x32_bf16 v[236:239], a[236:239], a[52:55], v[236:239]
v_mfma_f32_16x16x32_bf16 v[228:231], a[232:235], a[32:35], v[228:231]
ds_read_b64_tr_b16 a[232:233], v15 offset:12424
v_mfma_f32_16x16x32_bf16 v[228:231], a[236:239], a[48:51], v[228:231]
s_waitcnt lgkmcnt(4)
ds_read_b64_tr_b16 a[234:235], v15 offset:18568
v_mfma_f32_16x16x32_bf16 v[64:67], a[192:195], a[0:3], v[64:67]
ds_read_b64_tr_b16 a[236:237], v15 offset:24712
v_mfma_f32_16x16x32_bf16 v[64:67], a[196:199], a[16:19], v[64:67]
s_waitcnt lgkmcnt(3)
s_add_u32 m0, s39, 2048
s_add_u32 s30, s30, s57
ds_read_b64_tr_b16 a[238:239], v15 offset:30856
v_mfma_f32_16x16x32_bf16 v[72:75], a[192:195], a[4:7], v[72:75]
buffer_load_dwordx4 v26, s[4:7], s30 offen offset:0 lds
v_mfma_f32_16x16x32_bf16 v[72:75], a[196:199], a[20:23], v[72:75]
v_mfma_f32_16x16x32_bf16 v[80:83], a[192:195], a[8:11], v[80:83]
v_mfma_f32_16x16x32_bf16 v[80:83], a[196:199], a[24:27], v[80:83]
buffer_load_dwordx4 v27, s[4:7], s30 offen offset:1024 lds
v_mfma_f32_16x16x32_bf16 v[88:91], a[192:195], a[12:15], v[88:91]
ds_read_b64_tr_b16 a[192:193], v16 offset:12416
v_mfma_f32_16x16x32_bf16 v[88:91], a[196:199], a[28:31], v[88:91]
s_add_u32 m0, s39, 4096
s_add_u32 s31, s31, s57
ds_read_b64_tr_b16 a[194:195], v16 offset:18560
v_mfma_f32_16x16x32_bf16 v[92:95], a[200:203], a[12:15], v[92:95]
buffer_load_dwordx4 v26, s[4:7], s31 offen offset:0 lds
v_mfma_f32_16x16x32_bf16 v[92:95], a[204:207], a[28:31], v[92:95]
ds_read_b64_tr_b16 a[196:197], v16 offset:24704
v_mfma_f32_16x16x32_bf16 v[84:87], a[200:203], a[8:11], v[84:87]
ds_read_b64_tr_b16 a[198:199], v16 offset:30848
v_mfma_f32_16x16x32_bf16 v[84:87], a[204:207], a[24:27], v[84:87]
buffer_load_dwordx4 v27, s[4:7], s31 offen offset:1024 lds
v_mfma_f32_16x16x32_bf16 v[76:79], a[200:203], a[4:7], v[76:79]
v_mfma_f32_16x16x32_bf16 v[76:79], a[204:207], a[20:23], v[76:79]
v_mfma_f32_16x16x32_bf16 v[68:71], a[200:203], a[0:3], v[68:71]
buffer_load_dword a255, v59, s[64:67], s89 offen
s_add_u32 s89, s89, 1920
v_mfma_f32_16x16x32_bf16 v[68:71], a[204:207], a[16:19], v[68:71]
ds_read_b64_tr_b16 a[200:201], v16 offset:12424
v_mfma_f32_16x16x32_bf16 v[96:99], a[208:211], a[0:3], v[96:99]
ds_read_b64_tr_b16 a[202:203], v16 offset:18568
v_mfma_f32_16x16x32_bf16 v[96:99], a[212:215], a[16:19], v[96:99]
ds_read_b64_tr_b16 a[204:205], v16 offset:24712
v_mfma_f32_16x16x32_bf16 v[104:107], a[208:211], a[4:7], v[104:107]
ds_read_b64_tr_b16 a[206:207], v16 offset:30856
v_mfma_f32_16x16x32_bf16 v[104:107], a[212:215], a[20:23], v[104:107]
v_mfma_f32_16x16x32_bf16 v[112:115], a[208:211], a[8:11], v[112:115]
v_mov_b32 v54, 0
v_mfma_f32_16x16x32_bf16 v[112:115], a[212:215], a[24:27], v[112:115]
v_mfma_f32_16x16x32_bf16 v[120:123], a[208:211], a[12:15], v[120:123]
buffer_store_dword v54, v30, s[72:75], 0 offen sc1
v_mfma_f32_16x16x32_bf16 v[120:123], a[212:215], a[28:31], v[120:123]
s_add_u32 m0, s25, 0
ds_read_b64_tr_b16 a[208:209], v15 offset:12544
v_mfma_f32_16x16x32_bf16 v[124:127], a[216:219], a[12:15], v[124:127]
buffer_load_dwordx4 v18, s[8:11], s27 offen offset:1024 nt lds
v_mfma_f32_16x16x32_bf16 v[124:127], a[220:223], a[28:31], v[124:127]
ds_read_b64_tr_b16 a[210:211], v15 offset:18688
v_mfma_f32_16x16x32_bf16 v[116:119], a[216:219], a[8:11], v[116:119]
ds_read_b64_tr_b16 a[212:213], v15 offset:24832
v_mfma_f32_16x16x32_bf16 v[116:119], a[220:223], a[24:27], v[116:119]
ds_read_b64_tr_b16 a[214:215], v15 offset:30976
v_mfma_f32_16x16x32_bf16 v[108:111], a[216:219], a[4:7], v[108:111]
v_mfma_f32_16x16x32_bf16 v[108:111], a[220:223], a[20:23], v[108:111]
v_mfma_f32_16x16x32_bf16 v[100:103], a[216:219], a[0:3], v[100:103]
ds_read_b64_tr_b16 a[216:217], v15 offset:12552
v_mfma_f32_16x16x32_bf16 v[100:103], a[220:223], a[16:19], v[100:103]
ds_read_b64_tr_b16 a[218:219], v15 offset:18696
v_mfma_f32_16x16x32_bf16 v[128:131], a[224:227], a[0:3], v[128:131]
ds_read_b64_tr_b16 a[220:221], v15 offset:24840
v_mfma_f32_16x16x32_bf16 v[128:131], a[228:231], a[16:19], v[128:131]
ds_read_b64_tr_b16 a[222:223], v15 offset:30984
v_mfma_f32_16x16x32_bf16 v[136:139], a[224:227], a[4:7], v[136:139]
v_mfma_f32_16x16x32_bf16 v[136:139], a[228:231], a[20:23], v[136:139]
s_add_u32 m0, s25, 0
v_mfma_f32_16x16x32_bf16 v[144:147], a[224:227], a[8:11], v[144:147]
buffer_load_dwordx4 v19, s[8:11], s27 offen offset:2048 nt lds
s_add_u32 s27, s27, 12288
v_mfma_f32_16x16x32_bf16 v[144:147], a[228:231], a[24:27], v[144:147]
v_mfma_f32_16x16x32_bf16 v[152:155], a[224:227], a[12:15], v[152:155]
ds_read_b64_tr_b16 a[224:225], v16 offset:12544
v_mfma_f32_16x16x32_bf16 v[152:155], a[228:231], a[28:31], v[152:155]
s_waitcnt lgkmcnt(1)
ds_read_b64_tr_b16 a[226:227], v16 offset:18688
v_mfma_f32_16x16x32_bf16 v[156:159], a[232:235], a[12:15], v[156:159]
ds_read_b64_tr_b16 a[228:229], v16 offset:24832
v_mfma_f32_16x16x32_bf16 v[156:159], a[236:239], a[28:31], v[156:159]
ds_read_b64_tr_b16 a[230:231], v16 offset:30976
v_mfma_f32_16x16x32_bf16 v[148:151], a[232:235], a[8:11], v[148:151]
v_mfma_f32_16x16x32_bf16 v[148:151], a[236:239], a[24:27], v[148:151]
v_mfma_f32_16x16x32_bf16 v[140:143], a[232:235], a[4:7], v[140:143]
v_mfma_f32_16x16x32_bf16 v[140:143], a[236:239], a[20:23], v[140:143]
v_mfma_f32_16x16x32_bf16 v[132:135], a[232:235], a[0:3], v[132:135]
ds_read_b64_tr_b16 a[232:233], v16 offset:12552
v_mfma_f32_16x16x32_bf16 v[132:135], a[236:239], a[16:19], v[132:135]
ds_read_b64_tr_b16 a[234:235], v16 offset:18696
v_mfma_f32_16x16x32_bf16 v[160:163], a[192:195], a[0:3], v[160:163]
ds_read_b64_tr_b16 a[236:237], v16 offset:24840
v_mfma_f32_16x16x32_bf16 v[160:163], a[196:199], a[16:19], v[160:163]
ds_read_b64_tr_b16 a[238:239], v16 offset:30984
v_mfma_f32_16x16x32_bf16 v[168:171], a[192:195], a[4:7], v[168:171]
v_mfma_f32_16x16x32_bf16 v[168:171], a[196:199], a[20:23], v[168:171]
v_mfma_f32_16x16x32_bf16 v[176:179], a[192:195], a[8:11], v[176:179]
v_mfma_f32_16x16x32_bf16 v[176:179], a[196:199], a[24:27], v[176:179]
s_waitcnt vmcnt(19) lgkmcnt(0)
v_mfma_f32_16x16x32_bf16 v[184:187], a[192:195], a[12:15], v[184:187]
s_barrier
v_mfma_f32_16x16x32_bf16 v[184:187], a[196:199], a[28:31], v[184:187]
ds_read_b64_tr_b16 a[192:193], v13 offset:0
v_mfma_f32_16x16x32_bf16 v[188:191], a[200:203], a[12:15], v[188:191]
ds_read_b64_tr_b16 a[194:195], v13 offset:6144
v_mfma_f32_16x16x32_bf16 v[188:191], a[204:207], a[28:31], v[188:191]
ds_read_b64_tr_b16 a[196:197], v13 offset:12288
v_mfma_f32_16x16x32_bf16 v[180:183], a[200:203], a[8:11], v[180:183]
ds_read_b64_tr_b16 a[198:199], v13 offset:18432
v_mfma_f32_16x16x32_bf16 v[180:183], a[204:207], a[24:27], v[180:183]
s_add_u32 m0, s91, 36864
v_mfma_f32_16x16x32_bf16 v[172:175], a[200:203], a[4:7], v[172:175]
buffer_load_dwordx4 v23, s[16:19], s29 offen offset:0 nt lds
v_mfma_f32_16x16x32_bf16 v[172:175], a[204:207], a[20:23], v[172:175]
s_waitcnt vmcnt(12)
ds_read_b128 a[32:35], v28 offset:32768
v_mfma_f32_16x16x32_bf16 v[164:167], a[200:203], a[0:3], v[164:167]
ds_read_b64_tr_b16 a[200:201], v13 offset:8
v_mfma_f32_16x16x32_bf16 v[164:167], a[204:207], a[16:19], v[164:167]
ds_read_b64_tr_b16 a[202:203], v13 offset:6152
v_mfma_f32_16x16x32_bf16 v[192:195], a[208:211], a[0:3], v[192:195]
ds_read_b64_tr_b16 a[204:205], v13 offset:12296
v_mfma_f32_16x16x32_bf16 v[192:195], a[212:215], a[16:19], v[192:195]
buffer_load_dwordx4 v24, s[16:19], s29 offen offset:1024 nt lds
v_mfma_f32_16x16x32_bf16 v[200:203], a[208:211], a[4:7], v[200:203]
ds_read_b128 a[36:39], v28 offset:34816
v_mfma_f32_16x16x32_bf16 v[200:203], a[212:215], a[20:23], v[200:203]
ds_read_b64_tr_b16 a[206:207], v13 offset:18440
v_mfma_f32_16x16x32_bf16 v[208:211], a[208:211], a[8:11], v[208:211]
v_mfma_f32_16x16x32_bf16 v[208:211], a[212:215], a[24:27], v[208:211]
v_mfma_f32_16x16x32_bf16 v[216:219], a[208:211], a[12:15], v[216:219]
buffer_load_dwordx4 v25, s[16:19], s29 offen offset:2048 nt lds
s_add_u32 s29, s29, s100
v_mfma_f32_16x16x32_bf16 v[216:219], a[212:215], a[28:31], v[216:219]
ds_read_b128 a[40:43], v28 offset:36864
v_mfma_f32_16x16x32_bf16 v[220:223], a[216:219], a[12:15], v[220:223]
ds_read_b64_tr_b16 a[208:209], v14 offset:0
v_mfma_f32_16x16x32_bf16 v[220:223], a[220:223], a[28:31], v[220:223]
ds_read_b64_tr_b16 a[210:211], v14 offset:6144
v_mfma_f32_16x16x32_bf16 v[212:215], a[216:219], a[8:11], v[212:215]
s_add_u32 m0, s88, 6144
s_add_u32 s32, s32, s57
ds_read_b64_tr_b16 a[212:213], v14 offset:12288
v_mfma_f32_16x16x32_bf16 v[212:215], a[220:223], a[24:27], v[212:215]
buffer_load_dwordx4 v26, s[4:7], s32 offen offset:0 lds
v_mfma_f32_16x16x32_bf16 v[204:207], a[216:219], a[4:7], v[204:207]
ds_read_b128 a[44:47], v28 offset:38912
v_mfma_f32_16x16x32_bf16 v[204:207], a[220:223], a[20:23], v[204:207]
ds_read_b64_tr_b16 a[214:215], v14 offset:18432
v_mfma_f32_16x16x32_bf16 v[196:199], a[216:219], a[0:3], v[196:199]
ds_read_b64_tr_b16 a[216:217], v14 offset:8
v_mfma_f32_16x16x32_bf16 v[196:199], a[220:223], a[16:19], v[196:199]
ds_read_b64_tr_b16 a[218:219], v14 offset:6152
v_mfma_f32_16x16x32_bf16 v[224:227], a[224:227], a[0:3], v[224:227]
buffer_load_dwordx4 v27, s[4:7], s32 offen offset:1024 lds
v_mfma_f32_16x16x32_bf16 v[224:227], a[228:231], a[16:19], v[224:227]
ds_read_b128 a[48:51], v29 offset:32768
v_mfma_f32_16x16x32_bf16 v[232:235], a[224:227], a[4:7], v[232:235]
ds_read_b64_tr_b16 a[220:221], v14 offset:12296
v_mfma_f32_16x16x32_bf16 v[232:235], a[228:231], a[20:23], v[232:235]
ds_read_b64_tr_b16 a[222:223], v14 offset:18440
v_mfma_f32_16x16x32_bf16 v[240:243], a[224:227], a[8:11], v[240:243]
s_add_u32 m0, s88, 8192
s_add_u32 s33, s33, s57
v_mfma_f32_16x16x32_bf16 v[240:243], a[228:231], a[24:27], v[240:243]
buffer_load_dwordx4 v26, s[4:7], s33 offen offset:0 lds
v_mfma_f32_16x16x32_bf16 v[248:251], a[224:227], a[12:15], v[248:251]
ds_read_b128 a[52:55], v29 offset:34816
v_mfma_f32_16x16x32_bf16 v[248:251], a[228:231], a[28:31], v[248:251]
ds_read_b64_tr_b16 a[224:225], v13 offset:128
v_mfma_f32_16x16x32_bf16 v[252:255], a[232:235], a[12:15], v[252:255]
ds_read_b64_tr_b16 a[226:227], v13 offset:6272
v_mfma_f32_16x16x32_bf16 v[252:255], a[236:239], a[28:31], v[252:255]
ds_read_b64_tr_b16 a[228:229], v13 offset:12416
v_mfma_f32_16x16x32_bf16 v[244:247], a[232:235], a[8:11], v[244:247]
buffer_load_dwordx4 v27, s[4:7], s33 offen offset:1024 lds
v_mfma_f32_16x16x32_bf16 v[244:247], a[236:239], a[24:27], v[244:247]
ds_read_b128 a[56:59], v29 offset:36864
v_mfma_f32_16x16x32_bf16 v[236:239], a[232:235], a[4:7], v[236:239]
ds_read_b64_tr_b16 a[230:231], v13 offset:18560
v_mfma_f32_16x16x32_bf16 v[236:239], a[236:239], a[20:23], v[236:239]
v_mfma_f32_16x16x32_bf16 v[228:231], a[232:235], a[0:3], v[228:231]
ds_read_b64_tr_b16 a[232:233], v13 offset:136
v_mfma_f32_16x16x32_bf16 v[228:231], a[236:239], a[16:19], v[228:231]
s_waitcnt lgkmcnt(3)
ds_read_b128 a[60:63], v29 offset:38912
v_mfma_f32_16x16x32_bf16 v[64:67], a[192:195], a[32:35], v[64:67]
ds_read_b64_tr_b16 a[234:235], v13 offset:6280
v_mfma_f32_16x16x32_bf16 v[64:67], a[196:199], a[48:51], v[64:67]
s_add_u32 m0, s90, 49152
ds_read_b64_tr_b16 a[236:237], v13 offset:12424
v_mfma_f32_16x16x32_bf16 v[72:75], a[192:195], a[36:39], v[72:75]
buffer_load_dwordx4 v23, s[16:19], s29 offen offset:0 nt lds
v_mfma_f32_16x16x32_bf16 v[72:75], a[196:199], a[52:55], v[72:75]
ds_read_b64_tr_b16 a[238:239], v13 offset:18568
v_mfma_f32_16x16x32_bf16 v[80:83], a[192:195], a[40:43], v[80:83]
s_waitcnt lgkmcnt(4)
v_mfma_f32_16x16x32_bf16 v[80:83], a[196:199], a[56:59], v[80:83]
v_mfma_f32_16x16x32_bf16 v[88:91], a[192:195], a[44:47], v[88:91]
s_waitcnt lgkmcnt(2)
ds_read_b64_tr_b16 a[192:193], v14 offset:128
v_mfma_f32_16x16x32_bf16 v[88:91], a[196:199], a[60:63], v[88:91]
buffer_load_dwordx4 v24, s[16:19], s29 offen offset:1024 nt lds
v_mfma_f32_16x16x32_bf16 v[92:95], a[200:203], a[44:47], v[92:95]
ds_read_b64_tr_b16 a[194:195], v14 offset:6272
v_mfma_f32_16x16x32_bf16 v[92:95], a[204:207], a[60:63], v[92:95]
ds_read_b64_tr_b16 a[196:197], v14 offset:12416
v_mfma_f32_16x16x32_bf16 v[84:87], a[200:203], a[40:43], v[84:87]
ds_read_b64_tr_b16 a[198:199], v14 offset:18560
v_mfma_f32_16x16x32_bf16 v[84:87], a[204:207], a[56:59], v[84:87]
v_mfma_f32_16x16x32_bf16 v[76:79], a[200:203], a[36:39], v[76:79]
buffer_load_dwordx4 v25, s[16:19], s29 offen offset:2048 nt lds
s_add_u32 s29, s29, s38
v_mfma_f32_16x16x32_bf16 v[76:79], a[204:207], a[52:55], v[76:79]
v_mfma_f32_16x16x32_bf16 v[68:71], a[200:203], a[32:35], v[68:71]
ds_read_b64_tr_b16 a[200:201], v14 offset:136
v_mfma_f32_16x16x32_bf16 v[68:71], a[204:207], a[48:51], v[68:71]
ds_read_b64_tr_b16 a[202:203], v14 offset:6280
v_mfma_f32_16x16x32_bf16 v[96:99], a[208:211], a[32:35], v[96:99]
s_add_u32 m0, s91, 61440
ds_read_b64_tr_b16 a[204:205], v14 offset:12424
v_mfma_f32_16x16x32_bf16 v[96:99], a[212:215], a[48:51], v[96:99]
buffer_load_dwordx4 v23, s[16:19], s29 offen offset:0 nt lds
v_mfma_f32_16x16x32_bf16 v[104:107], a[208:211], a[36:39], v[104:107]
ds_read_b64_tr_b16 a[206:207], v14 offset:18568
v_mfma_f32_16x16x32_bf16 v[104:107], a[212:215], a[52:55], v[104:107]
v_mfma_f32_16x16x32_bf16 v[112:115], a[208:211], a[40:43], v[112:115]
v_mfma_f32_16x16x32_bf16 v[112:115], a[212:215], a[56:59], v[112:115]
v_mfma_f32_16x16x32_bf16 v[120:123], a[208:211], a[44:47], v[120:123]
buffer_load_dwordx4 v24, s[16:19], s29 offen offset:1024 nt lds
v_mfma_f32_16x16x32_bf16 v[120:123], a[212:215], a[60:63], v[120:123]
ds_read_b64_tr_b16 a[208:209], v13 offset:256
v_mfma_f32_16x16x32_bf16 v[124:127], a[216:219], a[44:47], v[124:127]
ds_read_b64_tr_b16 a[210:211], v13 offset:6400
v_mfma_f32_16x16x32_bf16 v[124:127], a[220:223], a[60:63], v[124:127]
ds_read_b64_tr_b16 a[212:213], v13 offset:12544
v_mfma_f32_16x16x32_bf16 v[116:119], a[216:219], a[40:43], v[116:119]
ds_read_b64_tr_b16 a[214:215], v13 offset:18688
v_mfma_f32_16x16x32_bf16 v[116:119], a[220:223], a[56:59], v[116:119]
buffer_load_dwordx4 v25, s[16:19], s29 offen offset:2048 nt lds
s_add_u32 s29, s29, s101
v_mfma_f32_16x16x32_bf16 v[108:111], a[216:219], a[36:39], v[108:111]
v_mfma_f32_16x16x32_bf16 v[108:111], a[220:223], a[52:55], v[108:111]
v_mfma_f32_16x16x32_bf16 v[100:103], a[216:219], a[32:35], v[100:103]
ds_read_b64_tr_b16 a[216:217], v13 offset:264
v_mfma_f32_16x16x32_bf16 v[100:103], a[220:223], a[48:51], v[100:103]
s_add_u32 m0, s39, 34816
s_add_u32 s30, s30, s56
ds_read_b64_tr_b16 a[218:219], v13 offset:6408
v_mfma_f32_16x16x32_bf16 v[128:131], a[224:227], a[32:35], v[128:131]
buffer_load_dwordx4 v26, s[4:7], s30 offen offset:0 lds
v_mfma_f32_16x16x32_bf16 v[128:131], a[228:231], a[48:51], v[128:131]
ds_read_b64_tr_b16 a[220:221], v13 offset:12552
v_mfma_f32_16x16x32_bf16 v[136:139], a[224:227], a[36:39], v[136:139]
ds_read_b64_tr_b16 a[222:223], v13 offset:18696
v_mfma_f32_16x16x32_bf16 v[136:139], a[228:231], a[52:55], v[136:139]
v_mfma_f32_16x16x32_bf16 v[144:147], a[224:227], a[40:43], v[144:147]
v_mfma_f32_16x16x32_bf16 v[144:147], a[228:231], a[56:59], v[144:147]
buffer_load_dwordx4 v27, s[4:7], s30 offen offset:1024 lds
v_mfma_f32_16x16x32_bf16 v[152:155], a[224:227], a[44:47], v[152:155]
ds_read_b64_tr_b16 a[224:225], v14 offset:256
v_mfma_f32_16x16x32_bf16 v[152:155], a[228:231], a[60:63], v[152:155]
ds_read_b64_tr_b16 a[226:227], v14 offset:6400
v_mfma_f32_16x16x32_bf16 v[156:159], a[232:235], a[44:47], v[156:159]
s_waitcnt lgkmcnt(2)
ds_read_b64_tr_b16 a[228:229], v14 offset:12544
v_mfma_f32_16x16x32_bf16 v[156:159], a[236:239], a[60:63], v[156:159]
s_add_u32 m0, s39, 36864
s_add_u32 s31, s31, s56
ds_read_b64_tr_b16 a[230:231], v14 offset:18688
v_mfma_f32_16x16x32_bf16 v[148:151], a[232:235], a[40:43], v[148:151]
buffer_load_dwordx4 v26, s[4:7], s31 offen offset:0 lds
v_mfma_f32_16x16x32_bf16 v[148:151], a[236:239], a[56:59], v[148:151]
v_mfma_f32_16x16x32_bf16 v[140:143], a[232:235], a[36:39], v[140:143]
v_mfma_f32_16x16x32_bf16 v[140:143], a[236:239], a[52:55], v[140:143]
v_mfma_f32_16x16x32_bf16 v[132:135], a[232:235], a[32:35], v[132:135]
ds_read_b64_tr_b16 a[232:233], v14 offset:264
v_mfma_f32_16x16x32_bf16 v[132:135], a[236:239], a[48:51], v[132:135]
buffer_load_dwordx4 v27, s[4:7], s31 offen offset:1024 lds
v_mfma_f32_16x16x32_bf16 v[160:163], a[192:195], a[32:35], v[160:163]
ds_read_b64_tr_b16 a[234:235], v14 offset:6408
v_mfma_f32_16x16x32_bf16 v[160:163], a[196:199], a[48:51], v[160:163]
ds_read_b64_tr_b16 a[236:237], v14 offset:12552
v_mfma_f32_16x16x32_bf16 v[168:171], a[192:195], a[36:39], v[168:171]
ds_read_b64_tr_b16 a[238:239], v14 offset:18696
v_mfma_f32_16x16x32_bf16 v[168:171], a[196:199], a[52:55], v[168:171]
v_mfma_f32_16x16x32_bf16 v[176:179], a[192:195], a[40:43], v[176:179]
v_mfma_f32_16x16x32_bf16 v[176:179], a[196:199], a[56:59], v[176:179]
s_waitcnt vmcnt(14) lgkmcnt(0)
v_mfma_f32_16x16x32_bf16 v[184:187], a[192:195], a[44:47], v[184:187]
s_barrier
s_add_u32 m0, s88, 38912
s_add_u32 s32, s32, s56
v_mfma_f32_16x16x32_bf16 v[184:187], a[196:199], a[60:63], v[184:187]
buffer_load_dwordx4 v26, s[4:7], s32 offen offset:0 lds
v_mfma_f32_16x16x32_bf16 v[188:191], a[200:203], a[44:47], v[188:191]
ds_read_b64_tr_b16 a[192:193], v13 offset:24576
v_mfma_f32_16x16x32_bf16 v[188:191], a[204:207], a[60:63], v[188:191]
ds_read_b64_tr_b16 a[194:195], v13 offset:30720
v_mfma_f32_16x16x32_bf16 v[180:183], a[200:203], a[40:43], v[180:183]
ds_read_b64_tr_b16 a[196:197], v15 offset:0
v_mfma_f32_16x16x32_bf16 v[180:183], a[204:207], a[56:59], v[180:183]
ds_read_b64_tr_b16 a[198:199], v15 offset:6144
v_mfma_f32_16x16x32_bf16 v[172:175], a[200:203], a[36:39], v[172:175]
buffer_load_dwordx4 v27, s[4:7], s32 offen offset:1024 lds
v_mfma_f32_16x16x32_bf16 v[172:175], a[204:207], a[52:55], v[172:175]
s_waitcnt vmcnt(12)
ds_read_b128 a[0:3], v28 offset:0
v_mfma_f32_16x16x32_bf16 v[164:167], a[200:203], a[32:35], v[164:167]
ds_read_b64_tr_b16 a[200:201], v13 offset:24584
v_mfma_f32_16x16x32_bf16 v[164:167], a[204:207], a[48:51], v[164:167]
ds_read_b64_tr_b16 a[202:203], v13 offset:30728
v_mfma_f32_16x16x32_bf16 v[192:195], a[208:211], a[32:35], v[192:195]
s_add_u32 m0, s88, 40960
s_add_u32 s33, s33, s56
ds_read_b64_tr_b16 a[204:205], v15 offset:8
v_mfma_f32_16x16x32_bf16 v[192:195], a[212:215], a[48:51], v[192:195]
buffer_load_dwordx4 v26, s[4:7], s33 offen offset:0 lds
v_mfma_f32_16x16x32_bf16 v[200:203], a[208:211], a[36:39], v[200:203]
ds_read_b128 a[4:7], v28 offset:2048
v_mfma_f32_16x16x32_bf16 v[200:203], a[212:215], a[52:55], v[200:203]
ds_read_b64_tr_b16 a[206:207], v15 offset:6152
v_mfma_f32_16x16x32_bf16 v[208:211], a[208:211], a[40:43], v[208:211]
v_mfma_f32_16x16x32_bf16 v[208:211], a[212:215], a[56:59], v[208:211]
v_mfma_f32_16x16x32_bf16 v[216:219], a[208:211], a[44:47], v[216:219]
buffer_load_dwordx4 v27, s[4:7], s33 offen offset:1024 lds
v_mfma_f32_16x16x32_bf16 v[216:219], a[212:215], a[60:63], v[216:219]
ds_read_b128 a[8:11], v28 offset:4096
v_mfma_f32_16x16x32_bf16 v[220:223], a[216:219], a[44:47], v[220:223]
ds_read_b64_tr_b16 a[208:209], v14 offset:24576
v_mfma_f32_16x16x32_bf16 v[220:223], a[220:223], a[60:63], v[220:223]
ds_read_b64_tr_b16 a[210:211], v14 offset:30720
v_mfma_f32_16x16x32_bf16 v[212:215], a[216:219], a[40:43], v[212:215]
ds_read_b64_tr_b16 a[212:213], v16 offset:0
v_mfma_f32_16x16x32_bf16 v[212:215], a[220:223], a[56:59], v[212:215]
ds_read_b128 a[12:15], v28 offset:6144
v_mfma_f32_16x16x32_bf16 v[204:207], a[216:219], a[36:39], v[204:207]
ds_read_b64_tr_b16 a[214:215], v16 offset:6144
v_mfma_f32_16x16x32_bf16 v[204:207], a[220:223], a[52:55], v[204:207]
v_mfma_f32_16x16x32_bf16 v[196:199], a[216:219], a[32:35], v[196:199]
ds_read_b64_tr_b16 a[216:217], v14 offset:24584
v_mfma_f32_16x16x32_bf16 v[196:199], a[220:223], a[48:51], v[196:199]
s_add_u32 m0, s90, 0
ds_read_b128 a[16:19], v29 offset:0
v_mfma_f32_16x16x32_bf16 v[224:227], a[224:227], a[32:35], v[224:227]
buffer_load_dwordx4 v23, s[16:19], s29 offen offset:0 nt lds
v_mfma_f32_16x16x32_bf16 v[224:227], a[228:231], a[48:51], v[224:227]
ds_read_b64_tr_b16 a[218:219], v14 offset:30728
v_mfma_f32_16x16x32_bf16 v[232:235], a[224:227], a[36:39], v[232:235]
ds_read_b64_tr_b16 a[220:221], v16 offset:8
v_mfma_f32_16x16x32_bf16 v[232:235], a[228:231], a[52:55], v[232:235]
buffer_load_dwordx4 v24, s[16:19], s29 offen offset:1024 nt lds
v_mfma_f32_16x16x32_bf16 v[240:243], a[224:227], a[40:43], v[240:243]
ds_read_b128 a[20:23], v29 offset:2048
v_mfma_f32_16x16x32_bf16 v[240:243], a[228:231], a[56:59], v[240:243]
ds_read_b64_tr_b16 a[222:223], v16 offset:6152
v_mfma_f32_16x16x32_bf16 v[248:251], a[224:227], a[44:47], v[248:251]
buffer_load_dwordx4 v25, s[16:19], s29 offen offset:2048 nt lds
s_add_u32 s29, s29, s38
v_mfma_f32_16x16x32_bf16 v[248:251], a[228:231], a[60:63], v[248:251]
ds_read_b64_tr_b16 a[224:225], v13 offset:24704
v_mfma_f32_16x16x32_bf16 v[252:255], a[232:235], a[44:47], v[252:255]
ds_read_b128 a[24:27], v29 offset:4096
v_mfma_f32_16x16x32_bf16 v[252:255], a[236:239], a[60:63], v[252:255]
ds_read_b64_tr_b16 a[226:227], v13 offset:30848
v_mfma_f32_16x16x32_bf16 v[244:247], a[232:235], a[40:43], v[244:247]
ds_read_b64_tr_b16 a[228:229], v15 offset:128
v_mfma_f32_16x16x32_bf16 v[244:247], a[236:239], a[56:59], v[244:247]
ds_read_b64_tr_b16 a[230:231], v15 offset:6272
v_mfma_f32_16x16x32_bf16 v[236:239], a[232:235], a[36:39], v[236:239]
ds_read_b128 a[28:31], v29 offset:6144
v_mfma_f32_16x16x32_bf16 v[236:239], a[236:239], a[52:55], v[236:239]
v_mfma_f32_16x16x32_bf16 v[228:231], a[232:235], a[32:35], v[228:231]
ds_read_b64_tr_b16 a[232:233], v13 offset:24712
v_mfma_f32_16x16x32_bf16 v[228:231], a[236:239], a[48:51], v[228:231]
s_waitcnt lgkmcnt(4)
ds_read_b64_tr_b16 a[234:235], v13 offset:30856
v_mfma_f32_16x16x32_bf16 v[64:67], a[192:195], a[0:3], v[64:67]
ds_read_b64_tr_b16 a[236:237], v15 offset:136
v_mfma_f32_16x16x32_bf16 v[64:67], a[196:199], a[16:19], v[64:67]
s_waitcnt lgkmcnt(3)
s_add_u32 m0, s39, 2048
s_add_u32 s30, s30, s57
ds_read_b64_tr_b16 a[238:239], v15 offset:6280
v_mfma_f32_16x16x32_bf16 v[72:75], a[192:195], a[4:7], v[72:75]
buffer_load_dwordx4 v26, s[4:7], s30 offen offset:0 lds
v_mfma_f32_16x16x32_bf16 v[72:75], a[196:199], a[20:23], v[72:75]
v_mfma_f32_16x16x32_bf16 v[80:83], a[192:195], a[8:11], v[80:83]
v_mfma_f32_16x16x32_bf16 v[80:83], a[196:199], a[24:27], v[80:83]
buffer_load_dwordx4 v27, s[4:7], s30 offen offset:1024 lds
v_mfma_f32_16x16x32_bf16 v[88:91], a[192:195], a[12:15], v[88:91]
ds_read_b64_tr_b16 a[192:193], v14 offset:24704
v_mfma_f32_16x16x32_bf16 v[88:91], a[196:199], a[28:31], v[88:91]
s_add_u32 m0, s39, 4096
s_add_u32 s31, s31, s57
ds_read_b64_tr_b16 a[194:195], v14 offset:30848
v_mfma_f32_16x16x32_bf16 v[92:95], a[200:203], a[12:15], v[92:95]
buffer_load_dwordx4 v26, s[4:7], s31 offen offset:0 lds
v_mfma_f32_16x16x32_bf16 v[92:95], a[204:207], a[28:31], v[92:95]
ds_read_b64_tr_b16 a[196:197], v16 offset:128
v_mfma_f32_16x16x32_bf16 v[84:87], a[200:203], a[8:11], v[84:87]
ds_read_b64_tr_b16 a[198:199], v16 offset:6272
v_mfma_f32_16x16x32_bf16 v[84:87], a[204:207], a[24:27], v[84:87]
buffer_load_dwordx4 v27, s[4:7], s31 offen offset:1024 lds
v_mfma_f32_16x16x32_bf16 v[76:79], a[200:203], a[4:7], v[76:79]
v_mfma_f32_16x16x32_bf16 v[76:79], a[204:207], a[20:23], v[76:79]
v_mfma_f32_16x16x32_bf16 v[68:71], a[200:203], a[0:3], v[68:71]
buffer_load_dword a255, v59, s[64:67], s89 offen
s_add_u32 s89, s89, 1920
v_mfma_f32_16x16x32_bf16 v[68:71], a[204:207], a[16:19], v[68:71]
ds_read_b64_tr_b16 a[200:201], v14 offset:24712
v_mfma_f32_16x16x32_bf16 v[96:99], a[208:211], a[0:3], v[96:99]
ds_read_b64_tr_b16 a[202:203], v14 offset:30856
v_mfma_f32_16x16x32_bf16 v[96:99], a[212:215], a[16:19], v[96:99]
ds_read_b64_tr_b16 a[204:205], v16 offset:136
v_mfma_f32_16x16x32_bf16 v[104:107], a[208:211], a[4:7], v[104:107]
ds_read_b64_tr_b16 a[206:207], v16 offset:6280
v_mfma_f32_16x16x32_bf16 v[104:107], a[212:215], a[20:23], v[104:107]
v_mfma_f32_16x16x32_bf16 v[112:115], a[208:211], a[8:11], v[112:115]
v_mfma_f32_16x16x32_bf16 v[112:115], a[212:215], a[24:27], v[112:115]
v_mfma_f32_16x16x32_bf16 v[120:123], a[208:211], a[12:15], v[120:123]
ds_read_b64_tr_b16 a[208:209], v13 offset:24832
v_mfma_f32_16x16x32_bf16 v[120:123], a[212:215], a[28:31], v[120:123]
s_add_u32 m0, s25, 12288
ds_read_b64_tr_b16 a[210:211], v13 offset:30976
v_mfma_f32_16x16x32_bf16 v[124:127], a[216:219], a[12:15], v[124:127]
buffer_load_dwordx4 v17, s[8:11], s27 offen offset:0 nt lds
v_mfma_f32_16x16x32_bf16 v[124:127], a[220:223], a[28:31], v[124:127]
ds_read_b64_tr_b16 a[212:213], v15 offset:256
v_mfma_f32_16x16x32_bf16 v[116:119], a[216:219], a[8:11], v[116:119]
ds_read_b64_tr_b16 a[214:215], v15 offset:6400
v_mfma_f32_16x16x32_bf16 v[116:119], a[220:223], a[24:27], v[116:119]
v_mfma_f32_16x16x32_bf16 v[108:111], a[216:219], a[4:7], v[108:111]
v_mfma_f32_16x16x32_bf16 v[108:111], a[220:223], a[20:23], v[108:111]
v_mfma_f32_16x16x32_bf16 v[100:103], a[216:219], a[0:3], v[100:103]
ds_read_b64_tr_b16 a[216:217], v13 offset:24840
v_mfma_f32_16x16x32_bf16 v[100:103], a[220:223], a[16:19], v[100:103]
ds_read_b64_tr_b16 a[218:219], v13 offset:30984
v_mfma_f32_16x16x32_bf16 v[128:131], a[224:227], a[0:3], v[128:131]
ds_read_b64_tr_b16 a[220:221], v15 offset:264
v_mfma_f32_16x16x32_bf16 v[128:131], a[228:231], a[16:19], v[128:131]
ds_read_b64_tr_b16 a[222:223], v15 offset:6408
v_mfma_f32_16x16x32_bf16 v[136:139], a[224:227], a[4:7], v[136:139]
v_mfma_f32_16x16x32_bf16 v[136:139], a[228:231], a[20:23], v[136:139]
s_add_u32 m0, s25, 12288
v_mfma_f32_16x16x32_bf16 v[144:147], a[224:227], a[8:11], v[144:147]
buffer_load_dwordx4 v18, s[8:11], s27 offen offset:1024 nt lds
v_mfma_f32_16x16x32_bf16 v[144:147], a[228:231], a[24:27], v[144:147]
v_mfma_f32_16x16x32_bf16 v[152:155], a[224:227], a[12:15], v[152:155]
ds_read_b64_tr_b16 a[224:225], v14 offset:24832
v_mfma_f32_16x16x32_bf16 v[152:155], a[228:231], a[28:31], v[152:155]
s_waitcnt lgkmcnt(1)
ds_read_b64_tr_b16 a[226:227], v14 offset:30976
v_mfma_f32_16x16x32_bf16 v[156:159], a[232:235], a[12:15], v[156:159]
ds_read_b64_tr_b16 a[228:229], v16 offset:256
v_mfma_f32_16x16x32_bf16 v[156:159], a[236:239], a[28:31], v[156:159]
ds_read_b64_tr_b16 a[230:231], v16 offset:6400
v_mfma_f32_16x16x32_bf16 v[148:151], a[232:235], a[8:11], v[148:151]
v_mfma_f32_16x16x32_bf16 v[148:151], a[236:239], a[24:27], v[148:151]
v_mfma_f32_16x16x32_bf16 v[140:143], a[232:235], a[4:7], v[140:143]
v_mfma_f32_16x16x32_bf16 v[140:143], a[236:239], a[20:23], v[140:143]
v_mfma_f32_16x16x32_bf16 v[132:135], a[232:235], a[0:3], v[132:135]
ds_read_b64_tr_b16 a[232:233], v14 offset:24840
v_mfma_f32_16x16x32_bf16 v[132:135], a[236:239], a[16:19], v[132:135]
ds_read_b64_tr_b16 a[234:235], v14 offset:30984
v_mfma_f32_16x16x32_bf16 v[160:163], a[192:195], a[0:3], v[160:163]
ds_read_b64_tr_b16 a[236:237], v16 offset:264
v_mfma_f32_16x16x32_bf16 v[160:163], a[196:199], a[16:19], v[160:163]
ds_read_b64_tr_b16 a[238:239], v16 offset:6408
v_mfma_f32_16x16x32_bf16 v[168:171], a[192:195], a[4:7], v[168:171]
v_mfma_f32_16x16x32_bf16 v[168:171], a[196:199], a[20:23], v[168:171]
v_mfma_f32_16x16x32_bf16 v[176:179], a[192:195], a[8:11], v[176:179]
v_mfma_f32_16x16x32_bf16 v[176:179], a[196:199], a[24:27], v[176:179]
s_waitcnt vmcnt(18) lgkmcnt(0)
v_mfma_f32_16x16x32_bf16 v[184:187], a[192:195], a[12:15], v[184:187]
s_barrier
v_mfma_f32_16x16x32_bf16 v[184:187], a[196:199], a[28:31], v[184:187]
ds_read_b64_tr_b16 a[192:193], v15 offset:12288
v_mfma_f32_16x16x32_bf16 v[188:191], a[200:203], a[12:15], v[188:191]
ds_read_b64_tr_b16 a[194:195], v15 offset:18432
v_mfma_f32_16x16x32_bf16 v[188:191], a[204:207], a[28:31], v[188:191]
ds_read_b64_tr_b16 a[196:197], v15 offset:24576
v_mfma_f32_16x16x32_bf16 v[180:183], a[200:203], a[8:11], v[180:183]
ds_read_b64_tr_b16 a[198:199], v15 offset:30720
v_mfma_f32_16x16x32_bf16 v[180:183], a[204:207], a[24:27], v[180:183]
s_add_u32 m0, s91, 12288
v_mfma_f32_16x16x32_bf16 v[172:175], a[200:203], a[4:7], v[172:175]
buffer_load_dwordx4 v23, s[16:19], s29 offen offset:0 nt lds
v_mfma_f32_16x16x32_bf16 v[172:175], a[204:207], a[20:23], v[172:175]
s_waitcnt vmcnt(11)
ds_read_b128 a[32:35], v28 offset:32768
v_mfma_f32_16x16x32_bf16 v[164:167], a[200:203], a[0:3], v[164:167]
ds_read_b64_tr_b16 a[200:201], v15 offset:12296
v_mfma_f32_16x16x32_bf16 v[164:167], a[204:207], a[16:19], v[164:167]
ds_read_b64_tr_b16 a[202:203], v15 offset:18440
v_mfma_f32_16x16x32_bf16 v[192:195], a[208:211], a[0:3], v[192:195]
ds_read_b64_tr_b16 a[204:205], v15 offset:24584
v_mfma_f32_16x16x32_bf16 v[192:195], a[212:215], a[16:19], v[192:195]
buffer_load_dwordx4 v24, s[16:19], s29 offen offset:1024 nt lds
v_mfma_f32_16x16x32_bf16 v[200:203], a[208:211], a[4:7], v[200:203]
ds_read_b128 a[36:39], v28 offset:34816
v_mfma_f32_16x16x32_bf16 v[200:203], a[212:215], a[20:23], v[200:203]
ds_read_b64_tr_b16 a[206:207], v15 offset:30728
v_mfma_f32_16x16x32_bf16 v[208:211], a[208:211], a[8:11], v[208:211]
v_mfma_f32_16x16x32_bf16 v[208:211], a[212:215], a[24:27], v[208:211]
v_mfma_f32_16x16x32_bf16 v[216:219], a[208:211], a[12:15], v[216:219]
buffer_load_dwordx4 v25, s[16:19], s29 offen offset:2048 nt lds
s_add_u32 s29, s29, s100
v_mfma_f32_16x16x32_bf16 v[216:219], a[212:215], a[28:31], v[216:219]
ds_read_b128 a[40:43], v28 offset:36864
v_mfma_f32_16x16x32_bf16 v[220:223], a[216:219], a[12:15], v[220:223]
ds_read_b64_tr_b16 a[208:209], v16 offset:12288
v_mfma_f32_16x16x32_bf16 v[220:223], a[220:223], a[28:31], v[220:223]
ds_read_b64_tr_b16 a[210:211], v16 offset:18432
v_mfma_f32_16x16x32_bf16 v[212:215], a[216:219], a[8:11], v[212:215]
s_add_u32 m0, s88, 6144
s_add_u32 s32, s32, s57
ds_read_b64_tr_b16 a[212:213], v16 offset:24576
v_mfma_f32_16x16x32_bf16 v[212:215], a[220:223], a[24:27], v[212:215]
buffer_load_dwordx4 v26, s[4:7], s32 offen offset:0 lds
v_mfma_f32_16x16x32_bf16 v[204:207], a[216:219], a[4:7], v[204:207]
ds_read_b128 a[44:47], v28 offset:38912
v_mfma_f32_16x16x32_bf16 v[204:207], a[220:223], a[20:23], v[204:207]
ds_read_b64_tr_b16 a[214:215], v16 offset:30720
v_mfma_f32_16x16x32_bf16 v[196:199], a[216:219], a[0:3], v[196:199]
ds_read_b64_tr_b16 a[216:217], v16 offset:12296
v_mfma_f32_16x16x32_bf16 v[196:199], a[220:223], a[16:19], v[196:199]
ds_read_b64_tr_b16 a[218:219], v16 offset:18440
v_mfma_f32_16x16x32_bf16 v[224:227], a[224:227], a[0:3], v[224:227]
buffer_load_dwordx4 v27, s[4:7], s32 offen offset:1024 lds
v_mfma_f32_16x16x32_bf16 v[224:227], a[228:231], a[16:19], v[224:227]
ds_read_b128 a[48:51], v29 offset:32768
v_mfma_f32_16x16x32_bf16 v[232:235], a[224:227], a[4:7], v[232:235]
ds_read_b64_tr_b16 a[220:221], v16 offset:24584
v_mfma_f32_16x16x32_bf16 v[232:235], a[228:231], a[20:23], v[232:235]
ds_read_b64_tr_b16 a[222:223], v16 offset:30728
v_mfma_f32_16x16x32_bf16 v[240:243], a[224:227], a[8:11], v[240:243]
s_add_u32 m0, s88, 8192
s_add_u32 s33, s33, s57
v_mfma_f32_16x16x32_bf16 v[240:243], a[228:231], a[24:27], v[240:243]
buffer_load_dwordx4 v26, s[4:7], s33 offen offset:0 lds
v_mfma_f32_16x16x32_bf16 v[248:251], a[224:227], a[12:15], v[248:251]
ds_read_b128 a[52:55], v29 offset:34816
v_mfma_f32_16x16x32_bf16 v[248:251], a[228:231], a[28:31], v[248:251]
ds_read_b64_tr_b16 a[224:225], v15 offset:12416
v_mfma_f32_16x16x32_bf16 v[252:255], a[232:235], a[12:15], v[252:255]
ds_read_b64_tr_b16 a[226:227], v15 offset:18560
v_mfma_f32_16x16x32_bf16 v[252:255], a[236:239], a[28:31], v[252:255]
ds_read_b64_tr_b16 a[228:229], v15 offset:24704
v_mfma_f32_16x16x32_bf16 v[244:247], a[232:235], a[8:11], v[244:247]
buffer_load_dwordx4 v27, s[4:7], s33 offen offset:1024 lds
v_mfma_f32_16x16x32_bf16 v[244:247], a[236:239], a[24:27], v[244:247]
ds_read_b128 a[56:59], v29 offset:36864
v_mfma_f32_16x16x32_bf16 v[236:239], a[232:235], a[4:7], v[236:239]
ds_read_b64_tr_b16 a[230:231], v15 offset:30848
v_mfma_f32_16x16x32_bf16 v[236:239], a[236:239], a[20:23], v[236:239]
v_mfma_f32_16x16x32_bf16 v[228:231], a[232:235], a[0:3], v[228:231]
ds_read_b64_tr_b16 a[232:233], v15 offset:12424
v_mfma_f32_16x16x32_bf16 v[228:231], a[236:239], a[16:19], v[228:231]
s_waitcnt lgkmcnt(3)
ds_read_b128 a[60:63], v29 offset:38912
v_mfma_f32_16x16x32_bf16 v[64:67], a[192:195], a[32:35], v[64:67]
ds_read_b64_tr_b16 a[234:235], v15 offset:18568
v_mfma_f32_16x16x32_bf16 v[64:67], a[196:199], a[48:51], v[64:67]
s_add_u32 m0, s90, 24576
ds_read_b64_tr_b16 a[236:237], v15 offset:24712
v_mfma_f32_16x16x32_bf16 v[72:75], a[192:195], a[36:39], v[72:75]
buffer_load_dwordx4 v23, s[16:19], s29 offen offset:0 nt lds
v_mfma_f32_16x16x32_bf16 v[72:75], a[196:199], a[52:55], v[72:75]
ds_read_b64_tr_b16 a[238:239], v15 offset:30856
v_mfma_f32_16x16x32_bf16 v[80:83], a[192:195], a[40:43], v[80:83]
s_waitcnt lgkmcnt(4)
v_mfma_f32_16x16x32_bf16 v[80:83], a[196:199], a[56:59], v[80:83]
v_mfma_f32_16x16x32_bf16 v[88:91], a[192:195], a[44:47], v[88:91]
s_waitcnt lgkmcnt(2)
ds_read_b64_tr_b16 a[192:193], v16 offset:12416
v_mfma_f32_16x16x32_bf16 v[88:91], a[196:199], a[60:63], v[88:91]
buffer_load_dwordx4 v24, s[16:19], s29 offen offset:1024 nt lds
v_mfma_f32_16x16x32_bf16 v[92:95], a[200:203], a[44:47], v[92:95]
ds_read_b64_tr_b16 a[194:195], v16 offset:18560
v_mfma_f32_16x16x32_bf16 v[92:95], a[204:207], a[60:63], v[92:95]
ds_read_b64_tr_b16 a[196:197], v16 offset:24704
v_mfma_f32_16x16x32_bf16 v[84:87], a[200:203], a[40:43], v[84:87]
ds_read_b64_tr_b16 a[198:199], v16 offset:30848
v_mfma_f32_16x16x32_bf16 v[84:87], a[204:207], a[56:59], v[84:87]
v_mfma_f32_16x16x32_bf16 v[76:79], a[200:203], a[36:39], v[76:79]
buffer_load_dwordx4 v25, s[16:19], s29 offen offset:2048 nt lds
s_add_u32 s29, s29, s38
v_mfma_f32_16x16x32_bf16 v[76:79], a[204:207], a[52:55], v[76:79]
v_mfma_f32_16x16x32_bf16 v[68:71], a[200:203], a[32:35], v[68:71]
ds_read_b64_tr_b16 a[200:201], v16 offset:12424
v_mfma_f32_16x16x32_bf16 v[68:71], a[204:207], a[48:51], v[68:71]
ds_read_b64_tr_b16 a[202:203], v16 offset:18568
v_mfma_f32_16x16x32_bf16 v[96:99], a[208:211], a[32:35], v[96:99]
s_add_u32 m0, s91, 36864
ds_read_b64_tr_b16 a[204:205], v16 offset:24712
v_mfma_f32_16x16x32_bf16 v[96:99], a[212:215], a[48:51], v[96:99]
buffer_load_dwordx4 v23, s[16:19], s29 offen offset:0 nt lds
v_mfma_f32_16x16x32_bf16 v[104:107], a[208:211], a[36:39], v[104:107]
ds_read_b64_tr_b16 a[206:207], v16 offset:30856
v_mfma_f32_16x16x32_bf16 v[104:107], a[212:215], a[52:55], v[104:107]
v_mfma_f32_16x16x32_bf16 v[112:115], a[208:211], a[40:43], v[112:115]
v_mfma_f32_16x16x32_bf16 v[112:115], a[212:215], a[56:59], v[112:115]
v_mfma_f32_16x16x32_bf16 v[120:123], a[208:211], a[44:47], v[120:123]
buffer_load_dwordx4 v24, s[16:19], s29 offen offset:1024 nt lds
v_mfma_f32_16x16x32_bf16 v[120:123], a[212:215], a[60:63], v[120:123]
ds_read_b64_tr_b16 a[208:209], v15 offset:12544
v_mfma_f32_16x16x32_bf16 v[124:127], a[216:219], a[44:47], v[124:127]
ds_read_b64_tr_b16 a[210:211], v15 offset:18688
v_mfma_f32_16x16x32_bf16 v[124:127], a[220:223], a[60:63], v[124:127]
ds_read_b64_tr_b16 a[212:213], v15 offset:24832
v_mfma_f32_16x16x32_bf16 v[116:119], a[216:219], a[40:43], v[116:119]
ds_read_b64_tr_b16 a[214:215], v15 offset:30976
v_mfma_f32_16x16x32_bf16 v[116:119], a[220:223], a[56:59], v[116:119]
buffer_load_dwordx4 v25, s[16:19], s29 offen offset:2048 nt lds
s_add_u32 s29, s29, s101
v_mfma_f32_16x16x32_bf16 v[108:111], a[216:219], a[36:39], v[108:111]
v_mfma_f32_16x16x32_bf16 v[108:111], a[220:223], a[52:55], v[108:111]
v_mfma_f32_16x16x32_bf16 v[100:103], a[216:219], a[32:35], v[100:103]
ds_read_b64_tr_b16 a[216:217], v15 offset:12552
v_mfma_f32_16x16x32_bf16 v[100:103], a[220:223], a[48:51], v[100:103]
s_add_u32 m0, s39, 34816
s_add_u32 s30, s30, s56
ds_read_b64_tr_b16 a[218:219], v15 offset:18696
v_mfma_f32_16x16x32_bf16 v[128:131], a[224:227], a[32:35], v[128:131]
buffer_load_dwordx4 v26, s[4:7], s30 offen offset:0 lds
v_mfma_f32_16x16x32_bf16 v[128:131], a[228:231], a[48:51], v[128:131]
ds_read_b64_tr_b16 a[220:221], v15 offset:24840
v_mfma_f32_16x16x32_bf16 v[136:139], a[224:227], a[36:39], v[136:139]
ds_read_b64_tr_b16 a[222:223], v15 offset:30984
v_mfma_f32_16x16x32_bf16 v[136:139], a[228:231], a[52:55], v[136:139]
v_mfma_f32_16x16x32_bf16 v[144:147], a[224:227], a[40:43], v[144:147]
v_mfma_f32_16x16x32_bf16 v[144:147], a[228:231], a[56:59], v[144:147]
buffer_load_dwordx4 v27, s[4:7], s30 offen offset:1024 lds
v_mfma_f32_16x16x32_bf16 v[152:155], a[224:227], a[44:47], v[152:155]
ds_read_b64_tr_b16 a[224:225], v16 offset:12544
v_mfma_f32_16x16x32_bf16 v[152:155], a[228:231], a[60:63], v[152:155]
ds_read_b64_tr_b16 a[226:227], v16 offset:18688
v_mfma_f32_16x16x32_bf16 v[156:159], a[232:235], a[44:47], v[156:159]
s_waitcnt lgkmcnt(2)
ds_read_b64_tr_b16 a[228:229], v16 offset:24832
v_mfma_f32_16x16x32_bf16 v[156:159], a[236:239], a[60:63], v[156:159]
s_add_u32 m0, s39, 36864
s_add_u32 s31, s31, s56
ds_read_b64_tr_b16 a[230:231], v16 offset:30976
v_mfma_f32_16x16x32_bf16 v[148:151], a[232:235], a[40:43], v[148:151]
buffer_load_dwordx4 v26, s[4:7], s31 offen offset:0 lds
v_mfma_f32_16x16x32_bf16 v[148:151], a[236:239], a[56:59], v[148:151]
v_mfma_f32_16x16x32_bf16 v[140:143], a[232:235], a[36:39], v[140:143]
v_mfma_f32_16x16x32_bf16 v[140:143], a[236:239], a[52:55], v[140:143]
v_mfma_f32_16x16x32_bf16 v[132:135], a[232:235], a[32:35], v[132:135]
ds_read_b64_tr_b16 a[232:233], v16 offset:12552
v_mfma_f32_16x16x32_bf16 v[132:135], a[236:239], a[48:51], v[132:135]
buffer_load_dwordx4 v27, s[4:7], s31 offen offset:1024 lds
v_mfma_f32_16x16x32_bf16 v[160:163], a[192:195], a[32:35], v[160:163]
ds_read_b64_tr_b16 a[234:235], v16 offset:18696
v_mfma_f32_16x16x32_bf16 v[160:163], a[196:199], a[48:51], v[160:163]
ds_read_b64_tr_b16 a[236:237], v16 offset:24840
v_mfma_f32_16x16x32_bf16 v[168:171], a[192:195], a[36:39], v[168:171]
ds_read_b64_tr_b16 a[238:239], v16 offset:30984
v_mfma_f32_16x16x32_bf16 v[168:171], a[196:199], a[52:55], v[168:171]
v_mfma_f32_16x16x32_bf16 v[176:179], a[192:195], a[40:43], v[176:179]
v_mfma_f32_16x16x32_bf16 v[176:179], a[196:199], a[56:59], v[176:179]
s_waitcnt vmcnt(14) lgkmcnt(0)
v_mfma_f32_16x16x32_bf16 v[184:187], a[192:195], a[44:47], v[184:187]
s_barrier
s_add_u32 m0, s88, 38912
s_add_u32 s32, s32, s56
v_mfma_f32_16x16x32_bf16 v[184:187], a[196:199], a[60:63], v[184:187]
buffer_load_dwordx4 v26, s[4:7], s32 offen offset:0 lds
v_mfma_f32_16x16x32_bf16 v[188:191], a[200:203], a[44:47], v[188:191]
ds_read_b64_tr_b16 a[192:193], v13 offset:0
v_mfma_f32_16x16x32_bf16 v[188:191], a[204:207], a[60:63], v[188:191]
ds_read_b64_tr_b16 a[194:195], v13 offset:6144
v_mfma_f32_16x16x32_bf16 v[180:183], a[200:203], a[40:43], v[180:183]
ds_read_b64_tr_b16 a[196:197], v13 offset:12288
v_mfma_f32_16x16x32_bf16 v[180:183], a[204:207], a[56:59], v[180:183]
ds_read_b64_tr_b16 a[198:199], v13 offset:18432
v_mfma_f32_16x16x32_bf16 v[172:175], a[200:203], a[36:39], v[172:175]
buffer_load_dwordx4 v27, s[4:7], s32 offen offset:1024 lds
v_mfma_f32_16x16x32_bf16 v[172:175], a[204:207], a[52:55], v[172:175]
s_waitcnt vmcnt(12)
ds_read_b128 a[0:3], v28 offset:0
v_mfma_f32_16x16x32_bf16 v[164:167], a[200:203], a[32:35], v[164:167]
ds_read_b64_tr_b16 a[200:201], v13 offset:8
v_mfma_f32_16x16x32_bf16 v[164:167], a[204:207], a[48:51], v[164:167]
ds_read_b64_tr_b16 a[202:203], v13 offset:6152
v_mfma_f32_16x16x32_bf16 v[192:195], a[208:211], a[32:35], v[192:195]
s_add_u32 m0, s88, 40960
s_add_u32 s33, s33, s56
ds_read_b64_tr_b16 a[204:205], v13 offset:12296
v_mfma_f32_16x16x32_bf16 v[192:195], a[212:215], a[48:51], v[192:195]
buffer_load_dwordx4 v26, s[4:7], s33 offen offset:0 lds
v_mfma_f32_16x16x32_bf16 v[200:203], a[208:211], a[36:39], v[200:203]
ds_read_b128 a[4:7], v28 offset:2048
v_mfma_f32_16x16x32_bf16 v[200:203], a[212:215], a[52:55], v[200:203]
ds_read_b64_tr_b16 a[206:207], v13 offset:18440
v_mfma_f32_16x16x32_bf16 v[208:211], a[208:211], a[40:43], v[208:211]
v_mfma_f32_16x16x32_bf16 v[208:211], a[212:215], a[56:59], v[208:211]
v_mfma_f32_16x16x32_bf16 v[216:219], a[208:211], a[44:47], v[216:219]
buffer_load_dwordx4 v27, s[4:7], s33 offen offset:1024 lds
v_mfma_f32_16x16x32_bf16 v[216:219], a[212:215], a[60:63], v[216:219]
ds_read_b128 a[8:11], v28 offset:4096
v_mfma_f32_16x16x32_bf16 v[220:223], a[216:219], a[44:47], v[220:223]
ds_read_b64_tr_b16 a[208:209], v14 offset:0
v_mfma_f32_16x16x32_bf16 v[220:223], a[220:223], a[60:63], v[220:223]
ds_read_b64_tr_b16 a[210:211], v14 offset:6144
v_mfma_f32_16x16x32_bf16 v[212:215], a[216:219], a[40:43], v[212:215]
ds_read_b64_tr_b16 a[212:213], v14 offset:12288
v_mfma_f32_16x16x32_bf16 v[212:215], a[220:223], a[56:59], v[212:215]
ds_read_b128 a[12:15], v28 offset:6144
v_mfma_f32_16x16x32_bf16 v[204:207], a[216:219], a[36:39], v[204:207]
ds_read_b64_tr_b16 a[214:215], v14 offset:18432
v_mfma_f32_16x16x32_bf16 v[204:207], a[220:223], a[52:55], v[204:207]
v_mfma_f32_16x16x32_bf16 v[196:199], a[216:219], a[32:35], v[196:199]
ds_read_b64_tr_b16 a[216:217], v14 offset:8
v_mfma_f32_16x16x32_bf16 v[196:199], a[220:223], a[48:51], v[196:199]
s_add_u32 m0, s90, 49152
ds_read_b128 a[16:19], v29 offset:0
v_mfma_f32_16x16x32_bf16 v[224:227], a[224:227], a[32:35], v[224:227]
buffer_load_dwordx4 v23, s[16:19], s29 offen offset:0 nt lds
v_mfma_f32_16x16x32_bf16 v[224:227], a[228:231], a[48:51], v[224:227]
ds_read_b64_tr_b16 a[218:219], v14 offset:6152
v_mfma_f32_16x16x32_bf16 v[232:235], a[224:227], a[36:39], v[232:235]
ds_read_b64_tr_b16 a[220:221], v14 offset:12296
v_mfma_f32_16x16x32_bf16 v[232:235], a[228:231], a[52:55], v[232:235]
buffer_load_dwordx4 v24, s[16:19], s29 offen offset:1024 nt lds
v_mfma_f32_16x16x32_bf16 v[240:243], a[224:227], a[40:43], v[240:243]
ds_read_b128 a[20:23], v29 offset:2048
v_mfma_f32_16x16x32_bf16 v[240:243], a[228:231], a[56:59], v[240:243]
ds_read_b64_tr_b16 a[222:223], v14 offset:18440
v_mfma_f32_16x16x32_bf16 v[248:251], a[224:227], a[44:47], v[248:251]
buffer_load_dwordx4 v25, s[16:19], s29 offen offset:2048 nt lds
s_add_u32 s29, s29, s38
v_mfma_f32_16x16x32_bf16 v[248:251], a[228:231], a[60:63], v[248:251]
ds_read_b64_tr_b16 a[224:225], v13 offset:128
v_mfma_f32_16x16x32_bf16 v[252:255], a[232:235], a[44:47], v[252:255]
ds_read_b128 a[24:27], v29 offset:4096
v_mfma_f32_16x16x32_bf16 v[252:255], a[236:239], a[60:63], v[252:255]
ds_read_b64_tr_b16 a[226:227], v13 offset:6272
v_mfma_f32_16x16x32_bf16 v[244:247], a[232:235], a[40:43], v[244:247]
ds_read_b64_tr_b16 a[228:229], v13 offset:12416
v_mfma_f32_16x16x32_bf16 v[244:247], a[236:239], a[56:59], v[244:247]
ds_read_b64_tr_b16 a[230:231], v13 offset:18560
v_mfma_f32_16x16x32_bf16 v[236:239], a[232:235], a[36:39], v[236:239]
ds_read_b128 a[28:31], v29 offset:6144
v_mfma_f32_16x16x32_bf16 v[236:239], a[236:239], a[52:55], v[236:239]
v_mfma_f32_16x16x32_bf16 v[228:231], a[232:235], a[32:35], v[228:231]
ds_read_b64_tr_b16 a[232:233], v13 offset:136
v_mfma_f32_16x16x32_bf16 v[228:231], a[236:239], a[48:51], v[228:231]
s_waitcnt lgkmcnt(4)
ds_read_b64_tr_b16 a[234:235], v13 offset:6280
v_mfma_f32_16x16x32_bf16 v[64:67], a[192:195], a[0:3], v[64:67]
ds_read_b64_tr_b16 a[236:237], v13 offset:12424
v_mfma_f32_16x16x32_bf16 v[64:67], a[196:199], a[16:19], v[64:67]
s_waitcnt lgkmcnt(3)
s_add_u32 m0, s39, 2048
s_add_u32 s30, s30, s57
ds_read_b64_tr_b16 a[238:239], v13 offset:18568
v_mfma_f32_16x16x32_bf16 v[72:75], a[192:195], a[4:7], v[72:75]
buffer_load_dwordx4 v26, s[4:7], s30 offen offset:0 lds
v_mfma_f32_16x16x32_bf16 v[72:75], a[196:199], a[20:23], v[72:75]
v_mfma_f32_16x16x32_bf16 v[80:83], a[192:195], a[8:11], v[80:83]
v_mfma_f32_16x16x32_bf16 v[80:83], a[196:199], a[24:27], v[80:83]
buffer_load_dwordx4 v27, s[4:7], s30 offen offset:1024 lds
v_mfma_f32_16x16x32_bf16 v[88:91], a[192:195], a[12:15], v[88:91]
ds_read_b64_tr_b16 a[192:193], v14 offset:128
v_mfma_f32_16x16x32_bf16 v[88:91], a[196:199], a[28:31], v[88:91]
s_add_u32 m0, s39, 4096
s_add_u32 s31, s31, s57
ds_read_b64_tr_b16 a[194:195], v14 offset:6272
v_mfma_f32_16x16x32_bf16 v[92:95], a[200:203], a[12:15], v[92:95]
buffer_load_dwordx4 v26, s[4:7], s31 offen offset:0 lds
v_mfma_f32_16x16x32_bf16 v[92:95], a[204:207], a[28:31], v[92:95]
ds_read_b64_tr_b16 a[196:197], v14 offset:12416
v_mfma_f32_16x16x32_bf16 v[84:87], a[200:203], a[8:11], v[84:87]
ds_read_b64_tr_b16 a[198:199], v14 offset:18560
v_mfma_f32_16x16x32_bf16 v[84:87], a[204:207], a[24:27], v[84:87]
buffer_load_dwordx4 v27, s[4:7], s31 offen offset:1024 lds
v_mfma_f32_16x16x32_bf16 v[76:79], a[200:203], a[4:7], v[76:79]
v_mfma_f32_16x16x32_bf16 v[76:79], a[204:207], a[20:23], v[76:79]
v_mfma_f32_16x16x32_bf16 v[68:71], a[200:203], a[0:3], v[68:71]
buffer_load_dword a255, v59, s[64:67], s89 offen
s_add_u32 s89, s89, 1920
v_mfma_f32_16x16x32_bf16 v[68:71], a[204:207], a[16:19], v[68:71]
ds_read_b64_tr_b16 a[200:201], v14 offset:136
v_mfma_f32_16x16x32_bf16 v[96:99], a[208:211], a[0:3], v[96:99]
ds_read_b64_tr_b16 a[202:203], v14 offset:6280
v_mfma_f32_16x16x32_bf16 v[96:99], a[212:215], a[16:19], v[96:99]
ds_read_b64_tr_b16 a[204:205], v14 offset:12424
v_mfma_f32_16x16x32_bf16 v[104:107], a[208:211], a[4:7], v[104:107]
ds_read_b64_tr_b16 a[206:207], v14 offset:18568
v_mfma_f32_16x16x32_bf16 v[104:107], a[212:215], a[20:23], v[104:107]
v_mfma_f32_16x16x32_bf16 v[112:115], a[208:211], a[8:11], v[112:115]
v_mov_b32 v54, 1
v_and_b32 v55, -16, v30
v_mfma_f32_16x16x32_bf16 v[112:115], a[212:215], a[24:27], v[112:115]
v_mfma_f32_16x16x32_bf16 v[120:123], a[208:211], a[12:15], v[120:123]
buffer_atomic_add v54, v55, s[76:79], 0 offen sc1
v_mfma_f32_16x16x32_bf16 v[120:123], a[212:215], a[28:31], v[120:123]
s_add_u32 m0, s25, 12288
ds_read_b64_tr_b16 a[208:209], v13 offset:256
v_mfma_f32_16x16x32_bf16 v[124:127], a[216:219], a[12:15], v[124:127]
buffer_load_dwordx4 v19, s[8:11], s27 offen offset:2048 nt lds
s_add_u32 s27, s27, 12288
v_mfma_f32_16x16x32_bf16 v[124:127], a[220:223], a[28:31], v[124:127]
ds_read_b64_tr_b16 a[210:211], v13 offset:6400
v_mfma_f32_16x16x32_bf16 v[116:119], a[216:219], a[8:11], v[116:119]
ds_read_b64_tr_b16 a[212:213], v13 offset:12544
v_mfma_f32_16x16x32_bf16 v[116:119], a[220:223], a[24:27], v[116:119]
ds_read_b64_tr_b16 a[214:215], v13 offset:18688
v_mfma_f32_16x16x32_bf16 v[108:111], a[216:219], a[4:7], v[108:111]
v_mfma_f32_16x16x32_bf16 v[108:111], a[220:223], a[20:23], v[108:111]
v_mfma_f32_16x16x32_bf16 v[100:103], a[216:219], a[0:3], v[100:103]
ds_read_b64_tr_b16 a[216:217], v13 offset:264
v_mfma_f32_16x16x32_bf16 v[100:103], a[220:223], a[16:19], v[100:103]
ds_read_b64_tr_b16 a[218:219], v13 offset:6408
v_mfma_f32_16x16x32_bf16 v[128:131], a[224:227], a[0:3], v[128:131]
ds_read_b64_tr_b16 a[220:221], v13 offset:12552
v_mfma_f32_16x16x32_bf16 v[128:131], a[228:231], a[16:19], v[128:131]
ds_read_b64_tr_b16 a[222:223], v13 offset:18696
v_mfma_f32_16x16x32_bf16 v[136:139], a[224:227], a[4:7], v[136:139]
v_mfma_f32_16x16x32_bf16 v[136:139], a[228:231], a[20:23], v[136:139]
v_mfma_f32_16x16x32_bf16 v[144:147], a[224:227], a[8:11], v[144:147]
v_mfma_f32_16x16x32_bf16 v[144:147], a[228:231], a[24:27], v[144:147]
v_mfma_f32_16x16x32_bf16 v[152:155], a[224:227], a[12:15], v[152:155]
ds_read_b64_tr_b16 a[224:225], v14 offset:256
v_mfma_f32_16x16x32_bf16 v[152:155], a[228:231], a[28:31], v[152:155]
s_waitcnt lgkmcnt(1)
ds_read_b64_tr_b16 a[226:227], v14 offset:6400
v_mfma_f32_16x16x32_bf16 v[156:159], a[232:235], a[12:15], v[156:159]
ds_read_b64_tr_b16 a[228:229], v14 offset:12544
v_mfma_f32_16x16x32_bf16 v[156:159], a[236:239], a[28:31], v[156:159]
ds_read_b64_tr_b16 a[230:231], v14 offset:18688
v_mfma_f32_16x16x32_bf16 v[148:151], a[232:235], a[8:11], v[148:151]
v_mfma_f32_16x16x32_bf16 v[148:151], a[236:239], a[24:27], v[148:151]
v_mfma_f32_16x16x32_bf16 v[140:143], a[232:235], a[4:7], v[140:143]
v_mfma_f32_16x16x32_bf16 v[140:143], a[236:239], a[20:23], v[140:143]
v_mfma_f32_16x16x32_bf16 v[132:135], a[232:235], a[0:3], v[132:135]
ds_read_b64_tr_b16 a[232:233], v14 offset:264
v_mfma_f32_16x16x32_bf16 v[132:135], a[236:239], a[16:19], v[132:135]
ds_read_b64_tr_b16 a[234:235], v14 offset:6408
v_mfma_f32_16x16x32_bf16 v[160:163], a[192:195], a[0:3], v[160:163]
ds_read_b64_tr_b16 a[236:237], v14 offset:12552
v_mfma_f32_16x16x32_bf16 v[160:163], a[196:199], a[16:19], v[160:163]
ds_read_b64_tr_b16 a[238:239], v14 offset:18696
v_mfma_f32_16x16x32_bf16 v[168:171], a[192:195], a[4:7], v[168:171]
v_mfma_f32_16x16x32_bf16 v[168:171], a[196:199], a[20:23], v[168:171]
v_mfma_f32_16x16x32_bf16 v[176:179], a[192:195], a[8:11], v[176:179]
v_mfma_f32_16x16x32_bf16 v[176:179], a[196:199], a[24:27], v[176:179]
s_waitcnt vmcnt(18) lgkmcnt(0)
v_mfma_f32_16x16x32_bf16 v[184:187], a[192:195], a[12:15], v[184:187]
s_barrier
v_mfma_f32_16x16x32_bf16 v[184:187], a[196:199], a[28:31], v[184:187]
ds_read_b64_tr_b16 a[192:193], v13 offset:24576
v_mfma_f32_16x16x32_bf16 v[188:191], a[200:203], a[12:15], v[188:191]
ds_read_b64_tr_b16 a[194:195], v13 offset:30720
v_mfma_f32_16x16x32_bf16 v[188:191], a[204:207], a[28:31], v[188:191]
ds_read_b64_tr_b16 a[196:197], v15 offset:0
v_mfma_f32_16x16x32_bf16 v[180:183], a[200:203], a[8:11], v[180:183]
ds_read_b64_tr_b16 a[198:199], v15 offset:6144
v_mfma_f32_16x16x32_bf16 v[180:183], a[204:207], a[24:27], v[180:183]
s_add_u32 m0, s91, 61440
v_mfma_f32_16x16x32_bf16 v[172:175], a[200:203], a[4:7], v[172:175]
buffer_load_dwordx4 v23, s[16:19], s29 offen offset:0 nt lds
v_mfma_f32_16x16x32_bf16 v[172:175], a[204:207], a[20:23], v[172:175]
s_waitcnt vmcnt(11)
ds_read_b128 a[32:35], v28 offset:32768
v_mfma_f32_16x16x32_bf16 v[164:167], a[200:203], a[0:3], v[164:167]
ds_read_b64_tr_b16 a[200:201], v13 offset:24584
v_mfma_f32_16x16x32_bf16 v[164:167], a[204:207], a[16:19], v[164:167]
ds_read_b64_tr_b16 a[202:203], v13 offset:30728
v_mfma_f32_16x16x32_bf16 v[192:195], a[208:211], a[0:3], v[192:195]
ds_read_b64_tr_b16 a[204:205], v15 offset:8
v_mfma_f32_16x16x32_bf16 v[192:195], a[212:215], a[16:19], v[192:195]
buffer_load_dwordx4 v24, s[16:19], s29 offen offset:1024 nt lds
v_mfma_f32_16x16x32_bf16 v[200:203], a[208:211], a[4:7], v[200:203]
ds_read_b128 a[36:39], v28 offset:34816
v_mfma_f32_16x16x32_bf16 v[200:203], a[212:215], a[20:23], v[200:203]
ds_read_b64_tr_b16 a[206:207], v15 offset:6152
v_mfma_f32_16x16x32_bf16 v[208:211], a[208:211], a[8:11], v[208:211]
v_mfma_f32_16x16x32_bf16 v[208:211], a[212:215], a[24:27], v[208:211]
v_mfma_f32_16x16x32_bf16 v[216:219], a[208:211], a[12:15], v[216:219]
buffer_load_dwordx4 v25, s[16:19], s29 offen offset:2048 nt lds
s_add_u32 s29, s29, s100
v_mfma_f32_16x16x32_bf16 v[216:219], a[212:215], a[28:31], v[216:219]
ds_read_b128 a[40:43], v28 offset:36864
v_mfma_f32_16x16x32_bf16 v[220:223], a[216:219], a[12:15], v[220:223]
ds_read_b64_tr_b16 a[208:209], v14 offset:24576
v_mfma_f32_16x16x32_bf16 v[220:223], a[220:223], a[28:31], v[220:223]
ds_read_b64_tr_b16 a[210:211], v14 offset:30720
v_mfma_f32_16x16x32_bf16 v[212:215], a[216:219], a[8:11], v[212:215]
s_add_u32 m0, s88, 6144
s_add_u32 s32, s32, s57
ds_read_b64_tr_b16 a[212:213], v16 offset:0
v_mfma_f32_16x16x32_bf16 v[212:215], a[220:223], a[24:27], v[212:215]
buffer_load_dwordx4 v26, s[4:7], s32 offen offset:0 lds
v_mfma_f32_16x16x32_bf16 v[204:207], a[216:219], a[4:7], v[204:207]
ds_read_b128 a[44:47], v28 offset:38912
v_mfma_f32_16x16x32_bf16 v[204:207], a[220:223], a[20:23], v[204:207]
ds_read_b64_tr_b16 a[214:215], v16 offset:6144
v_mfma_f32_16x16x32_bf16 v[196:199], a[216:219], a[0:3], v[196:199]
ds_read_b64_tr_b16 a[216:217], v14 offset:24584
v_mfma_f32_16x16x32_bf16 v[196:199], a[220:223], a[16:19], v[196:199]
ds_read_b64_tr_b16 a[218:219], v14 offset:30728
v_mfma_f32_16x16x32_bf16 v[224:227], a[224:227], a[0:3], v[224:227]
buffer_load_dwordx4 v27, s[4:7], s32 offen offset:1024 lds
v_mfma_f32_16x16x32_bf16 v[224:227], a[228:231], a[16:19], v[224:227]
ds_read_b128 a[48:51], v29 offset:32768
v_mfma_f32_16x16x32_bf16 v[232:235], a[224:227], a[4:7], v[232:235]
ds_read_b64_tr_b16 a[220:221], v16 offset:8
v_mfma_f32_16x16x32_bf16 v[232:235], a[228:231], a[20:23], v[232:235]
ds_read_b64_tr_b16 a[222:223], v16 offset:6152
v_mfma_f32_16x16x32_bf16 v[240:243], a[224:227], a[8:11], v[240:243]
s_add_u32 m0, s88, 8192
s_add_u32 s33, s33, s57
v_mfma_f32_16x16x32_bf16 v[240:243], a[228:231], a[24:27], v[240:243]
buffer_load_dwordx4 v26, s[4:7], s33 offen offset:0 lds
v_mfma_f32_16x16x32_bf16 v[248:251], a[224:227], a[12:15], v[248:251]
ds_read_b128 a[52:55], v29 offset:34816
v_mfma_f32_16x16x32_bf16 v[248:251], a[228:231], a[28:31], v[248:251]
ds_read_b64_tr_b16 a[224:225], v13 offset:24704
v_mfma_f32_16x16x32_bf16 v[252:255], a[232:235], a[12:15], v[252:255]
ds_read_b64_tr_b16 a[226:227], v13 offset:30848
v_mfma_f32_16x16x32_bf16 v[252:255], a[236:239], a[28:31], v[252:255]
ds_read_b64_tr_b16 a[228:229], v15 offset:128
v_mfma_f32_16x16x32_bf16 v[244:247], a[232:235], a[8:11], v[244:247]
buffer_load_dwordx4 v27, s[4:7], s33 offen offset:1024 lds
v_mfma_f32_16x16x32_bf16 v[244:247], a[236:239], a[24:27], v[244:247]
ds_read_b128 a[56:59], v29 offset:36864
v_mfma_f32_16x16x32_bf16 v[236:239], a[232:235], a[4:7], v[236:239]
ds_read_b64_tr_b16 a[230:231], v15 offset:6272
v_mfma_f32_16x16x32_bf16 v[236:239], a[236:239], a[20:23], v[236:239]
v_mfma_f32_16x16x32_bf16 v[228:231], a[232:235], a[0:3], v[228:231]
ds_read_b64_tr_b16 a[232:233], v13 offset:24712
v_mfma_f32_16x16x32_bf16 v[228:231], a[236:239], a[16:19], v[228:231]
s_waitcnt lgkmcnt(3)
ds_read_b128 a[60:63], v29 offset:38912
v_mfma_f32_16x16x32_bf16 v[64:67], a[192:195], a[32:35], v[64:67]
ds_read_b64_tr_b16 a[234:235], v13 offset:30856
v_mfma_f32_16x16x32_bf16 v[64:67], a[196:199], a[48:51], v[64:67]
s_add_u32 m0, s90, 0
ds_read_b64_tr_b16 a[236:237], v15 offset:136
v_mfma_f32_16x16x32_bf16 v[72:75], a[192:195], a[36:39], v[72:75]
buffer_load_dwordx4 v23, s[16:19], s29 offen offset:0 nt lds
v_mfma_f32_16x16x32_bf16 v[72:75], a[196:199], a[52:55], v[72:75]
ds_read_b64_tr_b16 a[238:239], v15 offset:6280
v_mfma_f32_16x16x32_bf16 v[80:83], a[192:195], a[40:43], v[80:83]
s_waitcnt lgkmcnt(4)
v_mfma_f32_16x16x32_bf16 v[80:83], a[196:199], a[56:59], v[80:83]
buffer_load_dwordx4 v24, s[16:19], s29 offen offset:1024 nt lds
v_mfma_f32_16x16x32_bf16 v[88:91], a[192:195], a[44:47], v[88:91]
s_waitcnt lgkmcnt(2)
ds_read_b64_tr_b16 a[192:193], v14 offset:24704
v_mfma_f32_16x16x32_bf16 v[88:91], a[196:199], a[60:63], v[88:91]
ds_read_b64_tr_b16 a[194:195], v14 offset:30848
v_mfma_f32_16x16x32_bf16 v[92:95], a[200:203], a[44:47], v[92:95]
buffer_load_dwordx4 v25, s[16:19], s29 offen offset:2048 nt lds
s_add_u32 s29, s29, s38
v_mfma_f32_16x16x32_bf16 v[92:95], a[204:207], a[60:63], v[92:95]
ds_read_b64_tr_b16 a[196:197], v16 offset:128
v_mfma_f32_16x16x32_bf16 v[84:87], a[200:203], a[40:43], v[84:87]
s_add_u32 m0, s91, 12288
ds_read_b64_tr_b16 a[198:199], v16 offset:6272
v_mfma_f32_16x16x32_bf16 v[84:87], a[204:207], a[56:59], v[84:87]
buffer_load_dwordx4 v23, s[16:19], s29 offen offset:0 nt lds
v_mfma_f32_16x16x32_bf16 v[76:79], a[200:203], a[36:39], v[76:79]
v_mfma_f32_16x16x32_bf16 v[76:79], a[204:207], a[52:55], v[76:79]
v_mfma_f32_16x16x32_bf16 v[68:71], a[200:203], a[32:35], v[68:71]
buffer_load_dwordx4 v24, s[16:19], s29 offen offset:1024 nt lds
v_mfma_f32_16x16x32_bf16 v[68:71], a[204:207], a[48:51], v[68:71]
ds_read_b64_tr_b16 a[200:201], v14 offset:24712
v_mfma_f32_16x16x32_bf16 v[96:99], a[208:211], a[32:35], v[96:99]
ds_read_b64_tr_b16 a[202:203], v14 offset:30856
v_mfma_f32_16x16x32_bf16 v[96:99], a[212:215], a[48:51], v[96:99]
buffer_load_dwordx4 v25, s[16:19], s29 offen offset:2048 nt lds
s_add_u32 s29, s29, s101
v_mfma_f32_16x16x32_bf16 v[104:107], a[208:211], a[36:39], v[104:107]
ds_read_b64_tr_b16 a[204:205], v16 offset:136
v_mfma_f32_16x16x32_bf16 v[104:107], a[212:215], a[52:55], v[104:107]
s_add_u32 m0, s39, 34816
s_add_u32 s30, s30, s56
ds_read_b64_tr_b16 a[206:207], v16 offset:6280
v_mfma_f32_16x16x32_bf16 v[112:115], a[208:211], a[40:43], v[112:115]
buffer_load_dwordx4 v26, s[4:7], s30 offen offset:0 lds
v_mfma_f32_16x16x32_bf16 v[112:115], a[212:215], a[56:59], v[112:115]
v_mfma_f32_16x16x32_bf16 v[120:123], a[208:211], a[44:47], v[120:123]
ds_read_b64_tr_b16 a[208:209], v13 offset:24832
v_mfma_f32_16x16x32_bf16 v[120:123], a[212:215], a[60:63], v[120:123]
buffer_load_dwordx4 v27, s[4:7], s30 offen offset:1024 lds
v_mfma_f32_16x16x32_bf16 v[124:127], a[216:219], a[44:47], v[124:127]
ds_read_b64_tr_b16 a[210:211], v13 offset:30976
v_mfma_f32_16x16x32_bf16 v[124:127], a[220:223], a[60:63], v[124:127]
s_add_u32 m0, s39, 36864
s_add_u32 s31, s31, s56
ds_read_b64_tr_b16 a[212:213], v15 offset:256
v_mfma_f32_16x16x32_bf16 v[116:119], a[216:219], a[40:43], v[116:119]
buffer_load_dwordx4 v26, s[4:7], s31 offen offset:0 lds
v_mfma_f32_16x16x32_bf16 v[116:119], a[220:223], a[56:59], v[116:119]
ds_read_b64_tr_b16 a[214:215], v15 offset:6400
v_mfma_f32_16x16x32_bf16 v[108:111], a[216:219], a[36:39], v[108:111]
v_mfma_f32_16x16x32_bf16 v[108:111], a[220:223], a[52:55], v[108:111]
buffer_load_dwordx4 v27, s[4:7], s31 offen offset:1024 lds
v_mfma_f32_16x16x32_bf16 v[100:103], a[216:219], a[32:35], v[100:103]
ds_read_b64_tr_b16 a[216:217], v13 offset:24840
v_mfma_f32_16x16x32_bf16 v[100:103], a[220:223], a[48:51], v[100:103]
s_add_u32 m0, s88, 38912
s_add_u32 s32, s32, s56
ds_read_b64_tr_b16 a[218:219], v13 offset:30984
v_mfma_f32_16x16x32_bf16 v[128:131], a[224:227], a[32:35], v[128:131]
buffer_load_dwordx4 v26, s[4:7], s32 offen offset:0 lds
v_mfma_f32_16x16x32_bf16 v[128:131], a[228:231], a[48:51], v[128:131]
ds_read_b64_tr_b16 a[220:221], v15 offset:264
v_mfma_f32_16x16x32_bf16 v[136:139], a[224:227], a[36:39], v[136:139]
ds_read_b64_tr_b16 a[222:223], v15 offset:6408
v_mfma_f32_16x16x32_bf16 v[136:139], a[228:231], a[52:55], v[136:139]
buffer_load_dwordx4 v27, s[4:7], s32 offen offset:1024 lds
v_mfma_f32_16x16x32_bf16 v[144:147], a[224:227], a[40:43], v[144:147]
v_mfma_f32_16x16x32_bf16 v[144:147], a[228:231], a[56:59], v[144:147]
s_add_u32 m0, s88, 40960
s_add_u32 s33, s33, s56
v_mfma_f32_16x16x32_bf16 v[152:155], a[224:227], a[44:47], v[152:155]
buffer_load_dwordx4 v26, s[4:7], s33 offen offset:0 lds
v_mfma_f32_16x16x32_bf16 v[152:155], a[228:231], a[60:63], v[152:155]
ds_read_b64_tr_b16 a[224:225], v14 offset:24832
v_mfma_f32_16x16x32_bf16 v[156:159], a[232:235], a[44:47], v[156:159]
s_waitcnt lgkmcnt(1)
ds_read_b64_tr_b16 a[226:227], v14 offset:30976
v_mfma_f32_16x16x32_bf16 v[156:159], a[236:239], a[60:63], v[156:159]
buffer_load_dwordx4 v27, s[4:7], s33 offen offset:1024 lds
v_mfma_f32_16x16x32_bf16 v[148:151], a[232:235], a[40:43], v[148:151]
ds_read_b64_tr_b16 a[228:229], v16 offset:256
v_mfma_f32_16x16x32_bf16 v[148:151], a[236:239], a[56:59], v[148:151]
ds_read_b64_tr_b16 a[230:231], v16 offset:6400
v_mfma_f32_16x16x32_bf16 v[140:143], a[232:235], a[36:39], v[140:143]
v_mfma_f32_16x16x32_bf16 v[140:143], a[236:239], a[52:55], v[140:143]
v_mfma_f32_16x16x32_bf16 v[132:135], a[232:235], a[32:35], v[132:135]
ds_read_b64_tr_b16 a[232:233], v14 offset:24840
v_mfma_f32_16x16x32_bf16 v[132:135], a[236:239], a[48:51], v[132:135]
ds_read_b64_tr_b16 a[234:235], v14 offset:30984
v_mfma_f32_16x16x32_bf16 v[160:163], a[192:195], a[32:35], v[160:163]
ds_read_b64_tr_b16 a[236:237], v16 offset:264
v_mfma_f32_16x16x32_bf16 v[160:163], a[196:199], a[48:51], v[160:163]
ds_read_b64_tr_b16 a[238:239], v16 offset:6408
v_mfma_f32_16x16x32_bf16 v[168:171], a[192:195], a[36:39], v[168:171]
v_mfma_f32_16x16x32_bf16 v[168:171], a[196:199], a[52:55], v[168:171]
v_mfma_f32_16x16x32_bf16 v[176:179], a[192:195], a[40:43], v[176:179]
v_mfma_f32_16x16x32_bf16 v[176:179], a[196:199], a[56:59], v[176:179]
s_waitcnt vmcnt(18) lgkmcnt(0)
v_mfma_f32_16x16x32_bf16 v[184:187], a[192:195], a[44:47], v[184:187]
s_barrier
v_mfma_f32_16x16x32_bf16 v[184:187], a[196:199], a[60:63], v[184:187]
ds_read_b64_tr_b16 a[192:193], v15 offset:12288
v_mfma_f32_16x16x32_bf16 v[188:191], a[200:203], a[44:47], v[188:191]
ds_read_b64_tr_b16 a[194:195], v15 offset:18432
v_mfma_f32_16x16x32_bf16 v[188:191], a[204:207], a[60:63], v[188:191]
s_add_u32 m0, s26, 24576
ds_read_b64_tr_b16 a[196:197], v15 offset:24576
v_mfma_f32_16x16x32_bf16 v[180:183], a[200:203], a[40:43], v[180:183]
buffer_load_dwordx4 v20, s[12:15], s28 offen offset:0 nt lds
v_mfma_f32_16x16x32_bf16 v[180:183], a[204:207], a[56:59], v[180:183]
ds_read_b64_tr_b16 a[198:199], v15 offset:30720
v_mfma_f32_16x16x32_bf16 v[172:175], a[200:203], a[36:39], v[172:175]
s_waitcnt vmcnt(15)
ds_read_b128 a[0:3], v28 offset:0
v_mfma_f32_16x16x32_bf16 v[172:175], a[204:207], a[52:55], v[172:175]
v_mfma_f32_16x16x32_bf16 v[164:167], a[200:203], a[32:35], v[164:167]
ds_read_b64_tr_b16 a[200:201], v15 offset:12296
v_mfma_f32_16x16x32_bf16 v[164:167], a[204:207], a[48:51], v[164:167]
ds_read_b64_tr_b16 a[202:203], v15 offset:18440
v_mfma_f32_16x16x32_bf16 v[192:195], a[208:211], a[32:35], v[192:195]
ds_read_b128 a[4:7], v28 offset:2048
v_mfma_f32_16x16x32_bf16 v[192:195], a[212:215], a[48:51], v[192:195]
ds_read_b64_tr_b16 a[204:205], v15 offset:24584
v_mfma_f32_16x16x32_bf16 v[200:203], a[208:211], a[36:39], v[200:203]
ds_read_b64_tr_b16 a[206:207], v15 offset:30728
v_mfma_f32_16x16x32_bf16 v[200:203], a[212:215], a[52:55], v[200:203]
v_mfma_f32_16x16x32_bf16 v[208:211], a[208:211], a[40:43], v[208:211]
ds_read_b128 a[8:11], v28 offset:4096
v_mfma_f32_16x16x32_bf16 v[208:211], a[212:215], a[56:59], v[208:211]
v_mfma_f32_16x16x32_bf16 v[216:219], a[208:211], a[44:47], v[216:219]
buffer_load_dwordx4 v21, s[12:15], s28 offen offset:1024 nt lds
v_mfma_f32_16x16x32_bf16 v[216:219], a[212:215], a[60:63], v[216:219]
ds_read_b64_tr_b16 a[208:209], v16 offset:12288
v_mfma_f32_16x16x32_bf16 v[220:223], a[216:219], a[44:47], v[220:223]
ds_read_b128 a[12:15], v28 offset:6144
v_mfma_f32_16x16x32_bf16 v[220:223], a[220:223], a[60:63], v[220:223]
ds_read_b64_tr_b16 a[210:211], v16 offset:18432
v_mfma_f32_16x16x32_bf16 v[212:215], a[216:219], a[40:43], v[212:215]
ds_read_b64_tr_b16 a[212:213], v16 offset:24576
v_mfma_f32_16x16x32_bf16 v[212:215], a[220:223], a[56:59], v[212:215]
ds_read_b64_tr_b16 a[214:215], v16 offset:30720
v_mfma_f32_16x16x32_bf16 v[204:207], a[216:219], a[36:39], v[204:207]
ds_read_b128 a[16:19], v29 offset:0
v_mfma_f32_16x16x32_bf16 v[204:207], a[220:223], a[52:55], v[204:207]
v_mfma_f32_16x16x32_bf16 v[196:199], a[216:219], a[32:35], v[196:199]
ds_read_b64_tr_b16 a[216:217], v16 offset:12296
v_mfma_f32_16x16x32_bf16 v[196:199], a[220:223], a[48:51], v[196:199]
ds_read_b64_tr_b16 a[218:219], v16 offset:18440
v_mfma_f32_16x16x32_bf16 v[224:227], a[224:227], a[32:35], v[224:227]
ds_read_b128 a[20:23], v29 offset:2048
v_mfma_f32_16x16x32_bf16 v[224:227], a[228:231], a[48:51], v[224:227]
ds_read_b64_tr_b16 a[220:221], v16 offset:24584
v_mfma_f32_16x16x32_bf16 v[232:235], a[224:227], a[36:39], v[232:235]
buffer_load_dwordx4 v22, s[12:15], s28 offen offset:2048 nt lds
s_add_u32 s28, s28, 12288
v_mfma_f32_16x16x32_bf16 v[232:235], a[228:231], a[52:55], v[232:235]
ds_read_b64_tr_b16 a[222:223], v16 offset:30728
v_mfma_f32_16x16x32_bf16 v[240:243], a[224:227], a[40:43], v[240:243]
ds_read_b128 a[24:27], v29 offset:4096
v_mfma_f32_16x16x32_bf16 v[240:243], a[228:231], a[56:59], v[240:243]
v_mfma_f32_16x16x32_bf16 v[248:251], a[224:227], a[44:47], v[248:251]
ds_read_b64_tr_b16 a[224:225], v15 offset:12416
v_mfma_f32_16x16x32_bf16 v[248:251], a[228:231], a[60:63], v[248:251]
ds_read_b64_tr_b16 a[226:227], v15 offset:18560
v_mfma_f32_16x16x32_bf16 v[252:255], a[232:235], a[44:47], v[252:255]
ds_read_b128 a[28:31], v29 offset:6144
v_mfma_f32_16x16x32_bf16 v[252:255], a[236:239], a[60:63], v[252:255]
ds_read_b64_tr_b16 a[228:229], v15 offset:24704
v_mfma_f32_16x16x32_bf16 v[244:247], a[232:235], a[40:43], v[244:247]
ds_read_b64_tr_b16 a[230:231], v15 offset:30848
v_mfma_f32_16x16x32_bf16 v[244:247], a[236:239], a[56:59], v[244:247]
v_mfma_f32_16x16x32_bf16 v[236:239], a[232:235], a[36:39], v[236:239]
v_mfma_f32_16x16x32_bf16 v[236:239], a[236:239], a[52:55], v[236:239]
v_mfma_f32_16x16x32_bf16 v[228:231], a[232:235], a[32:35], v[228:231]
ds_read_b64_tr_b16 a[232:233], v15 offset:12424
v_mfma_f32_16x16x32_bf16 v[228:231], a[236:239], a[48:51], v[228:231]
s_waitcnt lgkmcnt(2)
ds_read_b64_tr_b16 a[234:235], v15 offset:18568
v_mfma_f32_16x16x32_bf16 v[64:67], a[192:195], a[0:3], v[64:67]
ds_read_b64_tr_b16 a[236:237], v15 offset:24712
v_mfma_f32_16x16x32_bf16 v[64:67], a[196:199], a[16:19], v[64:67]
ds_read_b64_tr_b16 a[238:239], v15 offset:30856
v_mfma_f32_16x16x32_bf16 v[72:75], a[192:195], a[4:7], v[72:75]
v_mfma_f32_16x16x32_bf16 v[72:75], a[196:199], a[20:23], v[72:75]
s_add_u32 m0, s26, 36864
v_mfma_f32_16x16x32_bf16 v[80:83], a[192:195], a[8:11], v[80:83]
buffer_load_dwordx4 v20, s[12:15], s28 offen offset:0 nt lds
v_mfma_f32_16x16x32_bf16 v[80:83], a[196:199], a[24:27], v[80:83]
v_mfma_f32_16x16x32_bf16 v[88:91], a[192:195], a[12:15], v[88:91]
ds_read_b64_tr_b16 a[192:193], v16 offset:12416
v_mfma_f32_16x16x32_bf16 v[88:91], a[196:199], a[28:31], v[88:91]
ds_read_b64_tr_b16 a[194:195], v16 offset:18560
v_mfma_f32_16x16x32_bf16 v[92:95], a[200:203], a[12:15], v[92:95]
ds_read_b64_tr_b16 a[196:197], v16 offset:24704
v_mfma_f32_16x16x32_bf16 v[92:95], a[204:207], a[28:31], v[92:95]
ds_read_b64_tr_b16 a[198:199], v16 offset:30848
v_mfma_f32_16x16x32_bf16 v[84:87], a[200:203], a[8:11], v[84:87]
v_mfma_f32_16x16x32_bf16 v[84:87], a[204:207], a[24:27], v[84:87]
v_mfma_f32_16x16x32_bf16 v[76:79], a[200:203], a[4:7], v[76:79]
v_mfma_f32_16x16x32_bf16 v[76:79], a[204:207], a[20:23], v[76:79]
v_mfma_f32_16x16x32_bf16 v[68:71], a[200:203], a[0:3], v[68:71]
ds_read_b64_tr_b16 a[200:201], v16 offset:12424
v_mfma_f32_16x16x32_bf16 v[68:71], a[204:207], a[16:19], v[68:71]
ds_read_b64_tr_b16 a[202:203], v16 offset:18568
v_mfma_f32_16x16x32_bf16 v[96:99], a[208:211], a[0:3], v[96:99]
ds_read_b64_tr_b16 a[204:205], v16 offset:24712
v_mfma_f32_16x16x32_bf16 v[96:99], a[212:215], a[16:19], v[96:99]
ds_read_b64_tr_b16 a[206:207], v16 offset:30856
v_mfma_f32_16x16x32_bf16 v[104:107], a[208:211], a[4:7], v[104:107]
buffer_load_dwordx4 v21, s[12:15], s28 offen offset:1024 nt lds
v_mfma_f32_16x16x32_bf16 v[104:107], a[212:215], a[20:23], v[104:107]
v_mfma_f32_16x16x32_bf16 v[112:115], a[208:211], a[8:11], v[112:115]
v_mfma_f32_16x16x32_bf16 v[112:115], a[212:215], a[24:27], v[112:115]
v_mfma_f32_16x16x32_bf16 v[120:123], a[208:211], a[12:15], v[120:123]
ds_read_b64_tr_b16 a[208:209], v15 offset:12544
v_mfma_f32_16x16x32_bf16 v[120:123], a[212:215], a[28:31], v[120:123]
ds_read_b64_tr_b16 a[210:211], v15 offset:18688
v_mfma_f32_16x16x32_bf16 v[124:127], a[216:219], a[12:15], v[124:127]
ds_read_b64_tr_b16 a[212:213], v15 offset:24832
v_mfma_f32_16x16x32_bf16 v[124:127], a[220:223], a[28:31], v[124:127]
ds_read_b64_tr_b16 a[214:215], v15 offset:30976
v_mfma_f32_16x16x32_bf16 v[116:119], a[216:219], a[8:11], v[116:119]
v_mfma_f32_16x16x32_bf16 v[116:119], a[220:223], a[24:27], v[116:119]
v_mfma_f32_16x16x32_bf16 v[108:111], a[216:219], a[4:7], v[108:111]
v_mfma_f32_16x16x32_bf16 v[108:111], a[220:223], a[20:23], v[108:111]
v_mfma_f32_16x16x32_bf16 v[100:103], a[216:219], a[0:3], v[100:103]
ds_read_b64_tr_b16 a[216:217], v15 offset:12552
v_mfma_f32_16x16x32_bf16 v[100:103], a[220:223], a[16:19], v[100:103]
ds_read_b64_tr_b16 a[218:219], v15 offset:18696
v_mfma_f32_16x16x32_bf16 v[128:131], a[224:227], a[0:3], v[128:131]
s_waitcnt lgkmcnt(2)
buffer_load_dwordx4 v22, s[12:15], s28 offen offset:2048 nt lds
s_add_u32 s28, s28, 12288
v_mfma_f32_16x16x32_bf16 v[128:131], a[228:231], a[16:19], v[128:131]
ds_read_b64_tr_b16 a[220:221], v15 offset:24840
v_mfma_f32_16x16x32_bf16 v[136:139], a[224:227], a[4:7], v[136:139]
ds_read_b64_tr_b16 a[222:223], v15 offset:30984
v_mfma_f32_16x16x32_bf16 v[136:139], a[228:231], a[20:23], v[136:139]
v_mfma_f32_16x16x32_bf16 v[144:147], a[224:227], a[8:11], v[144:147]
v_mfma_f32_16x16x32_bf16 v[144:147], a[228:231], a[24:27], v[144:147]
v_mfma_f32_16x16x32_bf16 v[152:155], a[224:227], a[12:15], v[152:155]
ds_read_b64_tr_b16 a[224:225], v16 offset:12544
v_mfma_f32_16x16x32_bf16 v[152:155], a[228:231], a[28:31], v[152:155]
ds_read_b64_tr_b16 a[226:227], v16 offset:18688
v_mfma_f32_16x16x32_bf16 v[156:159], a[232:235], a[12:15], v[156:159]
ds_read_b64_tr_b16 a[228:229], v16 offset:24832
v_mfma_f32_16x16x32_bf16 v[156:159], a[236:239], a[28:31], v[156:159]
ds_read_b64_tr_b16 a[230:231], v16 offset:30976
v_mfma_f32_16x16x32_bf16 v[148:151], a[232:235], a[8:11], v[148:151]
v_mfma_f32_16x16x32_bf16 v[148:151], a[236:239], a[24:27], v[148:151]
v_mfma_f32_16x16x32_bf16 v[140:143], a[232:235], a[4:7], v[140:143]
v_mfma_f32_16x16x32_bf16 v[140:143], a[236:239], a[20:23], v[140:143]
v_mfma_f32_16x16x32_bf16 v[132:135], a[232:235], a[0:3], v[132:135]
ds_read_b64_tr_b16 a[232:233], v16 offset:12552
v_mfma_f32_16x16x32_bf16 v[132:135], a[236:239], a[16:19], v[132:135]
ds_read_b64_tr_b16 a[234:235], v16 offset:18696
v_mfma_f32_16x16x32_bf16 v[160:163], a[192:195], a[0:3], v[160:163]
ds_read_b64_tr_b16 a[236:237], v16 offset:24840
v_mfma_f32_16x16x32_bf16 v[160:163], a[196:199], a[16:19], v[160:163]
ds_read_b64_tr_b16 a[238:239], v16 offset:30984
v_mfma_f32_16x16x32_bf16 v[168:171], a[192:195], a[4:7], v[168:171]
v_mfma_f32_16x16x32_bf16 v[168:171], a[196:199], a[20:23], v[168:171]
v_mfma_f32_16x16x32_bf16 v[176:179], a[192:195], a[8:11], v[176:179]
v_mfma_f32_16x16x32_bf16 v[176:179], a[196:199], a[24:27], v[176:179]
s_waitcnt vmcnt(14) lgkmcnt(0)
v_mfma_f32_16x16x32_bf16 v[184:187], a[192:195], a[12:15], v[184:187]
s_barrier
v_mfma_f32_16x16x32_bf16 v[184:187], a[196:199], a[28:31], v[184:187]
ds_read_b64_tr_b16 a[192:193], v13 offset:0
v_mfma_f32_16x16x32_bf16 v[188:191], a[200:203], a[12:15], v[188:191]
ds_read_b64_tr_b16 a[194:195], v13 offset:6144
v_mfma_f32_16x16x32_bf16 v[188:191], a[204:207], a[28:31], v[188:191]
s_add_u32 m0, s25, 24576
ds_read_b64_tr_b16 a[196:197], v13 offset:12288
v_mfma_f32_16x16x32_bf16 v[180:183], a[200:203], a[8:11], v[180:183]
buffer_load_dwordx4 v17, s[8:11], s27 offen offset:0 nt lds
v_mfma_f32_16x16x32_bf16 v[180:183], a[204:207], a[24:27], v[180:183]
ds_read_b64_tr_b16 a[198:199], v13 offset:18432
v_mfma_f32_16x16x32_bf16 v[172:175], a[200:203], a[4:7], v[172:175]
s_waitcnt vmcnt(7)
ds_read_b128 a[32:35], v28 offset:32768
v_mfma_f32_16x16x32_bf16 v[172:175], a[204:207], a[20:23], v[172:175]
v_mfma_f32_16x16x32_bf16 v[164:167], a[200:203], a[0:3], v[164:167]
ds_read_b64_tr_b16 a[200:201], v13 offset:8
v_mfma_f32_16x16x32_bf16 v[164:167], a[204:207], a[16:19], v[164:167]
ds_read_b64_tr_b16 a[202:203], v13 offset:6152
v_mfma_f32_16x16x32_bf16 v[192:195], a[208:211], a[0:3], v[192:195]
ds_read_b128 a[36:39], v28 offset:34816
v_mfma_f32_16x16x32_bf16 v[192:195], a[212:215], a[16:19], v[192:195]
ds_read_b64_tr_b16 a[204:205], v13 offset:12296
v_mfma_f32_16x16x32_bf16 v[200:203], a[208:211], a[4:7], v[200:203]
ds_read_b64_tr_b16 a[206:207], v13 offset:18440
v_mfma_f32_16x16x32_bf16 v[200:203], a[212:215], a[20:23], v[200:203]
v_mfma_f32_16x16x32_bf16 v[208:211], a[208:211], a[8:11], v[208:211]
ds_read_b128 a[40:43], v28 offset:36864
v_mfma_f32_16x16x32_bf16 v[208:211], a[212:215], a[24:27], v[208:211]
v_mfma_f32_16x16x32_bf16 v[216:219], a[208:211], a[12:15], v[216:219]
buffer_load_dwordx4 v18, s[8:11], s27 offen offset:1024 nt lds
v_mfma_f32_16x16x32_bf16 v[216:219], a[212:215], a[28:31], v[216:219]
ds_read_b64_tr_b16 a[208:209], v14 offset:0
v_mfma_f32_16x16x32_bf16 v[220:223], a[216:219], a[12:15], v[220:223]
ds_read_b128 a[44:47], v28 offset:38912
v_mfma_f32_16x16x32_bf16 v[220:223], a[220:223], a[28:31], v[220:223]
ds_read_b64_tr_b16 a[210:211], v14 offset:6144
v_mfma_f32_16x16x32_bf16 v[212:215], a[216:219], a[8:11], v[212:215]
ds_read_b64_tr_b16 a[212:213], v14 offset:12288
v_mfma_f32_16x16x32_bf16 v[212:215], a[220:223], a[24:27], v[212:215]
ds_read_b64_tr_b16 a[214:215], v14 offset:18432
v_mfma_f32_16x16x32_bf16 v[204:207], a[216:219], a[4:7], v[204:207]
ds_read_b128 a[48:51], v29 offset:32768
v_mfma_f32_16x16x32_bf16 v[204:207], a[220:223], a[20:23], v[204:207]
v_mfma_f32_16x16x32_bf16 v[196:199], a[216:219], a[0:3], v[196:199]
ds_read_b64_tr_b16 a[216:217], v14 offset:8
v_mfma_f32_16x16x32_bf16 v[196:199], a[220:223], a[16:19], v[196:199]
ds_read_b64_tr_b16 a[218:219], v14 offset:6152
v_mfma_f32_16x16x32_bf16 v[224:227], a[224:227], a[0:3], v[224:227]
ds_read_b128 a[52:55], v29 offset:34816
v_mfma_f32_16x16x32_bf16 v[224:227], a[228:231], a[16:19], v[224:227]
ds_read_b64_tr_b16 a[220:221], v14 offset:12296
v_mfma_f32_16x16x32_bf16 v[232:235], a[224:227], a[4:7], v[232:235]
buffer_load_dwordx4 v19, s[8:11], s27 offen offset:2048 nt lds
s_add_u32 s27, s27, 12288
v_mfma_f32_16x16x32_bf16 v[232:235], a[228:231], a[20:23], v[232:235]
ds_read_b64_tr_b16 a[222:223], v14 offset:18440
v_mfma_f32_16x16x32_bf16 v[240:243], a[224:227], a[8:11], v[240:243]
ds_read_b128 a[56:59], v29 offset:36864
v_mfma_f32_16x16x32_bf16 v[240:243], a[228:231], a[24:27], v[240:243]
v_mfma_f32_16x16x32_bf16 v[248:251], a[224:227], a[12:15], v[248:251]
ds_read_b64_tr_b16 a[224:225], v13 offset:128
v_mfma_f32_16x16x32_bf16 v[248:251], a[228:231], a[28:31], v[248:251]
ds_read_b64_tr_b16 a[226:227], v13 offset:6272
v_mfma_f32_16x16x32_bf16 v[252:255], a[232:235], a[12:15], v[252:255]
ds_read_b128 a[60:63], v29 offset:38912
v_mfma_f32_16x16x32_bf16 v[252:255], a[236:239], a[28:31], v[252:255]
ds_read_b64_tr_b16 a[228:229], v13 offset:12416
v_mfma_f32_16x16x32_bf16 v[244:247], a[232:235], a[8:11], v[244:247]
ds_read_b64_tr_b16 a[230:231], v13 offset:18560
v_mfma_f32_16x16x32_bf16 v[244:247], a[236:239], a[24:27], v[244:247]
v_mfma_f32_16x16x32_bf16 v[236:239], a[232:235], a[4:7], v[236:239]
v_mfma_f32_16x16x32_bf16 v[236:239], a[236:239], a[20:23], v[236:239]
v_mfma_f32_16x16x32_bf16 v[228:231], a[232:235], a[0:3], v[228:231]
ds_read_b64_tr_b16 a[232:233], v13 offset:136
v_mfma_f32_16x16x32_bf16 v[228:231], a[236:239], a[16:19], v[228:231]
s_waitcnt lgkmcnt(2)
ds_read_b64_tr_b16 a[234:235], v13 offset:6280
v_mfma_f32_16x16x32_bf16 v[64:67], a[192:195], a[32:35], v[64:67]
ds_read_b64_tr_b16 a[236:237], v13 offset:12424
v_mfma_f32_16x16x32_bf16 v[64:67], a[196:199], a[48:51], v[64:67]
ds_read_b64_tr_b16 a[238:239], v13 offset:18568
v_mfma_f32_16x16x32_bf16 v[72:75], a[192:195], a[36:39], v[72:75]
v_mfma_f32_16x16x32_bf16 v[72:75], a[196:199], a[52:55], v[72:75]
s_add_u32 m0, s26, 49152
v_mfma_f32_16x16x32_bf16 v[80:83], a[192:195], a[40:43], v[80:83]
buffer_load_dwordx4 v20, s[12:15], s28 offen offset:0 nt lds
v_mfma_f32_16x16x32_bf16 v[80:83], a[196:199], a[56:59], v[80:83]
v_mfma_f32_16x16x32_bf16 v[88:91], a[192:195], a[44:47], v[88:91]
ds_read_b64_tr_b16 a[192:193], v14 offset:128
v_mfma_f32_16x16x32_bf16 v[88:91], a[196:199], a[60:63], v[88:91]
ds_read_b64_tr_b16 a[194:195], v14 offset:6272
v_mfma_f32_16x16x32_bf16 v[68:71], a[200:203], a[32:35], v[68:71]
ds_read_b64_tr_b16 a[196:197], v14 offset:12416
v_mfma_f32_16x16x32_bf16 v[68:71], a[204:207], a[48:51], v[68:71]
ds_read_b64_tr_b16 a[198:199], v14 offset:18560
v_mul_f32 v64, s37, v64
v_mfma_f32_16x16x32_bf16 v[76:79], a[200:203], a[36:39], v[76:79]
v_mul_f32 v65, s37, v65
v_mul_f32 v66, s37, v66
v_mfma_f32_16x16x32_bf16 v[76:79], a[204:207], a[52:55], v[76:79]
v_mul_f32 v67, s37, v67
v_cvt_pk_bf16_f32 v64, v64, v65
v_mfma_f32_16x16x32_bf16 v[84:87], a[200:203], a[40:43], v[84:87]
v_mul_f32 v68, s37, v68
v_mul_f32 v69, s37, v69
v_mfma_f32_16x16x32_bf16 v[84:87], a[204:207], a[56:59], v[84:87]
v_mul_f32 v70, s37, v70
v_mul_f32 v71, s37, v71
v_mfma_f32_16x16x32_bf16 v[92:95], a[200:203], a[44:47], v[92:95]
ds_read_b64_tr_b16 a[200:201], v14 offset:136
v_cvt_pk_bf16_f32 v65, v66, v67
v_mfma_f32_16x16x32_bf16 v[92:95], a[204:207], a[60:63], v[92:95]
ds_read_b64_tr_b16 a[202:203], v14 offset:6280
v_cvt_pk_bf16_f32 v66, v68, v69
v_mfma_f32_16x16x32_bf16 v[96:99], a[208:211], a[32:35], v[96:99]
ds_read_b64_tr_b16 a[204:205], v14 offset:12424
v_cvt_pk_bf16_f32 v67, v70, v71
v_mfma_f32_16x16x32_bf16 v[96:99], a[212:215], a[48:51], v[96:99]
ds_read_b64_tr_b16 a[206:207], v14 offset:18568
v_mul_f32 v72, s37, v72
v_mfma_f32_16x16x32_bf16 v[104:107], a[208:211], a[36:39], v[104:107]
buffer_load_dwordx4 v21, s[12:15], s28 offen offset:1024 nt lds
v_mfma_f32_16x16x32_bf16 v[104:107], a[212:215], a[52:55], v[104:107]
v_mul_f32 v73, s37, v73
v_mul_f32 v74, s37, v74
v_mfma_f32_16x16x32_bf16 v[112:115], a[208:211], a[40:43], v[112:115]
v_mul_f32 v75, s37, v75
v_mul_f32 v76, s37, v76
v_mfma_f32_16x16x32_bf16 v[112:115], a[212:215], a[56:59], v[112:115]
v_mul_f32 v77, s37, v77
v_mul_f32 v78, s37, v78
v_mfma_f32_16x16x32_bf16 v[120:123], a[208:211], a[44:47], v[120:123]
ds_read_b64_tr_b16 a[208:209], v13 offset:256
v_mul_f32 v79, s37, v79
v_mfma_f32_16x16x32_bf16 v[120:123], a[212:215], a[60:63], v[120:123]
ds_read_b64_tr_b16 a[210:211], v13 offset:6400
v_cvt_pk_bf16_f32 v68, v72, v73
v_mfma_f32_16x16x32_bf16 v[100:103], a[216:219], a[32:35], v[100:103]
ds_read_b64_tr_b16 a[212:213], v13 offset:12544
v_cvt_pk_bf16_f32 v69, v74, v75
v_mfma_f32_16x16x32_bf16 v[100:103], a[220:223], a[48:51], v[100:103]
ds_read_b64_tr_b16 a[214:215], v13 offset:18688
v_cvt_pk_bf16_f32 v70, v76, v77
v_mfma_f32_16x16x32_bf16 v[108:111], a[216:219], a[36:39], v[108:111]
v_cvt_pk_bf16_f32 v71, v78, v79
v_mul_f32 v80, s37, v80
v_mfma_f32_16x16x32_bf16 v[108:111], a[220:223], a[52:55], v[108:111]
v_mul_f32 v81, s37, v81
v_mul_f32 v82, s37, v82
v_mfma_f32_16x16x32_bf16 v[116:119], a[216:219], a[40:43], v[116:119]
v_mul_f32 v83, s37, v83
v_mul_f32 v84, s37, v84
v_mfma_f32_16x16x32_bf16 v[116:119], a[220:223], a[56:59], v[116:119]
v_mul_f32 v85, s37, v85
v_mul_f32 v86, s37, v86
v_mfma_f32_16x16x32_bf16 v[124:127], a[216:219], a[44:47], v[124:127]
ds_read_b64_tr_b16 a[216:217], v13 offset:264
v_mul_f32 v87, s37, v87
v_mfma_f32_16x16x32_bf16 v[124:127], a[220:223], a[60:63], v[124:127]
ds_read_b64_tr_b16 a[218:219], v13 offset:6408
v_cvt_pk_bf16_f32 v72, v80, v81
v_mfma_f32_16x16x32_bf16 v[128:131], a[224:227], a[32:35], v[128:131]
s_waitcnt lgkmcnt(2)
buffer_load_dwordx4 v22, s[12:15], s28 offen offset:2048 nt lds
s_add_u32 s28, s28, 12288
v_mfma_f32_16x16x32_bf16 v[128:131], a[228:231], a[48:51], v[128:131]
ds_read_b64_tr_b16 a[220:221], v13 offset:12552
v_cvt_pk_bf16_f32 v73, v82, v83
v_mfma_f32_16x16x32_bf16 v[136:139], a[224:227], a[36:39], v[136:139]
ds_read_b64_tr_b16 a[222:223], v13 offset:18696
v_cvt_pk_bf16_f32 v74, v84, v85
v_mfma_f32_16x16x32_bf16 v[136:139], a[228:231], a[52:55], v[136:139]
v_cvt_pk_bf16_f32 v75, v86, v87
v_mul_f32 v88, s37, v88
v_mfma_f32_16x16x32_bf16 v[144:147], a[224:227], a[40:43], v[144:147]
v_mul_f32 v89, s37, v89
v_mul_f32 v90, s37, v90
v_mfma_f32_16x16x32_bf16 v[144:147], a[228:231], a[56:59], v[144:147]
v_mul_f32 v91, s37, v91
v_mul_f32 v92, s37, v92
v_mfma_f32_16x16x32_bf16 v[152:155], a[224:227], a[44:47], v[152:155]
ds_read_b64_tr_b16 a[224:225], v14 offset:256
v_mul_f32 v93, s37, v93
v_mfma_f32_16x16x32_bf16 v[152:155], a[228:231], a[60:63], v[152:155]
ds_read_b64_tr_b16 a[226:227], v14 offset:6400
v_mul_f32 v94, s37, v94
v_mfma_f32_16x16x32_bf16 v[132:135], a[232:235], a[32:35], v[132:135]
ds_read_b64_tr_b16 a[228:229], v14 offset:12544
v_mul_f32 v95, s37, v95
v_mfma_f32_16x16x32_bf16 v[132:135], a[236:239], a[48:51], v[132:135]
ds_read_b64_tr_b16 a[230:231], v14 offset:18688
v_cvt_pk_bf16_f32 v76, v88, v89
v_mfma_f32_16x16x32_bf16 v[140:143], a[232:235], a[36:39], v[140:143]
v_cvt_pk_bf16_f32 v77, v90, v91
v_cvt_pk_bf16_f32 v78, v92, v93
v_mfma_f32_16x16x32_bf16 v[140:143], a[236:239], a[52:55], v[140:143]
v_cvt_pk_bf16_f32 v79, v94, v95
v_mul_f32 v96, s37, v96
v_mfma_f32_16x16x32_bf16 v[148:151], a[232:235], a[40:43], v[148:151]
v_mul_f32 v97, s37, v97
v_mul_f32 v98, s37, v98
v_mfma_f32_16x16x32_bf16 v[148:151], a[236:239], a[56:59], v[148:151]
v_mul_f32 v99, s37, v99
v_mul_f32 v100, s37, v100
v_mfma_f32_16x16x32_bf16 v[156:159], a[232:235], a[44:47], v[156:159]
ds_read_b64_tr_b16 a[232:233], v14 offset:264
v_mul_f32 v101, s37, v101
v_mfma_f32_16x16x32_bf16 v[156:159], a[236:239], a[60:63], v[156:159]
ds_read_b64_tr_b16 a[234:235], v14 offset:6408
v_mul_f32 v102, s37, v102
v_mfma_f32_16x16x32_bf16 v[160:163], a[192:195], a[32:35], v[160:163]
ds_read_b64_tr_b16 a[236:237], v14 offset:12552
v_mul_f32 v103, s37, v103
v_mfma_f32_16x16x32_bf16 v[160:163], a[196:199], a[48:51], v[160:163]
ds_read_b64_tr_b16 a[238:239], v14 offset:18696
v_cvt_pk_bf16_f32 v80, v96, v97
v_mfma_f32_16x16x32_bf16 v[168:171], a[192:195], a[36:39], v[168:171]
v_cvt_pk_bf16_f32 v81, v98, v99
v_cvt_pk_bf16_f32 v82, v100, v101
v_mfma_f32_16x16x32_bf16 v[168:171], a[196:199], a[52:55], v[168:171]
v_cvt_pk_bf16_f32 v83, v102, v103
v_mul_f32 v104, s37, v104
v_mfma_f32_16x16x32_bf16 v[176:179], a[192:195], a[40:43], v[176:179]
v_mul_f32 v105, s37, v105
v_mul_f32 v106, s37, v106
v_mfma_f32_16x16x32_bf16 v[176:179], a[196:199], a[56:59], v[176:179]
s_waitcnt vmcnt(9) lgkmcnt(0)
v_mul_f32 v107, s37, v107
v_mul_f32 v108, s37, v108
v_mfma_f32_16x16x32_bf16 v[184:187], a[192:195], a[44:47], v[184:187]
s_barrier
v_mul_f32 v109, s37, v109
v_mul_f32 v110, s37, v110
v_mfma_f32_16x16x32_bf16 v[184:187], a[196:199], a[60:63], v[184:187]
ds_read_b128 a[192:195], v1 offset:0
v_mul_f32 v111, s37, v111
v_mfma_f32_16x16x32_bf16 v[164:167], a[200:203], a[32:35], v[164:167]
ds_read_b128 a[196:199], v1 offset:6144
v_cvt_pk_bf16_f32 v84, v104, v105
v_mfma_f32_16x16x32_bf16 v[164:167], a[204:207], a[48:51], v[164:167]
s_add_u32 m0, s26, 61440
v_cvt_pk_bf16_f32 v85, v106, v107
v_cvt_pk_bf16_f32 v86, v108, v109
v_mfma_f32_16x16x32_bf16 v[172:175], a[200:203], a[36:39], v[172:175]
buffer_load_dwordx4 v20, s[12:15], s28 offen offset:0 nt lds
v_mfma_f32_16x16x32_bf16 v[172:175], a[204:207], a[52:55], v[172:175]
v_cvt_pk_bf16_f32 v87, v110, v111
v_mul_f32 v112, s37, v112
v_mfma_f32_16x16x32_bf16 v[180:183], a[200:203], a[40:43], v[180:183]
v_mul_f32 v113, s37, v113
v_mul_f32 v114, s37, v114
v_mfma_f32_16x16x32_bf16 v[180:183], a[204:207], a[56:59], v[180:183]
v_mul_f32 v115, s37, v115
v_mul_f32 v116, s37, v116
v_mfma_f32_16x16x32_bf16 v[188:191], a[200:203], a[44:47], v[188:191]
ds_read_b128 a[200:203], v2 offset:0
v_mul_f32 v117, s37, v117
v_mfma_f32_16x16x32_bf16 v[188:191], a[204:207], a[60:63], v[188:191]
ds_read_b128 a[204:207], v2 offset:6144
v_mul_f32 v118, s37, v118
v_mfma_f32_16x16x32_bf16 v[192:195], a[208:211], a[32:35], v[192:195]
v_mul_f32 v119, s37, v119
v_cvt_pk_bf16_f32 v88, v112, v113
v_mfma_f32_16x16x32_bf16 v[192:195], a[212:215], a[48:51], v[192:195]
v_cvt_pk_bf16_f32 v89, v114, v115
v_cvt_pk_bf16_f32 v90, v116, v117
v_mfma_f32_16x16x32_bf16 v[200:203], a[208:211], a[36:39], v[200:203]
v_cvt_pk_bf16_f32 v91, v118, v119
v_mul_f32 v120, s37, v120
v_mfma_f32_16x16x32_bf16 v[200:203], a[212:215], a[52:55], v[200:203]
v_mul_f32 v121, s37, v121
v_mul_f32 v122, s37, v122
v_mfma_f32_16x16x32_bf16 v[208:211], a[208:211], a[40:43], v[208:211]
v_mul_f32 v123, s37, v123
v_mul_f32 v124, s37, v124
v_mfma_f32_16x16x32_bf16 v[208:211], a[212:215], a[56:59], v[208:211]
v_mul_f32 v125, s37, v125
v_mul_f32 v126, s37, v126
v_mfma_f32_16x16x32_bf16 v[216:219], a[208:211], a[44:47], v[216:219]
buffer_load_dwordx4 v21, s[12:15], s28 offen offset:1024 nt lds
v_mfma_f32_16x16x32_bf16 v[216:219], a[212:215], a[60:63], v[216:219]
ds_read_b128 a[208:211], v1 offset:128
v_mul_f32 v127, s37, v127
v_mfma_f32_16x16x32_bf16 v[196:199], a[216:219], a[32:35], v[196:199]
ds_read_b128 a[212:215], v1 offset:6272
v_cvt_pk_bf16_f32 v92, v120, v121
v_mfma_f32_16x16x32_bf16 v[196:199], a[220:223], a[48:51], v[196:199]
v_cvt_pk_bf16_f32 v93, v122, v123
v_cvt_pk_bf16_f32 v94, v124, v125
v_mfma_f32_16x16x32_bf16 v[204:207], a[216:219], a[36:39], v[204:207]
v_cvt_pk_bf16_f32 v95, v126, v127
v_mul_f32 v128, s37, v128
v_mfma_f32_16x16x32_bf16 v[204:207], a[220:223], a[52:55], v[204:207]
v_mul_f32 v129, s37, v129
v_mul_f32 v130, s37, v130
v_mfma_f32_16x16x32_bf16 v[212:215], a[216:219], a[40:43], v[212:215]
v_mul_f32 v131, s37, v131
v_mul_f32 v132, s37, v132
v_mfma_f32_16x16x32_bf16 v[212:215], a[220:223], a[56:59], v[212:215]
v_mul_f32 v133, s37, v133
v_mul_f32 v134, s37, v134
v_mfma_f32_16x16x32_bf16 v[220:223], a[216:219], a[44:47], v[220:223]
ds_read_b128 a[216:219], v2 offset:128
v_mul_f32 v135, s37, v135
v_mfma_f32_16x16x32_bf16 v[220:223], a[220:223], a[60:63], v[220:223]
ds_read_b128 a[220:223], v2 offset:6272
v_cvt_pk_bf16_f32 v96, v128, v129
v_mfma_f32_16x16x32_bf16 v[224:227], a[224:227], a[32:35], v[224:227]
v_cvt_pk_bf16_f32 v97, v130, v131
v_cvt_pk_bf16_f32 v98, v132, v133
v_mfma_f32_16x16x32_bf16 v[224:227], a[228:231], a[48:51], v[224:227]
v_cvt_pk_bf16_f32 v99, v134, v135
v_mul_f32 v136, s37, v136
v_mfma_f32_16x16x32_bf16 v[232:235], a[224:227], a[36:39], v[232:235]
buffer_load_dwordx4 v22, s[12:15], s28 offen offset:2048 nt lds
s_add_u32 s28, s28, 12288
v_mfma_f32_16x16x32_bf16 v[232:235], a[228:231], a[52:55], v[232:235]
v_mul_f32 v137, s37, v137
v_mul_f32 v138, s37, v138
v_mfma_f32_16x16x32_bf16 v[240:243], a[224:227], a[40:43], v[240:243]
v_mul_f32 v139, s37, v139
v_mul_f32 v140, s37, v140
v_mfma_f32_16x16x32_bf16 v[240:243], a[228:231], a[56:59], v[240:243]
v_mul_f32 v141, s37, v141
v_mul_f32 v142, s37, v142
v_mfma_f32_16x16x32_bf16 v[248:251], a[224:227], a[44:47], v[248:251]
ds_read_b128 a[224:227], v1 offset:256
v_mul_f32 v143, s37, v143
v_mfma_f32_16x16x32_bf16 v[248:251], a[228:231], a[60:63], v[248:251]
ds_read_b128 a[228:231], v1 offset:6400
v_cvt_pk_bf16_f32 v100, v136, v137
v_mfma_f32_16x16x32_bf16 v[228:231], a[232:235], a[32:35], v[228:231]
v_cvt_pk_bf16_f32 v101, v138, v139
v_cvt_pk_bf16_f32 v102, v140, v141
v_mfma_f32_16x16x32_bf16 v[228:231], a[236:239], a[48:51], v[228:231]
v_cvt_pk_bf16_f32 v103, v142, v143
v_mul_f32 v144, s37, v144
v_mfma_f32_16x16x32_bf16 v[236:239], a[232:235], a[36:39], v[236:239]
v_mul_f32 v145, s37, v145
v_mul_f32 v146, s37, v146
v_mfma_f32_16x16x32_bf16 v[236:239], a[236:239], a[52:55], v[236:239]
v_mul_f32 v147, s37, v147
v_mul_f32 v148, s37, v148
v_mfma_f32_16x16x32_bf16 v[244:247], a[232:235], a[40:43], v[244:247]
v_mul_f32 v149, s37, v149
v_mul_f32 v150, s37, v150
v_mfma_f32_16x16x32_bf16 v[244:247], a[236:239], a[56:59], v[244:247]
v_mul_f32 v151, s37, v151
v_cvt_pk_bf16_f32 v104, v144, v145
v_mfma_f32_16x16x32_bf16 v[252:255], a[232:235], a[44:47], v[252:255]
ds_read_b128 a[232:235], v2 offset:256
v_cvt_pk_bf16_f32 v105, v146, v147
v_mfma_f32_16x16x32_bf16 v[252:255], a[236:239], a[60:63], v[252:255]
s_waitcnt lgkmcnt(1)
ds_read_b128 a[236:239], v2 offset:6400
v_cvt_pk_bf16_f32 v106, v148, v149
v_mfma_f32_16x16x32_bf16 v[32:35], a[192:195], v[64:67], 0
v_cvt_pk_bf16_f32 v107, v150, v151
v_mul_f32 v152, s37, v152
v_mfma_f32_16x16x32_bf16 v[48:51], a[196:199], v[64:67], 0
v_mul_f32 v153, s37, v153
v_mul_f32 v154, s37, v154
v_mfma_f32_16x16x32_bf16 v[36:39], a[192:195], v[68:71], 0
v_mul_f32 v155, s37, v155
v_mul_f32 v156, s37, v156
v_mfma_f32_16x16x32_bf16 v[52:55], a[196:199], v[68:71], 0
s_add_u32 m0, s25, 36864
v_mul_f32 v157, s37, v157
v_mul_f32 v158, s37, v158
v_mfma_f32_16x16x32_bf16 v[40:43], a[192:195], v[72:75], 0
buffer_load_dwordx4 v17, s[8:11], s27 offen offset:0 nt lds
v_mfma_f32_16x16x32_bf16 v[56:59], a[196:199], v[72:75], 0
v_mul_f32 v159, s37, v159
v_cvt_pk_bf16_f32 v108, v152, v153
v_mfma_f32_16x16x32_bf16 v[44:47], a[192:195], v[76:79], 0
v_cvt_pk_bf16_f32 v109, v154, v155
v_cvt_pk_bf16_f32 v110, v156, v157
v_mfma_f32_16x16x32_bf16 v[60:63], a[196:199], v[76:79], 0
ds_read_b128 a[192:195], v1 offset:12288
v_cvt_pk_bf16_f32 v111, v158, v159
v_mfma_f32_16x16x32_bf16 v[32:35], a[200:203], v[80:83], v[32:35]
ds_read_b128 a[196:199], v2 offset:12288
v_mul_f32 v160, s37, v160
v_mfma_f32_16x16x32_bf16 v[48:51], a[204:207], v[80:83], v[48:51]
v_mul_f32 v161, s37, v161
v_mul_f32 v162, s37, v162
v_mfma_f32_16x16x32_bf16 v[36:39], a[200:203], v[84:87], v[36:39]
v_mul_f32 v163, s37, v163
v_mul_f32 v164, s37, v164
v_mfma_f32_16x16x32_bf16 v[52:55], a[204:207], v[84:87], v[52:55]
buffer_load_dwordx4 v18, s[8:11], s27 offen offset:1024 nt lds
v_mfma_f32_16x16x32_bf16 v[40:43], a[200:203], v[88:91], v[40:43]
v_mul_f32 v165, s37, v165
v_mul_f32 v166, s37, v166
v_mfma_f32_16x16x32_bf16 v[56:59], a[204:207], v[88:91], v[56:59]
v_mul_f32 v167, s37, v167
v_cvt_pk_bf16_f32 v112, v160, v161
v_mfma_f32_16x16x32_bf16 v[44:47], a[200:203], v[92:95], v[44:47]
v_cvt_pk_bf16_f32 v113, v162, v163
v_cvt_pk_bf16_f32 v114, v164, v165
v_mfma_f32_16x16x32_bf16 v[60:63], a[204:207], v[92:95], v[60:63]
ds_read_b128 a[200:203], v1 offset:12416
v_cvt_pk_bf16_f32 v115, v166, v167
v_mfma_f32_16x16x32_bf16 v[32:35], a[208:211], v[96:99], v[32:35]
ds_read_b128 a[204:207], v2 offset:12416
v_mul_f32 v168, s37, v168
v_mfma_f32_16x16x32_bf16 v[48:51], a[212:215], v[96:99], v[48:51]
v_mul_f32 v169, s37, v169
v_mul_f32 v170, s37, v170
v_mfma_f32_16x16x32_bf16 v[36:39], a[208:211], v[100:103], v[36:39]
buffer_load_dwordx4 v19, s[8:11], s27 offen offset:2048 nt lds
s_add_u32 s27, s27, 12288
v_mfma_f32_16x16x32_bf16 v[52:55], a[212:215], v[100:103], v[52:55]
v_mul_f32 v171, s37, v171
v_mul_f32 v172, s37, v172
v_mfma_f32_16x16x32_bf16 v[40:43], a[208:211], v[104:107], v[40:43]
v_mul_f32 v173, s37, v173
v_mul_f32 v174, s37, v174
v_mfma_f32_16x16x32_bf16 v[56:59], a[212:215], v[104:107], v[56:59]
v_mul_f32 v175, s37, v175
v_cvt_pk_bf16_f32 v116, v168, v169
v_mfma_f32_16x16x32_bf16 v[44:47], a[208:211], v[108:111], v[44:47]
v_cvt_pk_bf16_f32 v117, v170, v171
v_cvt_pk_bf16_f32 v118, v172, v173
v_mfma_f32_16x16x32_bf16 v[60:63], a[212:215], v[108:111], v[60:63]
ds_read_b128 a[208:211], v1 offset:12544
v_cvt_pk_bf16_f32 v119, v174, v175
v_mfma_f32_16x16x32_bf16 v[32:35], a[216:219], v[112:115], v[32:35]
s_add_u32 m0, s26, 0
ds_read_b128 a[212:215], v2 offset:12544
v_mul_f32 v176, s37, v176
v_mfma_f32_16x16x32_bf16 v[48:51], a[220:223], v[112:115], v[48:51]
buffer_load_dwordx4 v20, s[12:15], s28 offen offset:0 nt lds
v_mfma_f32_16x16x32_bf16 v[36:39], a[216:219], v[116:119], v[36:39]
v_mul_f32 v177, s37, v177
v_mul_f32 v178, s37, v178
v_mfma_f32_16x16x32_bf16 v[52:55], a[220:223], v[116:119], v[52:55]
v_mul_f32 v179, s37, v179
v_mul_f32 v180, s37, v180
v_mul_f32 v181, s37, v181
v_mul_f32 v182, s37, v182
v_mul_f32 v183, s37, v183
v_cvt_pk_bf16_f32 v120, v176, v177
v_cvt_pk_bf16_f32 v121, v178, v179
v_cvt_pk_bf16_f32 v122, v180, v181
v_cvt_pk_bf16_f32 v123, v182, v183
s_nop 1
v_mfma_f32_16x16x32_bf16 v[40:43], a[216:219], v[120:123], v[40:43]
v_mul_f32 v184, s37, v184
v_mul_f32 v185, s37, v185
v_mfma_f32_16x16x32_bf16 v[56:59], a[220:223], v[120:123], v[56:59]
v_mul_f32 v186, s37, v186
v_mul_f32 v187, s37, v187
v_mul_f32 v188, s37, v188
v_mul_f32 v189, s37, v189
v_mul_f32 v190, s37, v190
v_mul_f32 v191, s37, v191
v_cvt_pk_bf16_f32 v124, v184, v185
v_cvt_pk_bf16_f32 v125, v186, v187
v_cvt_pk_bf16_f32 v126, v188, v189
v_cvt_pk_bf16_f32 v127, v190, v191
s_nop 1
v_mfma_f32_16x16x32_bf16 v[44:47], a[216:219], v[124:127], v[44:47]
v_mul_f32 v192, s37, v192
v_mul_f32 v193, s37, v193
v_mfma_f32_16x16x32_bf16 v[60:63], a[220:223], v[124:127], v[60:63]
ds_read_b128 a[216:219], v1 offset:18432
v_mul_f32 v194, s37, v194
v_mul_f32 v195, s37, v195
v_mul_f32 v196, s37, v196
v_mul_f32 v197, s37, v197
v_mul_f32 v198, s37, v198
v_mul_f32 v199, s37, v199
v_cvt_pk_bf16_f32 v128, v192, v193
v_cvt_pk_bf16_f32 v129, v194, v195
v_cvt_pk_bf16_f32 v130, v196, v197
v_cvt_pk_bf16_f32 v131, v198, v199
s_nop 1
v_mfma_f32_16x16x32_bf16 v[32:35], a[224:227], v[128:131], v[32:35]
buffer_load_dwordx4 v21, s[12:15], s28 offen offset:1024 nt lds
v_mfma_f32_16x16x32_bf16 v[48:51], a[228:231], v[128:131], v[48:51]
ds_read_b128 a[220:223], v2 offset:18432
v_mul_f32 v200, s37, v200
v_mul_f32 v201, s37, v201
v_mul_f32 v202, s37, v202
v_mul_f32 v203, s37, v203
v_mul_f32 v204, s37, v204
v_mul_f32 v205, s37, v205
v_mul_f32 v206, s37, v206
v_mul_f32 v207, s37, v207
v_cvt_pk_bf16_f32 v132, v200, v201
v_cvt_pk_bf16_f32 v133, v202, v203
v_cvt_pk_bf16_f32 v134, v204, v205
v_cvt_pk_bf16_f32 v135, v206, v207
s_nop 1
v_mfma_f32_16x16x32_bf16 v[36:39], a[224:227], v[132:135], v[36:39]
v_mul_f32 v208, s37, v208
v_mul_f32 v209, s37, v209
v_mfma_f32_16x16x32_bf16 v[52:55], a[228:231], v[132:135], v[52:55]
v_mul_f32 v210, s37, v210
v_mul_f32 v211, s37, v211
v_mul_f32 v212, s37, v212
v_mul_f32 v213, s37, v213
v_mul_f32 v214, s37, v214
v_mul_f32 v215, s37, v215
v_cvt_pk_bf16_f32 v136, v208, v209
v_cvt_pk_bf16_f32 v137, v210, v211
v_cvt_pk_bf16_f32 v138, v212, v213
v_cvt_pk_bf16_f32 v139, v214, v215
s_nop 1
v_mfma_f32_16x16x32_bf16 v[40:43], a[224:227], v[136:139], v[40:43]
v_mul_f32 v216, s37, v216
v_mul_f32 v217, s37, v217
v_mfma_f32_16x16x32_bf16 v[56:59], a[228:231], v[136:139], v[56:59]
v_mul_f32 v218, s37, v218
v_mul_f32 v219, s37, v219
v_mul_f32 v220, s37, v220
v_mul_f32 v221, s37, v221
v_mul_f32 v222, s37, v222
v_mul_f32 v223, s37, v223
v_cvt_pk_bf16_f32 v140, v216, v217
v_cvt_pk_bf16_f32 v141, v218, v219
v_cvt_pk_bf16_f32 v142, v220, v221
v_cvt_pk_bf16_f32 v143, v222, v223
s_nop 1
v_mfma_f32_16x16x32_bf16 v[44:47], a[224:227], v[140:143], v[44:47]
v_mul_f32 v224, s37, v224
v_mul_f32 v225, s37, v225
v_mfma_f32_16x16x32_bf16 v[60:63], a[228:231], v[140:143], v[60:63]
s_waitcnt lgkmcnt(0)
buffer_load_dwordx4 v22, s[12:15], s28 offen offset:2048 nt lds
s_add_u32 s28, s28, 12288
v_mul_f32 v226, s37, v226
v_mul_f32 v227, s37, v227
v_mul_f32 v228, s37, v228
v_mul_f32 v229, s37, v229
v_mul_f32 v230, s37, v230
v_mul_f32 v231, s37, v231
v_cvt_pk_bf16_f32 v144, v224, v225
v_cvt_pk_bf16_f32 v145, v226, v227
v_cvt_pk_bf16_f32 v146, v228, v229
v_cvt_pk_bf16_f32 v147, v230, v231
s_nop 1
v_mfma_f32_16x16x32_bf16 v[32:35], a[232:235], v[144:147], v[32:35]
ds_read_b128 a[224:227], v1 offset:18560
v_mul_f32 v232, s37, v232
v_mfma_f32_16x16x32_bf16 v[48:51], a[236:239], v[144:147], v[48:51]
ds_read_b128 a[228:231], v2 offset:18560
v_mul_f32 v233, s37, v233
v_mul_f32 v234, s37, v234
v_mul_f32 v235, s37, v235
v_mul_f32 v236, s37, v236
v_mul_f32 v237, s37, v237
v_mul_f32 v238, s37, v238
v_mul_f32 v239, s37, v239
v_cvt_pk_bf16_f32 v148, v232, v233
v_cvt_pk_bf16_f32 v149, v234, v235
v_cvt_pk_bf16_f32 v150, v236, v237
v_cvt_pk_bf16_f32 v151, v238, v239
s_nop 1
v_mfma_f32_16x16x32_bf16 v[36:39], a[232:235], v[148:151], v[36:39]
v_mul_f32 v240, s37, v240
v_mul_f32 v241, s37, v241
v_mfma_f32_16x16x32_bf16 v[52:55], a[236:239], v[148:151], v[52:55]
v_mul_f32 v242, s37, v242
v_mul_f32 v243, s37, v243
v_mul_f32 v244, s37, v244
v_mul_f32 v245, s37, v245
v_mul_f32 v246, s37, v246
v_mul_f32 v247, s37, v247
v_cvt_pk_bf16_f32 v152, v240, v241
v_cvt_pk_bf16_f32 v153, v242, v243
v_cvt_pk_bf16_f32 v154, v244, v245
v_cvt_pk_bf16_f32 v155, v246, v247
s_nop 1
v_mfma_f32_16x16x32_bf16 v[40:43], a[232:235], v[152:155], v[40:43]
v_mul_f32 v248, s37, v248
v_mul_f32 v249, s37, v249
v_mfma_f32_16x16x32_bf16 v[56:59], a[236:239], v[152:155], v[56:59]
v_mul_f32 v250, s37, v250
v_mul_f32 v251, s37, v251
v_mul_f32 v252, s37, v252
v_mul_f32 v253, s37, v253
v_mul_f32 v254, s37, v254
v_mul_f32 v255, s37, v255
v_cvt_pk_bf16_f32 v156, v248, v249
v_cvt_pk_bf16_f32 v157, v250, v251
v_cvt_pk_bf16_f32 v158, v252, v253
v_cvt_pk_bf16_f32 v159, v254, v255
s_nop 1
v_mfma_f32_16x16x32_bf16 v[44:47], a[232:235], v[156:159], v[44:47]
v_mov_b32 v192, 0
v_mov_b32 v193, 0
v_mfma_f32_16x16x32_bf16 v[60:63], a[236:239], v[156:159], v[60:63]
ds_read_b128 a[232:235], v1 offset:18688
v_mov_b32 v194, 0
v_mov_b32 v195, 0
v_mov_b32 v196, 0
v_mov_b32 v197, 0
v_mov_b32 v198, 0
v_mov_b32 v199, 0
v_mov_b32 v200, 0
v_mov_b32 v201, 0
v_mov_b32 v202, 0
v_mov_b32 v203, 0
v_mov_b32 v204, 0
v_mov_b32 v205, 0
v_mov_b32 v206, 0
v_mov_b32 v207, 0
v_mov_b32 v208, 0
v_mov_b32 v209, 0
v_mov_b32 v210, 0
v_mov_b32 v211, 0
v_lshlrev_b32 v255, 4, v0
v_accvgpr_read_b32 v23, a240
v_accvgpr_read_b32 v24, a241
v_accvgpr_read_b32 v25, a242
v_add_u32 v26, 73728, v13
v_add_u32 v27, 73728, v14
v_add_u32 v28, 73728, v15
v_add_u32 v29, 73728, v16
v_exp_f32 v216, v32
v_exp_f32 v217, v33
v_exp_f32 v218, v34
v_exp_f32 v219, v35
v_add_f32 v212, v216, v217
v_cvt_pk_bf16_f32 v160, v216, v217
v_add_f32 v212, v212, v218
v_add_f32 v212, v212, v219
v_cvt_pk_bf16_f32 v161, v218, v219
v_exp_f32 v220, v36
v_exp_f32 v221, v37
v_exp_f32 v222, v38
v_exp_f32 v223, v39
v_add_f32 v213, v220, v221
v_cvt_pk_bf16_f32 v164, v220, v221
v_add_f32 v213, v213, v222
v_add_f32 v213, v213, v223
v_cvt_pk_bf16_f32 v165, v222, v223
v_exp_f32 v224, v40
v_exp_f32 v225, v41
v_exp_f32 v226, v42
v_exp_f32 v227, v43
v_add_f32 v214, v224, v225
v_cvt_pk_bf16_f32 v168, v224, v225
v_add_f32 v214, v214, v226
v_add_f32 v214, v214, v227
v_cvt_pk_bf16_f32 v169, v226, v227
v_exp_f32 v228, v44
v_exp_f32 v229, v45
v_exp_f32 v230, v46
v_exp_f32 v231, v47
v_add_f32 v215, v228, v229
v_cvt_pk_bf16_f32 v172, v228, v229
v_add_f32 v215, v215, v230
v_add_f32 v215, v215, v231
v_cvt_pk_bf16_f32 v173, v230, v231
v_exp_f32 v216, v48
v_exp_f32 v217, v49
v_exp_f32 v218, v50
v_exp_f32 v219, v51
v_add_f32 v212, v212, v216
v_add_f32 v212, v212, v217
v_cvt_pk_bf16_f32 v162, v216, v217
v_add_f32 v212, v212, v218
v_add_f32 v212, v212, v219
v_cvt_pk_bf16_f32 v163, v218, v219
v_exp_f32 v220, v52
v_exp_f32 v221, v53
v_exp_f32 v222, v54
v_exp_f32 v223, v55
v_add_f32 v213, v213, v220
v_add_f32 v213, v213, v221
v_cvt_pk_bf16_f32 v166, v220, v221
v_add_f32 v213, v213, v222
v_add_f32 v213, v213, v223
v_cvt_pk_bf16_f32 v167, v222, v223
v_max3_f32 v232, v56, v57, v58
v_max3_f32 v233, v59, v60, v61
v_max3_f32 v232, v232, v62, v63
v_max3_f32 v233, v233, v214, v215
v_max3_f32 v232, v232, v233, v212
v_max_f32 v232, v232, v213
v_cmp_lt_f32 vcc, 0x42800000, v232
v_min3_f32 v234, v212, v213, v214
v_min_f32 v234, v234, v215
v_mov_b32 v235, 0x35800000
v_cmp_nge_f32 s[40:41], v234, v235
s_nop 1
s_or_b64 vcc, vcc, s[40:41]
s_cbranch_vccnz L1_stubf
L1_backf:
s_mov_b32 s35, 0
v_mfma_f32_16x16x32_bf16 v[32:35], a[192:195], v[64:67], v[192:195]
ds_read_b128 a[236:239], v2 offset:18688
v_add_f32 v208, v208, v212
v_mfma_f32_16x16x32_bf16 v[32:35], a[196:199], v[80:83], v[32:35]
v_exp_f32 v224, v56
v_mfma_f32_16x16x32_bf16 v[32:35], a[200:203], v[96:99], v[32:35]
s_add_u32 s29, s26, 36864
v_exp_f32 v225, v57
v_mfma_f32_16x16x32_bf16 v[36:39], a[192:195], v[68:71], v[196:199]
v_exp_f32 v226, v58
v_mfma_f32_16x16x32_bf16 v[36:39], a[196:199], v[84:87], v[36:39]
v_exp_f32 v227, v59
v_mfma_f32_16x16x32_bf16 v[36:39], a[200:203], v[100:103], v[36:39]
v_exp_f32 v228, v60
v_mfma_f32_16x16x32_bf16 v[40:43], a[192:195], v[72:75], v[200:203]
v_exp_f32 v229, v61
v_mfma_f32_16x16x32_bf16 v[40:43], a[196:199], v[88:91], v[40:43]
v_exp_f32 v230, v62
v_mfma_f32_16x16x32_bf16 v[40:43], a[200:203], v[104:107], v[40:43]
v_exp_f32 v231, v63
v_mfma_f32_16x16x32_bf16 v[44:47], a[192:195], v[76:79], v[204:207]
s_add_u32 m0, s26, 12288
ds_read_b64_tr_b16 a[192:193], v5 offset:24576
v_add_f32 v209, v209, v213
v_mfma_f32_16x16x32_bf16 v[44:47], a[196:199], v[92:95], v[44:47]
buffer_load_dwordx4 v20, s[12:15], s28 offen offset:0 nt lds
v_mfma_f32_16x16x32_bf16 v[44:47], a[200:203], v[108:111], v[44:47]
ds_read_b64_tr_b16 a[194:195], v5 offset:30720
v_add_f32 v210, v210, v214
v_mfma_f32_16x16x32_bf16 v[32:35], a[204:207], v[112:115], v[32:35]
ds_read_b64_tr_b16 a[196:197], v6 offset:24576
v_add_f32 v211, v211, v215
v_mfma_f32_16x16x32_bf16 v[32:35], a[208:211], v[128:131], v[32:35]
ds_read_b64_tr_b16 a[198:199], v6 offset:30720
v_add_f32 v210, v210, v224
v_mfma_f32_16x16x32_bf16 v[32:35], a[212:215], v[144:147], v[32:35]
ds_read_b64_tr_b16 a[200:201], v7 offset:24576
v_add_f32 v210, v210, v225
v_mfma_f32_16x16x32_bf16 v[36:39], a[204:207], v[116:119], v[36:39]
ds_read_b64_tr_b16 a[202:203], v7 offset:30720
v_cvt_pk_bf16_f32 v170, v224, v225
v_mfma_f32_16x16x32_bf16 v[36:39], a[208:211], v[132:135], v[36:39]
v_add_f32 v210, v210, v226
v_add_f32 v210, v210, v227
v_mfma_f32_16x16x32_bf16 v[36:39], a[212:215], v[148:151], v[36:39]
v_exp_f32 v216, v32
v_mfma_f32_16x16x32_bf16 v[40:43], a[204:207], v[120:123], v[40:43]
v_exp_f32 v217, v33
v_mfma_f32_16x16x32_bf16 v[40:43], a[208:211], v[136:139], v[40:43]
v_exp_f32 v218, v34
v_mfma_f32_16x16x32_bf16 v[40:43], a[212:215], v[152:155], v[40:43]
v_exp_f32 v219, v35
v_mfma_f32_16x16x32_bf16 v[44:47], a[204:207], v[124:127], v[44:47]
ds_read_b64_tr_b16 a[204:205], v8 offset:24576
v_cvt_pk_bf16_f32 v171, v226, v227
v_mfma_f32_16x16x32_bf16 v[44:47], a[208:211], v[140:143], v[44:47]
ds_read_b64_tr_b16 a[206:207], v8 offset:30720
v_add_f32 v211, v211, v228
v_mfma_f32_16x16x32_bf16 v[44:47], a[212:215], v[156:159], v[44:47]
ds_read_b64_tr_b16 a[208:209], v5 offset:24704
v_add_f32 v211, v211, v229
v_mfma_f32_16x16x32_bf16 v[48:51], a[216:219], v[64:67], v[192:195]
ds_read_b64_tr_b16 a[210:211], v5 offset:30848
v_cvt_pk_bf16_f32 v174, v228, v229
v_mfma_f32_16x16x32_bf16 v[48:51], a[220:223], v[80:83], v[48:51]
s_waitcnt lgkmcnt(4)
ds_read_b64_tr_b16 a[212:213], v6 offset:24704
v_add_f32 v211, v211, v230
v_mfma_f32_16x16x32_bf16 v[48:51], a[224:227], v[96:99], v[48:51]
buffer_load_dwordx4 v21, s[12:15], s28 offen offset:1024 nt lds
v_mfma_f32_16x16x32_bf16 v[52:55], a[216:219], v[68:71], v[196:199]
ds_read_b64_tr_b16 a[214:215], v6 offset:30848
v_add_f32 v211, v211, v231
v_mfma_f32_16x16x32_bf16 v[52:55], a[220:223], v[84:87], v[52:55]
v_exp_f32 v220, v36
v_mfma_f32_16x16x32_bf16 v[52:55], a[224:227], v[100:103], v[52:55]
v_exp_f32 v221, v37
v_mfma_f32_16x16x32_bf16 v[56:59], a[216:219], v[72:75], v[200:203]
v_exp_f32 v222, v38
v_mfma_f32_16x16x32_bf16 v[56:59], a[220:223], v[88:91], v[56:59]
v_exp_f32 v223, v39
v_mfma_f32_16x16x32_bf16 v[56:59], a[224:227], v[104:107], v[56:59]
v_exp_f32 v224, v40
v_mfma_f32_16x16x32_bf16 v[60:63], a[216:219], v[76:79], v[204:207]
ds_read_b64_tr_b16 a[216:217], v7 offset:24704
v_cvt_pk_bf16_f32 v175, v230, v231
v_mfma_f32_16x16x32_bf16 v[60:63], a[220:223], v[92:95], v[60:63]
ds_read_b64_tr_b16 a[218:219], v7 offset:30848
v_add_f32 v212, v216, v217
v_mfma_f32_16x16x32_bf16 v[60:63], a[224:227], v[108:111], v[60:63]
ds_read_b64_tr_b16 a[220:221], v8 offset:24704
v_cvt_pk_bf16_f32 v176, v216, v217
v_mfma_f32_16x16x32_bf16 v[48:51], a[228:231], v[112:115], v[48:51]
ds_read_b64_tr_b16 a[222:223], v8 offset:30848
v_add_f32 v212, v212, v218
v_mfma_f32_16x16x32_bf16 v[48:51], a[232:235], v[128:131], v[48:51]
ds_read_b64_tr_b16 a[224:225], v5 offset:24832
v_add_f32 v212, v212, v219
v_mfma_f32_16x16x32_bf16 v[48:51], a[236:239], v[144:147], v[48:51]
ds_read_b64_tr_b16 a[226:227], v5 offset:30976
v_cvt_pk_bf16_f32 v177, v218, v219
v_mfma_f32_16x16x32_bf16 v[52:55], a[228:231], v[116:119], v[52:55]
v_exp_f32 v225, v41
v_mfma_f32_16x16x32_bf16 v[52:55], a[232:235], v[132:135], v[52:55]
v_exp_f32 v226, v42
v_mfma_f32_16x16x32_bf16 v[52:55], a[236:239], v[148:151], v[52:55]
v_exp_f32 v227, v43
v_mfma_f32_16x16x32_bf16 v[56:59], a[228:231], v[120:123], v[56:59]
buffer_load_dwordx4 v22, s[12:15], s28 offen offset:2048 nt lds
v_mfma_f32_16x16x32_bf16 v[56:59], a[232:235], v[136:139], v[56:59]
s_add_u32 s28, s28, 12288
v_exp_f32 v228, v44
v_mfma_f32_16x16x32_bf16 v[56:59], a[236:239], v[152:155], v[56:59]
v_exp_f32 v229, v45
v_mfma_f32_16x16x32_bf16 v[60:63], a[228:231], v[124:127], v[60:63]
ds_read_b64_tr_b16 a[228:229], v6 offset:24832
v_add_f32 v213, v220, v221
v_mfma_f32_16x16x32_bf16 v[60:63], a[232:235], v[140:143], v[60:63]
ds_read_b64_tr_b16 a[230:231], v6 offset:30976
v_cvt_pk_bf16_f32 v180, v220, v221
v_mfma_f32_16x16x32_bf16 v[60:63], a[236:239], v[156:159], v[60:63]
ds_read_b64_tr_b16 a[232:233], v7 offset:24832
v_add_f32 v213, v213, v222
v_mfma_f32_16x16x32_bf16 a[0:3], a[192:195], v[160:163], 0
ds_read_b64_tr_b16 a[234:235], v7 offset:30976
v_add_f32 v213, v213, v223
v_mfma_f32_16x16x32_bf16 a[4:7], a[192:195], v[164:167], 0
ds_read_b64_tr_b16 a[236:237], v8 offset:24832
v_cvt_pk_bf16_f32 v181, v222, v223
v_mfma_f32_16x16x32_bf16 a[8:11], a[192:195], v[168:171], 0
ds_read_b64_tr_b16 a[238:239], v8 offset:30976
v_add_f32 v214, v224, v225
v_mfma_f32_16x16x32_bf16 a[12:15], a[192:195], v[172:175], 0
v_exp_f32 v230, v46
v_mfma_f32_16x16x32_bf16 a[28:31], a[196:199], v[172:175], 0
v_exp_f32 v231, v47
v_mfma_f32_16x16x32_bf16 a[24:27], a[196:199], v[168:171], 0
s_waitcnt vmcnt(15) lgkmcnt(0)
v_exp_f32 v216, v48
v_mfma_f32_16x16x32_bf16 a[20:23], a[196:199], v[164:167], 0
s_barrier
v_exp_f32 v217, v49
v_mfma_f32_16x16x32_bf16 a[16:19], a[196:199], v[160:163], 0
ds_read_b128 a[192:195], v1 offset:24576
v_cvt_pk_bf16_f32 v184, v224, v225
v_mfma_f32_16x16x32_bf16 a[32:35], a[200:203], v[160:163], 0
ds_read_b128 a[196:199], v2 offset:24576
v_add_f32 v214, v214, v226
v_mfma_f32_16x16x32_bf16 a[36:39], a[200:203], v[164:167], 0
s_add_u32 m0, s26, 24576
v_exp_f32 v218, v50
v_mfma_f32_16x16x32_bf16 a[40:43], a[200:203], v[168:171], 0
buffer_load_dwordx4 v20, s[12:15], s28 offen offset:0 nt lds
v_mfma_f32_16x16x32_bf16 a[44:47], a[200:203], v[172:175], 0
ds_read_b128 a[200:203], v1 offset:24704
v_add_f32 v214, v214, v227
v_mfma_f32_16x16x32_bf16 a[60:63], a[204:207], v[172:175], 0
v_exp_f32 v219, v51
v_mfma_f32_16x16x32_bf16 a[56:59], a[204:207], v[168:171], 0
v_exp_f32 v220, v52
v_mfma_f32_16x16x32_bf16 a[52:55], a[204:207], v[164:167], 0
v_exp_f32 v221, v53
v_mfma_f32_16x16x32_bf16 a[48:51], a[204:207], v[160:163], 0
ds_read_b128 a[204:207], v2 offset:24704
v_cvt_pk_bf16_f32 v185, v226, v227
v_mfma_f32_16x16x32_bf16 a[64:67], a[208:211], v[160:163], 0
v_exp_f32 v222, v54
v_mfma_f32_16x16x32_bf16 a[68:71], a[208:211], v[164:167], 0
v_exp_f32 v223, v55
v_mfma_f32_16x16x32_bf16 a[72:75], a[208:211], v[168:171], 0
v_add_f32 v215, v228, v229
v_cvt_pk_bf16_f32 v188, v228, v229
v_mfma_f32_16x16x32_bf16 a[76:79], a[208:211], v[172:175], 0
ds_read_b128 a[208:211], v1 offset:24832
v_add_f32 v215, v215, v230
v_mfma_f32_16x16x32_bf16 a[92:95], a[212:215], v[172:175], 0
v_add_f32 v215, v215, v231
v_cvt_pk_bf16_f32 v189, v230, v231
v_mfma_f32_16x16x32_bf16 a[88:91], a[212:215], v[168:171], 0
v_add_f32 v212, v212, v216
v_add_f32 v212, v212, v217
v_mfma_f32_16x16x32_bf16 a[84:87], a[212:215], v[164:167], 0
v_cvt_pk_bf16_f32 v178, v216, v217
v_add_f32 v212, v212, v218
v_mfma_f32_16x16x32_bf16 a[80:83], a[212:215], v[160:163], 0
ds_read_b128 a[212:215], v2 offset:24832
v_add_f32 v212, v212, v219
v_mfma_f32_16x16x32_bf16 a[96:99], a[216:219], v[160:163], 0
v_cvt_pk_bf16_f32 v179, v218, v219
v_add_f32 v213, v213, v220
v_mfma_f32_16x16x32_bf16 a[100:103], a[216:219], v[164:167], 0
buffer_load_dwordx4 v21, s[12:15], s28 offen offset:1024 nt lds
v_mfma_f32_16x16x32_bf16 a[104:107], a[216:219], v[168:171], 0
v_add_f32 v213, v213, v221
v_cvt_pk_bf16_f32 v182, v220, v221
v_mfma_f32_16x16x32_bf16 a[108:111], a[216:219], v[172:175], 0
ds_read_b128 a[216:219], v1 offset:30720
v_add_f32 v213, v213, v222
v_mfma_f32_16x16x32_bf16 a[124:127], a[220:223], v[172:175], 0
v_add_f32 v213, v213, v223
v_cvt_pk_bf16_f32 v183, v222, v223
v_mfma_f32_16x16x32_bf16 a[120:123], a[220:223], v[168:171], 0
v_max3_f32 v232, v56, v57, v58
v_max3_f32 v233, v59, v60, v61
v_mfma_f32_16x16x32_bf16 a[116:119], a[220:223], v[164:167], 0
v_max3_f32 v232, v232, v62, v63
v_max3_f32 v233, v233, v214, v215
v_mfma_f32_16x16x32_bf16 a[112:115], a[220:223], v[160:163], 0
ds_read_b128 a[220:223], v2 offset:30720
v_max3_f32 v232, v232, v233, v212
v_mfma_f32_16x16x32_bf16 a[128:131], a[224:227], v[160:163], 0
v_max_f32 v232, v232, v213
v_cmp_lt_f32 vcc, 0x42800000, v232
v_mfma_f32_16x16x32_bf16 a[132:135], a[224:227], v[164:167], 0
v_mfma_f32_16x16x32_bf16 a[136:139], a[224:227], v[168:171], 0
v_mfma_f32_16x16x32_bf16 a[140:143], a[224:227], v[172:175], 0
ds_read_b128 a[224:227], v1 offset:30848
v_mfma_f32_16x16x32_bf16 a[156:159], a[228:231], v[172:175], 0
v_mfma_f32_16x16x32_bf16 a[152:155], a[228:231], v[168:171], 0
v_mfma_f32_16x16x32_bf16 a[148:151], a[228:231], v[164:167], 0
v_mfma_f32_16x16x32_bf16 a[144:147], a[228:231], v[160:163], 0
ds_read_b128 a[228:231], v2 offset:30848
v_mfma_f32_16x16x32_bf16 a[160:163], a[232:235], v[160:163], 0
buffer_load_dwordx4 v22, s[12:15], s28 offen offset:2048 nt lds
v_mfma_f32_16x16x32_bf16 a[164:167], a[232:235], v[164:167], 0
s_add_u32 s28, s28, 12288
v_mfma_f32_16x16x32_bf16 a[168:171], a[232:235], v[168:171], 0
v_mfma_f32_16x16x32_bf16 a[172:175], a[232:235], v[172:175], 0
ds_read_b128 a[232:235], v1 offset:30976
v_mfma_f32_16x16x32_bf16 a[188:191], a[236:239], v[172:175], 0
v_mfma_f32_16x16x32_bf16 a[184:187], a[236:239], v[168:171], 0
s_waitcnt lgkmcnt(1)
v_mfma_f32_16x16x32_bf16 a[180:183], a[236:239], v[164:167], 0
v_mfma_f32_16x16x32_bf16 a[176:179], a[236:239], v[160:163], 0
s_cbranch_vccnz L1_stubp
L1_backp:
L1_loop:
v_mfma_f32_16x16x32_bf16 v[32:35], a[192:195], v[64:67], v[192:195]
ds_read_b128 a[236:239], v2 offset:30976
v_add_f32 v208, v208, v212
v_mfma_f32_16x16x32_bf16 v[32:35], a[196:199], v[80:83], v[32:35]
v_exp_f32 v224, v56
v_mfma_f32_16x16x32_bf16 v[32:35], a[200:203], v[96:99], v[32:35]
v_exp_f32 v225, v57
v_mfma_f32_16x16x32_bf16 v[36:39], a[192:195], v[68:71], v[196:199]
v_exp_f32 v226, v58
v_mfma_f32_16x16x32_bf16 v[36:39], a[196:199], v[84:87], v[36:39]
v_exp_f32 v227, v59
v_mfma_f32_16x16x32_bf16 v[36:39], a[200:203], v[100:103], v[36:39]
v_exp_f32 v228, v60
v_mfma_f32_16x16x32_bf16 v[40:43], a[192:195], v[72:75], v[200:203]
v_exp_f32 v229, v61
v_mfma_f32_16x16x32_bf16 v[40:43], a[196:199], v[88:91], v[40:43]
s_add_u32 m0, s25, 49152
v_exp_f32 v230, v62
v_mfma_f32_16x16x32_bf16 v[40:43], a[200:203], v[104:107], v[40:43]
s_waitcnt vmcnt(3)
buffer_load_dwordx4 v17, s[8:11], s27 offen offset:0 nt lds
v_mfma_f32_16x16x32_bf16 v[44:47], a[192:195], v[76:79], v[204:207]
ds_read_b64_tr_b16 a[192:193], v9 offset:0
v_add_f32 v209, v209, v213
v_mfma_f32_16x16x32_bf16 v[44:47], a[196:199], v[92:95], v[44:47]
ds_read_b64_tr_b16 a[194:195], v9 offset:6144
v_add_f32 v210, v210, v214
v_mfma_f32_16x16x32_bf16 v[44:47], a[200:203], v[108:111], v[44:47]
ds_read_b64_tr_b16 a[196:197], v10 offset:0
v_add_f32 v211, v211, v215
v_mfma_f32_16x16x32_bf16 v[32:35], a[204:207], v[112:115], v[32:35]
ds_read_b64_tr_b16 a[198:199], v10 offset:6144
v_add_f32 v210, v210, v224
v_mfma_f32_16x16x32_bf16 v[32:35], a[208:211], v[128:131], v[32:35]
ds_read_b64_tr_b16 a[200:201], v11 offset:0
v_add_f32 v210, v210, v225
v_mfma_f32_16x16x32_bf16 v[32:35], a[212:215], v[144:147], v[32:35]
ds_read_b64_tr_b16 a[202:203], v11 offset:6144
v_cvt_pk_bf16_f32 v186, v224, v225
v_mfma_f32_16x16x32_bf16 v[36:39], a[204:207], v[116:119], v[36:39]
v_exp_f32 v231, v63
v_mfma_f32_16x16x32_bf16 v[36:39], a[208:211], v[132:135], v[36:39]
v_add_f32 v210, v210, v226
v_add_f32 v210, v210, v227
v_mfma_f32_16x16x32_bf16 v[36:39], a[212:215], v[148:151], v[36:39]
v_exp_f32 v216, v32
v_mfma_f32_16x16x32_bf16 v[40:43], a[204:207], v[120:123], v[40:43]
v_exp_f32 v217, v33
v_mfma_f32_16x16x32_bf16 v[40:43], a[208:211], v[136:139], v[40:43]
v_exp_f32 v218, v34
v_mfma_f32_16x16x32_bf16 v[40:43], a[212:215], v[152:155], v[40:43]
v_exp_f32 v219, v35
v_mfma_f32_16x16x32_bf16 v[44:47], a[204:207], v[124:127], v[44:47]
ds_read_b64_tr_b16 a[204:205], v12 offset:0
v_cvt_pk_bf16_f32 v187, v226, v227
v_mfma_f32_16x16x32_bf16 v[44:47], a[208:211], v[140:143], v[44:47]
ds_read_b64_tr_b16 a[206:207], v12 offset:6144
v_add_f32 v211, v211, v228
v_mfma_f32_16x16x32_bf16 v[44:47], a[212:215], v[156:159], v[44:47]
ds_read_b64_tr_b16 a[208:209], v9 offset:128
v_add_f32 v211, v211, v229
v_mfma_f32_16x16x32_bf16 v[48:51], a[216:219], v[64:67], v[192:195]
ds_read_b64_tr_b16 a[210:211], v9 offset:6272
v_cvt_pk_bf16_f32 v190, v228, v229
v_mfma_f32_16x16x32_bf16 v[48:51], a[220:223], v[80:83], v[48:51]
s_waitcnt vmcnt(3)
buffer_load_dwordx4 v18, s[8:11], s27 offen offset:1024 nt lds
v_mfma_f32_16x16x32_bf16 v[48:51], a[224:227], v[96:99], v[48:51]
ds_read_b64_tr_b16 a[212:213], v10 offset:128
v_add_f32 v211, v211, v230
v_mfma_f32_16x16x32_bf16 v[52:55], a[216:219], v[68:71], v[196:199]
ds_read_b64_tr_b16 a[214:215], v10 offset:6272
v_add_f32 v211, v211, v231
v_mfma_f32_16x16x32_bf16 v[52:55], a[220:223], v[84:87], v[52:55]
v_exp_f32 v220, v36
v_mfma_f32_16x16x32_bf16 v[52:55], a[224:227], v[100:103], v[52:55]
v_exp_f32 v221, v37
v_mfma_f32_16x16x32_bf16 v[56:59], a[216:219], v[72:75], v[200:203]
v_exp_f32 v222, v38
v_mfma_f32_16x16x32_bf16 v[56:59], a[220:223], v[88:91], v[56:59]
v_exp_f32 v223, v39
v_mfma_f32_16x16x32_bf16 v[56:59], a[224:227], v[104:107], v[56:59]
v_exp_f32 v224, v40
v_mfma_f32_16x16x32_bf16 v[60:63], a[216:219], v[76:79], v[204:207]
ds_read_b64_tr_b16 a[216:217], v11 offset:128
v_cvt_pk_bf16_f32 v191, v230, v231
v_mfma_f32_16x16x32_bf16 v[60:63], a[220:223], v[92:95], v[60:63]
ds_read_b64_tr_b16 a[218:219], v11 offset:6272
v_add_f32 v212, v216, v217
v_mfma_f32_16x16x32_bf16 v[60:63], a[224:227], v[108:111], v[60:63]
ds_read_b64_tr_b16 a[220:221], v12 offset:128
v_cvt_pk_bf16_f32 v160, v216, v217
v_mfma_f32_16x16x32_bf16 v[48:51], a[228:231], v[112:115], v[48:51]
s_waitcnt lgkmcnt(3)
ds_read_b64_tr_b16 a[222:223], v12 offset:6272
v_add_f32 v212, v212, v218
v_mfma_f32_16x16x32_bf16 v[48:51], a[232:235], v[128:131], v[48:51]
ds_read_b64_tr_b16 a[224:225], v9 offset:256
v_add_f32 v212, v212, v219
v_mfma_f32_16x16x32_bf16 v[48:51], a[236:239], v[144:147], v[48:51]
ds_read_b64_tr_b16 a[226:227], v9 offset:6400
v_cvt_pk_bf16_f32 v161, v218, v219
v_mfma_f32_16x16x32_bf16 v[52:55], a[228:231], v[116:119], v[52:55]
v_exp_f32 v225, v41
v_mfma_f32_16x16x32_bf16 v[52:55], a[232:235], v[132:135], v[52:55]
v_exp_f32 v226, v42
v_mfma_f32_16x16x32_bf16 v[52:55], a[236:239], v[148:151], v[52:55]
v_exp_f32 v227, v43
v_mfma_f32_16x16x32_bf16 v[56:59], a[228:231], v[120:123], v[56:59]
s_waitcnt vmcnt(3)
buffer_load_dwordx4 v19, s[8:11], s27 offen offset:2048 nt lds
v_mfma_f32_16x16x32_bf16 v[56:59], a[232:235], v[136:139], v[56:59]
s_add_u32 s27, s27, 12288
v_exp_f32 v228, v44
v_mfma_f32_16x16x32_bf16 v[56:59], a[236:239], v[152:155], v[56:59]
v_exp_f32 v229, v45
v_mfma_f32_16x16x32_bf16 v[60:63], a[228:231], v[124:127], v[60:63]
ds_read_b64_tr_b16 a[228:229], v10 offset:256
v_add_f32 v213, v220, v221
v_mfma_f32_16x16x32_bf16 v[60:63], a[232:235], v[140:143], v[60:63]
ds_read_b64_tr_b16 a[230:231], v10 offset:6400
v_cvt_pk_bf16_f32 v164, v220, v221
v_mfma_f32_16x16x32_bf16 v[60:63], a[236:239], v[156:159], v[60:63]
ds_read_b64_tr_b16 a[232:233], v11 offset:256
v_add_f32 v213, v213, v222
v_mfma_f32_16x16x32_bf16 a[0:3], a[192:195], v[176:179], a[0:3]
ds_read_b64_tr_b16 a[234:235], v11 offset:6400
v_add_f32 v213, v213, v223
v_mfma_f32_16x16x32_bf16 a[4:7], a[192:195], v[180:183], a[4:7]
ds_read_b64_tr_b16 a[236:237], v12 offset:256
v_cvt_pk_bf16_f32 v165, v222, v223
v_mfma_f32_16x16x32_bf16 a[8:11], a[192:195], v[184:187], a[8:11]
ds_read_b64_tr_b16 a[238:239], v12 offset:6400
v_add_f32 v214, v224, v225
v_mfma_f32_16x16x32_bf16 a[12:15], a[192:195], v[188:191], a[12:15]
v_exp_f32 v230, v46
v_mfma_f32_16x16x32_bf16 a[28:31], a[196:199], v[188:191], a[28:31]
v_exp_f32 v231, v47
v_mfma_f32_16x16x32_bf16 a[24:27], a[196:199], v[184:187], a[24:27]
s_waitcnt vmcnt(3) lgkmcnt(0)
v_exp_f32 v216, v48
v_mfma_f32_16x16x32_bf16 a[20:23], a[196:199], v[180:183], a[20:23]
s_barrier
v_exp_f32 v217, v49
v_mfma_f32_16x16x32_bf16 a[16:19], a[196:199], v[176:179], a[16:19]
ds_read_b128 a[192:195], v3 offset:0
v_cvt_pk_bf16_f32 v168, v224, v225
v_mfma_f32_16x16x32_bf16 a[32:35], a[200:203], v[176:179], a[32:35]
ds_read_b128 a[196:199], v4 offset:0
v_add_f32 v214, v214, v226
v_mfma_f32_16x16x32_bf16 a[36:39], a[200:203], v[180:183], a[36:39]
v_exp_f32 v218, v50
v_mfma_f32_16x16x32_bf16 a[40:43], a[200:203], v[184:187], a[40:43]
s_mov_b32 m0, s29
v_exp_f32 v219, v51
v_mfma_f32_16x16x32_bf16 a[44:47], a[200:203], v[188:191], a[44:47]
s_waitcnt vmcnt(3)
buffer_load_dwordx4 v20, s[12:15], s28 offen offset:0 nt lds
v_mfma_f32_16x16x32_bf16 a[60:63], a[204:207], v[188:191], a[60:63]
ds_read_b128 a[200:203], v3 offset:128
v_add_f32 v214, v214, v227
v_mfma_f32_16x16x32_bf16 a[56:59], a[204:207], v[184:187], a[56:59]
s_add_u32 s29, s29, 12288
v_exp_f32 v220, v52
v_mfma_f32_16x16x32_bf16 a[52:55], a[204:207], v[180:183], a[52:55]
v_exp_f32 v221, v53
v_mfma_f32_16x16x32_bf16 a[48:51], a[204:207], v[176:179], a[48:51]
s_cmp_eq_u32 s29, s25
s_cselect_b32 s29, s26, s29
ds_read_b128 a[204:207], v4 offset:128
v_mfma_f32_16x16x32_bf16 a[64:67], a[208:211], v[176:179], a[64:67]
v_exp_f32 v222, v54
v_mfma_f32_16x16x32_bf16 a[68:71], a[208:211], v[180:183], a[68:71]
v_exp_f32 v223, v55
v_mfma_f32_16x16x32_bf16 a[72:75], a[208:211], v[184:187], a[72:75]
v_cvt_pk_bf16_f32 v169, v226, v227
v_add_f32 v215, v228, v229
v_mfma_f32_16x16x32_bf16 a[76:79], a[208:211], v[188:191], a[76:79]
ds_read_b128 a[208:211], v3 offset:256
v_cvt_pk_bf16_f32 v172, v228, v229
v_mfma_f32_16x16x32_bf16 a[92:95], a[212:215], v[188:191], a[92:95]
v_add_f32 v215, v215, v230
v_add_f32 v215, v215, v231
v_mfma_f32_16x16x32_bf16 a[88:91], a[212:215], v[184:187], a[88:91]
v_cvt_pk_bf16_f32 v173, v230, v231
v_add_f32 v212, v212, v216
v_mfma_f32_16x16x32_bf16 a[84:87], a[212:215], v[180:183], a[84:87]
v_add_f32 v212, v212, v217
v_cvt_pk_bf16_f32 v162, v216, v217
v_mfma_f32_16x16x32_bf16 a[80:83], a[212:215], v[176:179], a[80:83]
ds_read_b128 a[212:215], v4 offset:256
v_add_f32 v212, v212, v218
v_mfma_f32_16x16x32_bf16 a[96:99], a[216:219], v[176:179], a[96:99]
v_add_f32 v212, v212, v219
v_cvt_pk_bf16_f32 v163, v218, v219
v_mfma_f32_16x16x32_bf16 a[100:103], a[216:219], v[180:183], a[100:103]
v_add_f32 v213, v213, v220
v_add_f32 v213, v213, v221
v_mfma_f32_16x16x32_bf16 a[104:107], a[216:219], v[184:187], a[104:107]
v_cvt_pk_bf16_f32 v166, v220, v221
v_add_f32 v213, v213, v222
v_mfma_f32_16x16x32_bf16 a[108:111], a[216:219], v[188:191], a[108:111]
ds_read_b128 a[216:219], v3 offset:6144
v_add_f32 v213, v213, v223
v_mfma_f32_16x16x32_bf16 a[124:127], a[220:223], v[188:191], a[124:127]
s_waitcnt vmcnt(3)
buffer_load_dwordx4 v21, s[12:15], s28 offen offset:1024 nt lds
v_mfma_f32_16x16x32_bf16 a[120:123], a[220:223], v[184:187], a[120:123]
v_cvt_pk_bf16_f32 v167, v222, v223
v_max3_f32 v232, v56, v57, v58
v_mfma_f32_16x16x32_bf16 a[116:119], a[220:223], v[180:183], a[116:119]
v_max3_f32 v233, v59, v60, v61
v_max3_f32 v232, v232, v62, v63
v_mfma_f32_16x16x32_bf16 a[112:115], a[220:223], v[176:179], a[112:115]
ds_read_b128 a[220:223], v4 offset:6144
v_max3_f32 v233, v233, v214, v215
v_mfma_f32_16x16x32_bf16 a[128:131], a[224:227], v[176:179], a[128:131]
v_max3_f32 v232, v232, v233, v212
v_max_f32 v232, v232, v213
v_mfma_f32_16x16x32_bf16 a[132:135], a[224:227], v[180:183], a[132:135]
v_cmp_lt_f32 vcc, 0x42800000, v232
v_mfma_f32_16x16x32_bf16 a[136:139], a[224:227], v[184:187], a[136:139]
v_mfma_f32_16x16x32_bf16 a[140:143], a[224:227], v[188:191], a[140:143]
ds_read_b128 a[224:227], v3 offset:6272
v_mfma_f32_16x16x32_bf16 a[156:159], a[228:231], v[188:191], a[156:159]
v_mfma_f32_16x16x32_bf16 a[152:155], a[228:231], v[184:187], a[152:155]
v_mfma_f32_16x16x32_bf16 a[148:151], a[228:231], v[180:183], a[148:151]
v_mfma_f32_16x16x32_bf16 a[144:147], a[228:231], v[176:179], a[144:147]
ds_read_b128 a[228:231], v4 offset:6272
v_mfma_f32_16x16x32_bf16 a[160:163], a[232:235], v[176:179], a[160:163]
v_mfma_f32_16x16x32_bf16 a[164:167], a[232:235], v[180:183], a[164:167]
v_mfma_f32_16x16x32_bf16 a[168:171], a[232:235], v[184:187], a[168:171]
v_mfma_f32_16x16x32_bf16 a[172:175], a[232:235], v[188:191], a[172:175]
ds_read_b128 a[232:235], v3 offset:6400
v_mfma_f32_16x16x32_bf16 a[188:191], a[236:239], v[188:191], a[188:191]
v_mfma_f32_16x16x32_bf16 a[184:187], a[236:239], v[184:187], a[184:187]
s_waitcnt lgkmcnt(1)
v_mfma_f32_16x16x32_bf16 a[180:183], a[236:239], v[180:183], a[180:183]
v_mfma_f32_16x16x32_bf16 a[176:179], a[236:239], v[176:179], a[176:179]
s_cbranch_vccnz L1_stub0
L1_back0:
v_mfma_f32_16x16x32_bf16 v[32:35], a[192:195], v[64:67], v[192:195]
ds_read_b128 a[236:239], v4 offset:6400
v_add_f32 v208, v208, v212
v_mfma_f32_16x16x32_bf16 v[32:35], a[196:199], v[80:83], v[32:35]
s_waitcnt vmcnt(3)
buffer_load_dwordx4 v22, s[12:15], s28 offen offset:2048 nt lds
v_mfma_f32_16x16x32_bf16 v[32:35], a[200:203], v[96:99], v[32:35]
s_add_u32 s28, s28, 12288
v_exp_f32 v224, v56
v_mfma_f32_16x16x32_bf16 v[36:39], a[192:195], v[68:71], v[196:199]
v_exp_f32 v225, v57
v_mfma_f32_16x16x32_bf16 v[36:39], a[196:199], v[84:87], v[36:39]
v_exp_f32 v226, v58
v_mfma_f32_16x16x32_bf16 v[36:39], a[200:203], v[100:103], v[36:39]
v_exp_f32 v227, v59
v_mfma_f32_16x16x32_bf16 v[40:43], a[192:195], v[72:75], v[200:203]
v_exp_f32 v228, v60
v_mfma_f32_16x16x32_bf16 v[40:43], a[196:199], v[88:91], v[40:43]
v_exp_f32 v229, v61
v_mfma_f32_16x16x32_bf16 v[40:43], a[200:203], v[104:107], v[40:43]
v_exp_f32 v230, v62
v_mfma_f32_16x16x32_bf16 v[44:47], a[192:195], v[76:79], v[204:207]
ds_read_b64_tr_b16 a[192:193], v9 offset:12288
v_add_f32 v209, v209, v213
v_mfma_f32_16x16x32_bf16 v[44:47], a[196:199], v[92:95], v[44:47]
ds_read_b64_tr_b16 a[194:195], v9 offset:18432
v_add_f32 v210, v210, v214
v_mfma_f32_16x16x32_bf16 v[44:47], a[200:203], v[108:111], v[44:47]
ds_read_b64_tr_b16 a[196:197], v10 offset:12288
v_add_f32 v211, v211, v215
v_mfma_f32_16x16x32_bf16 v[32:35], a[204:207], v[112:115], v[32:35]
ds_read_b64_tr_b16 a[198:199], v10 offset:18432
v_add_f32 v210, v210, v224
v_mfma_f32_16x16x32_bf16 v[32:35], a[208:211], v[128:131], v[32:35]
s_add_u32 m0, s25, 61440
ds_read_b64_tr_b16 a[200:201], v11 offset:12288
v_add_f32 v210, v210, v225
v_mfma_f32_16x16x32_bf16 v[32:35], a[212:215], v[144:147], v[32:35]
s_waitcnt vmcnt(3)
buffer_load_dwordx4 v17, s[8:11], s27 offen offset:0 nt lds
v_mfma_f32_16x16x32_bf16 v[36:39], a[204:207], v[116:119], v[36:39]
ds_read_b64_tr_b16 a[202:203], v11 offset:18432
v_cvt_pk_bf16_f32 v170, v224, v225
v_mfma_f32_16x16x32_bf16 v[36:39], a[208:211], v[132:135], v[36:39]
v_exp_f32 v231, v63
v_mfma_f32_16x16x32_bf16 v[36:39], a[212:215], v[148:151], v[36:39]
v_exp_f32 v216, v32
v_mfma_f32_16x16x32_bf16 v[40:43], a[204:207], v[120:123], v[40:43]
v_exp_f32 v217, v33
v_mfma_f32_16x16x32_bf16 v[40:43], a[208:211], v[136:139], v[40:43]
v_exp_f32 v218, v34
v_mfma_f32_16x16x32_bf16 v[40:43], a[212:215], v[152:155], v[40:43]
v_exp_f32 v219, v35
v_mfma_f32_16x16x32_bf16 v[44:47], a[204:207], v[124:127], v[44:47]
ds_read_b64_tr_b16 a[204:205], v12 offset:12288
v_add_f32 v210, v210, v226
v_mfma_f32_16x16x32_bf16 v[44:47], a[208:211], v[140:143], v[44:47]
ds_read_b64_tr_b16 a[206:207], v12 offset:18432
v_add_f32 v210, v210, v227
v_mfma_f32_16x16x32_bf16 v[44:47], a[212:215], v[156:159], v[44:47]
ds_read_b64_tr_b16 a[208:209], v9 offset:12416
v_cvt_pk_bf16_f32 v171, v226, v227
v_mfma_f32_16x16x32_bf16 v[48:51], a[216:219], v[64:67], v[192:195]
ds_read_b64_tr_b16 a[210:211], v9 offset:18560
v_add_f32 v211, v211, v228
v_mfma_f32_16x16x32_bf16 v[48:51], a[220:223], v[80:83], v[48:51]
ds_read_b64_tr_b16 a[212:213], v10 offset:12416
v_add_f32 v211, v211, v229
v_mfma_f32_16x16x32_bf16 v[48:51], a[224:227], v[96:99], v[48:51]
ds_read_b64_tr_b16 a[214:215], v10 offset:18560
v_cvt_pk_bf16_f32 v174, v228, v229
v_mfma_f32_16x16x32_bf16 v[52:55], a[216:219], v[68:71], v[196:199]
v_exp_f32 v220, v36
v_mfma_f32_16x16x32_bf16 v[52:55], a[220:223], v[84:87], v[52:55]
v_exp_f32 v221, v37
v_mfma_f32_16x16x32_bf16 v[52:55], a[224:227], v[100:103], v[52:55]
v_exp_f32 v222, v38
v_mfma_f32_16x16x32_bf16 v[56:59], a[216:219], v[72:75], v[200:203]
v_exp_f32 v223, v39
v_mfma_f32_16x16x32_bf16 v[56:59], a[220:223], v[88:91], v[56:59]
s_waitcnt vmcnt(3)
buffer_load_dwordx4 v18, s[8:11], s27 offen offset:1024 nt lds
v_mfma_f32_16x16x32_bf16 v[56:59], a[224:227], v[104:107], v[56:59]
v_add_f32 v211, v211, v230
v_add_f32 v211, v211, v231
v_mfma_f32_16x16x32_bf16 v[60:63], a[216:219], v[76:79], v[204:207]
ds_read_b64_tr_b16 a[216:217], v11 offset:12416
v_cvt_pk_bf16_f32 v175, v230, v231
v_mfma_f32_16x16x32_bf16 v[60:63], a[220:223], v[92:95], v[60:63]
ds_read_b64_tr_b16 a[218:219], v11 offset:18560
v_add_f32 v212, v216, v217
v_mfma_f32_16x16x32_bf16 v[60:63], a[224:227], v[108:111], v[60:63]
ds_read_b64_tr_b16 a[220:221], v12 offset:12416
v_cvt_pk_bf16_f32 v176, v216, v217
v_mfma_f32_16x16x32_bf16 v[48:51], a[228:231], v[112:115], v[48:51]
s_waitcnt lgkmcnt(3)
ds_read_b64_tr_b16 a[222:223], v12 offset:18560
v_add_f32 v212, v212, v218
v_mfma_f32_16x16x32_bf16 v[48:51], a[232:235], v[128:131], v[48:51]
ds_read_b64_tr_b16 a[224:225], v9 offset:12544
v_add_f32 v212, v212, v219
v_mfma_f32_16x16x32_bf16 v[48:51], a[236:239], v[144:147], v[48:51]
ds_read_b64_tr_b16 a[226:227], v9 offset:18688
v_cvt_pk_bf16_f32 v177, v218, v219
v_mfma_f32_16x16x32_bf16 v[52:55], a[228:231], v[116:119], v[52:55]
v_exp_f32 v224, v40
v_mfma_f32_16x16x32_bf16 v[52:55], a[232:235], v[132:135], v[52:55]
v_exp_f32 v225, v41
v_mfma_f32_16x16x32_bf16 v[52:55], a[236:239], v[148:151], v[52:55]
v_exp_f32 v226, v42
v_mfma_f32_16x16x32_bf16 v[56:59], a[228:231], v[120:123], v[56:59]
v_exp_f32 v227, v43
v_mfma_f32_16x16x32_bf16 v[56:59], a[232:235], v[136:139], v[56:59]
v_exp_f32 v228, v44
v_mfma_f32_16x16x32_bf16 v[56:59], a[236:239], v[152:155], v[56:59]
s_waitcnt vmcnt(3)
buffer_load_dwordx4 v19, s[8:11], s27 offen offset:2048 nt lds
v_mfma_f32_16x16x32_bf16 v[60:63], a[228:231], v[124:127], v[60:63]
s_add_u32 s27, s27, 12288
ds_read_b64_tr_b16 a[228:229], v10 offset:12544
v_add_f32 v213, v220, v221
v_mfma_f32_16x16x32_bf16 v[60:63], a[232:235], v[140:143], v[60:63]
ds_read_b64_tr_b16 a[230:231], v10 offset:18688
v_cvt_pk_bf16_f32 v180, v220, v221
v_mfma_f32_16x16x32_bf16 v[60:63], a[236:239], v[156:159], v[60:63]
ds_read_b64_tr_b16 a[232:233], v11 offset:12544
v_add_f32 v213, v213, v222
v_mfma_f32_16x16x32_bf16 a[0:3], a[192:195], v[160:163], a[0:3]
ds_read_b64_tr_b16 a[234:235], v11 offset:18688
v_add_f32 v213, v213, v223
v_mfma_f32_16x16x32_bf16 a[4:7], a[192:195], v[164:167], a[4:7]
ds_read_b64_tr_b16 a[236:237], v12 offset:12544
v_cvt_pk_bf16_f32 v181, v222, v223
v_mfma_f32_16x16x32_bf16 a[8:11], a[192:195], v[168:171], a[8:11]
ds_read_b64_tr_b16 a[238:239], v12 offset:18688
v_add_f32 v214, v224, v225
v_mfma_f32_16x16x32_bf16 a[12:15], a[192:195], v[172:175], a[12:15]
v_exp_f32 v229, v45
v_mfma_f32_16x16x32_bf16 a[28:31], a[196:199], v[172:175], a[28:31]
v_exp_f32 v230, v46
v_mfma_f32_16x16x32_bf16 a[24:27], a[196:199], v[168:171], a[24:27]
s_waitcnt lgkmcnt(0)
v_exp_f32 v231, v47
v_mfma_f32_16x16x32_bf16 a[20:23], a[196:199], v[164:167], a[20:23]
s_barrier
v_exp_f32 v216, v48
v_mfma_f32_16x16x32_bf16 a[16:19], a[196:199], v[160:163], a[16:19]
ds_read_b128 a[192:195], v3 offset:12288
v_cvt_pk_bf16_f32 v184, v224, v225
v_mfma_f32_16x16x32_bf16 a[32:35], a[200:203], v[160:163], a[32:35]
ds_read_b128 a[196:199], v4 offset:12288
v_add_f32 v214, v214, v226
v_mfma_f32_16x16x32_bf16 a[36:39], a[200:203], v[164:167], a[36:39]
v_exp_f32 v217, v49
v_mfma_f32_16x16x32_bf16 a[40:43], a[200:203], v[168:171], a[40:43]
v_exp_f32 v218, v50
v_mfma_f32_16x16x32_bf16 a[44:47], a[200:203], v[172:175], a[44:47]
ds_read_b128 a[200:203], v3 offset:12416
v_add_f32 v214, v214, v227
v_mfma_f32_16x16x32_bf16 a[60:63], a[204:207], v[172:175], a[60:63]
v_exp_f32 v219, v51
v_mfma_f32_16x16x32_bf16 a[56:59], a[204:207], v[168:171], a[56:59]
v_exp_f32 v220, v52
v_mfma_f32_16x16x32_bf16 a[52:55], a[204:207], v[164:167], a[52:55]
v_exp_f32 v221, v53
v_mfma_f32_16x16x32_bf16 a[48:51], a[204:207], v[160:163], a[48:51]
ds_read_b128 a[204:207], v4 offset:12416
v_cvt_pk_bf16_f32 v185, v226, v227
v_mfma_f32_16x16x32_bf16 a[64:67], a[208:211], v[160:163], a[64:67]
s_mov_b32 m0, s29
v_exp_f32 v222, v54
v_mfma_f32_16x16x32_bf16 a[68:71], a[208:211], v[164:167], a[68:71]
s_waitcnt vmcnt(3)
buffer_load_dwordx4 v20, s[12:15], s28 offen offset:0 nt lds
v_mfma_f32_16x16x32_bf16 a[72:75], a[208:211], v[168:171], a[72:75]
v_exp_f32 v223, v55
v_mfma_f32_16x16x32_bf16 a[76:79], a[208:211], v[172:175], a[76:79]
s_add_u32 s29, s29, 12288
ds_read_b128 a[208:211], v3 offset:12544
v_add_f32 v215, v228, v229
v_mfma_f32_16x16x32_bf16 a[92:95], a[212:215], v[172:175], a[92:95]
v_cvt_pk_bf16_f32 v188, v228, v229
v_add_f32 v215, v215, v230
v_mfma_f32_16x16x32_bf16 a[88:91], a[212:215], v[168:171], a[88:91]
s_cmp_eq_u32 s29, s25
s_cselect_b32 s29, s26, s29
v_add_f32 v215, v215, v231
v_mfma_f32_16x16x32_bf16 a[84:87], a[212:215], v[164:167], a[84:87]
v_cvt_pk_bf16_f32 v189, v230, v231
v_add_f32 v212, v212, v216
v_mfma_f32_16x16x32_bf16 a[80:83], a[212:215], v[160:163], a[80:83]
ds_read_b128 a[212:215], v4 offset:12544
v_add_f32 v212, v212, v217
v_mfma_f32_16x16x32_bf16 a[96:99], a[216:219], v[160:163], a[96:99]
v_cvt_pk_bf16_f32 v178, v216, v217
v_add_f32 v212, v212, v218
v_mfma_f32_16x16x32_bf16 a[100:103], a[216:219], v[164:167], a[100:103]
v_add_f32 v212, v212, v219
v_cvt_pk_bf16_f32 v179, v218, v219
v_mfma_f32_16x16x32_bf16 a[104:107], a[216:219], v[168:171], a[104:107]
v_add_f32 v213, v213, v220
v_add_f32 v213, v213, v221
v_mfma_f32_16x16x32_bf16 a[108:111], a[216:219], v[172:175], a[108:111]
ds_read_b128 a[216:219], v3 offset:18432
v_cvt_pk_bf16_f32 v182, v220, v221
v_mfma_f32_16x16x32_bf16 a[124:127], a[220:223], v[172:175], a[124:127]
v_add_f32 v213, v213, v222
v_add_f32 v213, v213, v223
v_mfma_f32_16x16x32_bf16 a[120:123], a[220:223], v[168:171], a[120:123]
v_cvt_pk_bf16_f32 v183, v222, v223
v_max3_f32 v232, v56, v57, v58
v_mfma_f32_16x16x32_bf16 a[116:119], a[220:223], v[164:167], a[116:119]
v_max3_f32 v233, v59, v60, v61
v_max3_f32 v232, v232, v62, v63
v_mfma_f32_16x16x32_bf16 a[112:115], a[220:223], v[160:163], a[112:115]
ds_read_b128 a[220:223], v4 offset:18432
v_max3_f32 v233, v233, v214, v215
v_mfma_f32_16x16x32_bf16 a[128:131], a[224:227], v[160:163], a[128:131]
v_max3_f32 v232, v232, v233, v212
v_max_f32 v232, v232, v213
v_mfma_f32_16x16x32_bf16 a[132:135], a[224:227], v[164:167], a[132:135]
v_cmp_lt_f32 vcc, 0x42800000, v232
v_mfma_f32_16x16x32_bf16 a[136:139], a[224:227], v[168:171], a[136:139]
s_waitcnt vmcnt(3)
buffer_load_dwordx4 v21, s[12:15], s28 offen offset:1024 nt lds
v_mfma_f32_16x16x32_bf16 a[140:143], a[224:227], v[172:175], a[140:143]
ds_read_b128 a[224:227], v3 offset:18560
v_mfma_f32_16x16x32_bf16 a[156:159], a[228:231], v[172:175], a[156:159]
v_mfma_f32_16x16x32_bf16 a[152:155], a[228:231], v[168:171], a[152:155]
v_mfma_f32_16x16x32_bf16 a[148:151], a[228:231], v[164:167], a[148:151]
v_mfma_f32_16x16x32_bf16 a[144:147], a[228:231], v[160:163], a[144:147]
ds_read_b128 a[228:231], v4 offset:18560
v_mfma_f32_16x16x32_bf16 a[160:163], a[232:235], v[160:163], a[160:163]
v_mfma_f32_16x16x32_bf16 a[164:167], a[232:235], v[164:167], a[164:167]
v_mfma_f32_16x16x32_bf16 a[168:171], a[232:235], v[168:171], a[168:171]
v_mfma_f32_16x16x32_bf16 a[172:175], a[232:235], v[172:175], a[172:175]
ds_read_b128 a[232:235], v3 offset:18688
v_mfma_f32_16x16x32_bf16 a[188:191], a[236:239], v[172:175], a[188:191]
v_mfma_f32_16x16x32_bf16 a[184:187], a[236:239], v[168:171], a[184:187]
s_waitcnt lgkmcnt(1)
v_mfma_f32_16x16x32_bf16 a[180:183], a[236:239], v[164:167], a[180:183]
v_mfma_f32_16x16x32_bf16 a[176:179], a[236:239], v[160:163], a[176:179]
s_cbranch_vccnz L1_stub1
L1_back1:
v_mfma_f32_16x16x32_bf16 v[32:35], a[192:195], v[64:67], v[192:195]
ds_read_b128 a[236:239], v4 offset:18688
v_add_f32 v208, v208, v212
v_mfma_f32_16x16x32_bf16 v[32:35], a[196:199], v[80:83], v[32:35]
v_exp_f32 v224, v56
v_mfma_f32_16x16x32_bf16 v[32:35], a[200:203], v[96:99], v[32:35]
v_exp_f32 v225, v57
v_mfma_f32_16x16x32_bf16 v[36:39], a[192:195], v[68:71], v[196:199]
s_waitcnt vmcnt(3)
buffer_load_dwordx4 v22, s[12:15], s28 offen offset:2048 nt lds
v_mfma_f32_16x16x32_bf16 v[36:39], a[196:199], v[84:87], v[36:39]
s_add_u32 s28, s28, 12288
v_exp_f32 v226, v58
v_mfma_f32_16x16x32_bf16 v[36:39], a[200:203], v[100:103], v[36:39]
v_exp_f32 v227, v59
v_mfma_f32_16x16x32_bf16 v[40:43], a[192:195], v[72:75], v[200:203]
v_exp_f32 v228, v60
v_mfma_f32_16x16x32_bf16 v[40:43], a[196:199], v[88:91], v[40:43]
v_exp_f32 v229, v61
v_mfma_f32_16x16x32_bf16 v[40:43], a[200:203], v[104:107], v[40:43]
v_exp_f32 v230, v62
v_mfma_f32_16x16x32_bf16 v[44:47], a[192:195], v[76:79], v[204:207]
ds_read_b64_tr_b16 a[192:193], v9 offset:24576
v_add_f32 v209, v209, v213
v_mfma_f32_16x16x32_bf16 v[44:47], a[196:199], v[92:95], v[44:47]
ds_read_b64_tr_b16 a[194:195], v9 offset:30720
v_add_f32 v210, v210, v214
v_mfma_f32_16x16x32_bf16 v[44:47], a[200:203], v[108:111], v[44:47]
ds_read_b64_tr_b16 a[196:197], v10 offset:24576
v_add_f32 v211, v211, v215
v_mfma_f32_16x16x32_bf16 v[32:35], a[204:207], v[112:115], v[32:35]
ds_read_b64_tr_b16 a[198:199], v10 offset:30720
v_add_f32 v210, v210, v224
v_mfma_f32_16x16x32_bf16 v[32:35], a[208:211], v[128:131], v[32:35]
ds_read_b64_tr_b16 a[200:201], v11 offset:24576
v_add_f32 v210, v210, v225
v_mfma_f32_16x16x32_bf16 v[32:35], a[212:215], v[144:147], v[32:35]
ds_read_b64_tr_b16 a[202:203], v11 offset:30720
v_cvt_pk_bf16_f32 v186, v224, v225
v_mfma_f32_16x16x32_bf16 v[36:39], a[204:207], v[116:119], v[36:39]
v_exp_f32 v231, v63
v_mfma_f32_16x16x32_bf16 v[36:39], a[208:211], v[132:135], v[36:39]
v_add_f32 v210, v210, v226
v_add_f32 v210, v210, v227
v_mfma_f32_16x16x32_bf16 v[36:39], a[212:215], v[148:151], v[36:39]
v_exp_f32 v216, v32
v_mfma_f32_16x16x32_bf16 v[40:43], a[204:207], v[120:123], v[40:43]
v_exp_f32 v217, v33
v_mfma_f32_16x16x32_bf16 v[40:43], a[208:211], v[136:139], v[40:43]
s_add_u32 m0, s25, 0
v_exp_f32 v218, v34
v_mfma_f32_16x16x32_bf16 v[40:43], a[212:215], v[152:155], v[40:43]
s_waitcnt vmcnt(3)
buffer_load_dwordx4 v17, s[8:11], s27 offen offset:0 nt lds
v_mfma_f32_16x16x32_bf16 v[44:47], a[204:207], v[124:127], v[44:47]
ds_read_b64_tr_b16 a[204:205], v12 offset:24576
v_cvt_pk_bf16_f32 v187, v226, v227
v_mfma_f32_16x16x32_bf16 v[44:47], a[208:211], v[140:143], v[44:47]
ds_read_b64_tr_b16 a[206:207], v12 offset:30720
v_add_f32 v211, v211, v228
v_mfma_f32_16x16x32_bf16 v[44:47], a[212:215], v[156:159], v[44:47]
ds_read_b64_tr_b16 a[208:209], v9 offset:24704
v_add_f32 v211, v211, v229
v_mfma_f32_16x16x32_bf16 v[48:51], a[216:219], v[64:67], v[192:195]
ds_read_b64_tr_b16 a[210:211], v9 offset:30848
v_cvt_pk_bf16_f32 v190, v228, v229
v_mfma_f32_16x16x32_bf16 v[48:51], a[220:223], v[80:83], v[48:51]
ds_read_b64_tr_b16 a[212:213], v10 offset:24704
v_add_f32 v211, v211, v230
v_mfma_f32_16x16x32_bf16 v[48:51], a[224:227], v[96:99], v[48:51]
ds_read_b64_tr_b16 a[214:215], v10 offset:30848
v_add_f32 v211, v211, v231
v_mfma_f32_16x16x32_bf16 v[52:55], a[216:219], v[68:71], v[196:199]
v_exp_f32 v219, v35
v_mfma_f32_16x16x32_bf16 v[52:55], a[220:223], v[84:87], v[52:55]
v_exp_f32 v220, v36
v_mfma_f32_16x16x32_bf16 v[52:55], a[224:227], v[100:103], v[52:55]
v_exp_f32 v221, v37
v_mfma_f32_16x16x32_bf16 v[56:59], a[216:219], v[72:75], v[200:203]
v_exp_f32 v222, v38
v_mfma_f32_16x16x32_bf16 v[56:59], a[220:223], v[88:91], v[56:59]
v_exp_f32 v223, v39
v_mfma_f32_16x16x32_bf16 v[56:59], a[224:227], v[104:107], v[56:59]
v_exp_f32 v224, v40
v_mfma_f32_16x16x32_bf16 v[60:63], a[216:219], v[76:79], v[204:207]
ds_read_b64_tr_b16 a[216:217], v11 offset:24704
v_cvt_pk_bf16_f32 v191, v230, v231
v_mfma_f32_16x16x32_bf16 v[60:63], a[220:223], v[92:95], v[60:63]
ds_read_b64_tr_b16 a[218:219], v11 offset:30848
v_add_f32 v212, v216, v217
v_mfma_f32_16x16x32_bf16 v[60:63], a[224:227], v[108:111], v[60:63]
ds_read_b64_tr_b16 a[220:221], v12 offset:24704
v_cvt_pk_bf16_f32 v160, v216, v217
v_mfma_f32_16x16x32_bf16 v[48:51], a[228:231], v[112:115], v[48:51]
s_waitcnt lgkmcnt(3)
ds_read_b64_tr_b16 a[222:223], v12 offset:30848
v_add_f32 v212, v212, v218
v_mfma_f32_16x16x32_bf16 v[48:51], a[232:235], v[128:131], v[48:51]
s_waitcnt vmcnt(3)
buffer_load_dwordx4 v18, s[8:11], s27 offen offset:1024 nt lds
v_mfma_f32_16x16x32_bf16 v[48:51], a[236:239], v[144:147], v[48:51]
ds_read_b64_tr_b16 a[224:225], v9 offset:24832
v_add_f32 v212, v212, v219
v_mfma_f32_16x16x32_bf16 v[52:55], a[228:231], v[116:119], v[52:55]
ds_read_b64_tr_b16 a[226:227], v9 offset:30976
v_cvt_pk_bf16_f32 v161, v218, v219
v_mfma_f32_16x16x32_bf16 v[52:55], a[232:235], v[132:135], v[52:55]
v_exp_f32 v225, v41
v_mfma_f32_16x16x32_bf16 v[52:55], a[236:239], v[148:151], v[52:55]
v_exp_f32 v226, v42
v_mfma_f32_16x16x32_bf16 v[56:59], a[228:231], v[120:123], v[56:59]
v_exp_f32 v227, v43
v_mfma_f32_16x16x32_bf16 v[56:59], a[232:235], v[136:139], v[56:59]
v_exp_f32 v228, v44
v_mfma_f32_16x16x32_bf16 v[56:59], a[236:239], v[152:155], v[56:59]
v_exp_f32 v229, v45
v_mfma_f32_16x16x32_bf16 v[60:63], a[228:231], v[124:127], v[60:63]
ds_read_b64_tr_b16 a[228:229], v10 offset:24832
v_add_f32 v213, v220, v221
v_mfma_f32_16x16x32_bf16 v[60:63], a[232:235], v[140:143], v[60:63]
ds_read_b64_tr_b16 a[230:231], v10 offset:30976
v_cvt_pk_bf16_f32 v164, v220, v221
v_mfma_f32_16x16x32_bf16 v[60:63], a[236:239], v[156:159], v[60:63]
ds_read_b64_tr_b16 a[232:233], v11 offset:24832
v_add_f32 v213, v213, v222
v_mfma_f32_16x16x32_bf16 a[0:3], a[192:195], v[176:179], a[0:3]
ds_read_b64_tr_b16 a[234:235], v11 offset:30976
v_add_f32 v213, v213, v223
v_mfma_f32_16x16x32_bf16 a[4:7], a[192:195], v[180:183], a[4:7]
ds_read_b64_tr_b16 a[236:237], v12 offset:24832
v_cvt_pk_bf16_f32 v165, v222, v223
v_mfma_f32_16x16x32_bf16 a[8:11], a[192:195], v[184:187], a[8:11]
ds_read_b64_tr_b16 a[238:239], v12 offset:30976
v_add_f32 v214, v224, v225
v_mfma_f32_16x16x32_bf16 a[12:15], a[192:195], v[188:191], a[12:15]
v_exp_f32 v230, v46
v_mfma_f32_16x16x32_bf16 a[28:31], a[196:199], v[188:191], a[28:31]
v_exp_f32 v231, v47
v_mfma_f32_16x16x32_bf16 a[24:27], a[196:199], v[184:187], a[24:27]
s_waitcnt lgkmcnt(0)
v_exp_f32 v216, v48
v_mfma_f32_16x16x32_bf16 a[20:23], a[196:199], v[180:183], a[20:23]
s_barrier
v_exp_f32 v217, v49
v_mfma_f32_16x16x32_bf16 a[16:19], a[196:199], v[176:179], a[16:19]
ds_read_b128 a[192:195], v3 offset:24576
v_cvt_pk_bf16_f32 v168, v224, v225
v_mfma_f32_16x16x32_bf16 a[32:35], a[200:203], v[176:179], a[32:35]
s_waitcnt vmcnt(3)
buffer_load_dwordx4 v19, s[8:11], s27 offen offset:2048 nt lds
v_mfma_f32_16x16x32_bf16 a[36:39], a[200:203], v[180:183], a[36:39]
s_add_u32 s27, s27, 12288
ds_read_b128 a[196:199], v4 offset:24576
v_add_f32 v214, v214, v226
v_mfma_f32_16x16x32_bf16 a[40:43], a[200:203], v[184:187], a[40:43]
v_exp_f32 v218, v50
v_mfma_f32_16x16x32_bf16 a[44:47], a[200:203], v[188:191], a[44:47]
ds_read_b128 a[200:203], v3 offset:24704
v_add_f32 v214, v214, v227
v_mfma_f32_16x16x32_bf16 a[60:63], a[204:207], v[188:191], a[60:63]
v_exp_f32 v219, v51
v_mfma_f32_16x16x32_bf16 a[56:59], a[204:207], v[184:187], a[56:59]
v_exp_f32 v220, v52
v_mfma_f32_16x16x32_bf16 a[52:55], a[204:207], v[180:183], a[52:55]
v_exp_f32 v221, v53
v_mfma_f32_16x16x32_bf16 a[48:51], a[204:207], v[176:179], a[48:51]
ds_read_b128 a[204:207], v4 offset:24704
v_cvt_pk_bf16_f32 v169, v226, v227
v_mfma_f32_16x16x32_bf16 a[64:67], a[208:211], v[176:179], a[64:67]
v_exp_f32 v222, v54
v_mfma_f32_16x16x32_bf16 a[68:71], a[208:211], v[180:183], a[68:71]
v_exp_f32 v223, v55
v_mfma_f32_16x16x32_bf16 a[72:75], a[208:211], v[184:187], a[72:75]
v_add_f32 v215, v228, v229
v_cvt_pk_bf16_f32 v172, v228, v229
v_mfma_f32_16x16x32_bf16 a[76:79], a[208:211], v[188:191], a[76:79]
ds_read_b128 a[208:211], v3 offset:24832
v_add_f32 v215, v215, v230
v_mfma_f32_16x16x32_bf16 a[92:95], a[212:215], v[188:191], a[92:95]
v_add_f32 v215, v215, v231
v_cvt_pk_bf16_f32 v173, v230, v231
v_mfma_f32_16x16x32_bf16 a[88:91], a[212:215], v[184:187], a[88:91]
v_add_f32 v212, v212, v216
v_add_f32 v212, v212, v217
v_mfma_f32_16x16x32_bf16 a[84:87], a[212:215], v[180:183], a[84:87]
s_mov_b32 m0, s29
v_cvt_pk_bf16_f32 v162, v216, v217
v_add_f32 v212, v212, v218
v_mfma_f32_16x16x32_bf16 a[80:83], a[212:215], v[176:179], a[80:83]
s_waitcnt vmcnt(3)
buffer_load_dwordx4 v20, s[12:15], s28 offen offset:0 nt lds
v_mfma_f32_16x16x32_bf16 a[96:99], a[216:219], v[176:179], a[96:99]
ds_read_b128 a[212:215], v4 offset:24832
v_add_f32 v212, v212, v219
v_mfma_f32_16x16x32_bf16 a[100:103], a[216:219], v[180:183], a[100:103]
s_add_u32 s29, s29, 12288
v_cvt_pk_bf16_f32 v163, v218, v219
v_add_f32 v213, v213, v220
v_mfma_f32_16x16x32_bf16 a[104:107], a[216:219], v[184:187], a[104:107]
v_add_f32 v213, v213, v221
v_cvt_pk_bf16_f32 v166, v220, v221
v_mfma_f32_16x16x32_bf16 a[108:111], a[216:219], v[188:191], a[108:111]
s_cmp_eq_u32 s29, s25
s_cselect_b32 s29, s26, s29
ds_read_b128 a[216:219], v3 offset:30720
v_mfma_f32_16x16x32_bf16 a[124:127], a[220:223], v[188:191], a[124:127]
v_add_f32 v213, v213, v222
v_add_f32 v213, v213, v223
v_mfma_f32_16x16x32_bf16 a[120:123], a[220:223], v[184:187], a[120:123]
v_cvt_pk_bf16_f32 v167, v222, v223
v_max3_f32 v232, v56, v57, v58
v_mfma_f32_16x16x32_bf16 a[116:119], a[220:223], v[180:183], a[116:119]
v_max3_f32 v233, v59, v60, v61
v_max3_f32 v232, v232, v62, v63
v_mfma_f32_16x16x32_bf16 a[112:115], a[220:223], v[176:179], a[112:115]
ds_read_b128 a[220:223], v4 offset:30720
v_max3_f32 v233, v233, v214, v215
v_mfma_f32_16x16x32_bf16 a[128:131], a[224:227], v[176:179], a[128:131]
v_max3_f32 v232, v232, v233, v212
v_max_f32 v232, v232, v213
v_mfma_f32_16x16x32_bf16 a[132:135], a[224:227], v[180:183], a[132:135]
v_cmp_lt_f32 vcc, 0x42800000, v232
v_mfma_f32_16x16x32_bf16 a[136:139], a[224:227], v[184:187], a[136:139]
v_mfma_f32_16x16x32_bf16 a[140:143], a[224:227], v[188:191], a[140:143]
ds_read_b128 a[224:227], v3 offset:30848
v_mfma_f32_16x16x32_bf16 a[156:159], a[228:231], v[188:191], a[156:159]
v_mfma_f32_16x16x32_bf16 a[152:155], a[228:231], v[184:187], a[152:155]
v_mfma_f32_16x16x32_bf16 a[148:151], a[228:231], v[180:183], a[148:151]
v_mfma_f32_16x16x32_bf16 a[144:147], a[228:231], v[176:179], a[144:147]
ds_read_b128 a[228:231], v4 offset:30848
v_mfma_f32_16x16x32_bf16 a[160:163], a[232:235], v[176:179], a[160:163]
s_waitcnt vmcnt(3)
buffer_load_dwordx4 v21, s[12:15], s28 offen offset:1024 nt lds
v_mfma_f32_16x16x32_bf16 a[164:167], a[232:235], v[180:183], a[164:167]
v_mfma_f32_16x16x32_bf16 a[168:171], a[232:235], v[184:187], a[168:171]
v_mfma_f32_16x16x32_bf16 a[172:175], a[232:235], v[188:191], a[172:175]
ds_read_b128 a[232:235], v3 offset:30976
v_mfma_f32_16x16x32_bf16 a[188:191], a[236:239], v[188:191], a[188:191]
v_mfma_f32_16x16x32_bf16 a[184:187], a[236:239], v[184:187], a[184:187]
s_waitcnt lgkmcnt(1)
v_mfma_f32_16x16x32_bf16 a[180:183], a[236:239], v[180:183], a[180:183]
v_mfma_f32_16x16x32_bf16 a[176:179], a[236:239], v[176:179], a[176:179]
s_cbranch_vccnz L1_stub2
L1_back2:
v_mfma_f32_16x16x32_bf16 v[32:35], a[192:195], v[64:67], v[192:195]
ds_read_b128 a[236:239], v4 offset:30976
v_add_f32 v208, v208, v212
v_mfma_f32_16x16x32_bf16 v[32:35], a[196:199], v[80:83], v[32:35]
v_exp_f32 v224, v56
v_mfma_f32_16x16x32_bf16 v[32:35], a[200:203], v[96:99], v[32:35]
v_exp_f32 v225, v57
v_mfma_f32_16x16x32_bf16 v[36:39], a[192:195], v[68:71], v[196:199]
v_exp_f32 v226, v58
v_mfma_f32_16x16x32_bf16 v[36:39], a[196:199], v[84:87], v[36:39]
v_exp_f32 v227, v59
v_mfma_f32_16x16x32_bf16 v[36:39], a[200:203], v[100:103], v[36:39]
v_exp_f32 v228, v60
v_mfma_f32_16x16x32_bf16 v[40:43], a[192:195], v[72:75], v[200:203]
v_exp_f32 v229, v61
v_mfma_f32_16x16x32_bf16 v[40:43], a[196:199], v[88:91], v[40:43]
v_exp_f32 v230, v62
v_mfma_f32_16x16x32_bf16 v[40:43], a[200:203], v[104:107], v[40:43]
v_exp_f32 v231, v63
v_mfma_f32_16x16x32_bf16 v[44:47], a[192:195], v[76:79], v[204:207]
s_waitcnt vmcnt(3)
buffer_load_dwordx4 v22, s[12:15], s28 offen offset:2048 nt lds
v_mfma_f32_16x16x32_bf16 v[44:47], a[196:199], v[92:95], v[44:47]
s_add_u32 s28, s28, 12288
ds_read_b64_tr_b16 a[192:193], v5 offset:0
v_add_f32 v209, v209, v213
v_mfma_f32_16x16x32_bf16 v[44:47], a[200:203], v[108:111], v[44:47]
ds_read_b64_tr_b16 a[194:195], v5 offset:6144
v_add_f32 v210, v210, v214
v_mfma_f32_16x16x32_bf16 v[32:35], a[204:207], v[112:115], v[32:35]
ds_read_b64_tr_b16 a[196:197], v6 offset:0
v_add_f32 v211, v211, v215
v_mfma_f32_16x16x32_bf16 v[32:35], a[208:211], v[128:131], v[32:35]
ds_read_b64_tr_b16 a[198:199], v6 offset:6144
v_add_f32 v210, v210, v224
v_mfma_f32_16x16x32_bf16 v[32:35], a[212:215], v[144:147], v[32:35]
ds_read_b64_tr_b16 a[200:201], v7 offset:0
v_add_f32 v210, v210, v225
v_mfma_f32_16x16x32_bf16 v[36:39], a[204:207], v[116:119], v[36:39]
ds_read_b64_tr_b16 a[202:203], v7 offset:6144
v_cvt_pk_bf16_f32 v170, v224, v225
v_mfma_f32_16x16x32_bf16 v[36:39], a[208:211], v[132:135], v[36:39]
v_add_f32 v210, v210, v226
v_add_f32 v210, v210, v227
v_mfma_f32_16x16x32_bf16 v[36:39], a[212:215], v[148:151], v[36:39]
v_exp_f32 v216, v32
v_mfma_f32_16x16x32_bf16 v[40:43], a[204:207], v[120:123], v[40:43]
v_exp_f32 v217, v33
v_mfma_f32_16x16x32_bf16 v[40:43], a[208:211], v[136:139], v[40:43]
v_exp_f32 v218, v34
v_mfma_f32_16x16x32_bf16 v[40:43], a[212:215], v[152:155], v[40:43]
v_exp_f32 v219, v35
v_mfma_f32_16x16x32_bf16 v[44:47], a[204:207], v[124:127], v[44:47]
ds_read_b64_tr_b16 a[204:205], v8 offset:0
v_cvt_pk_bf16_f32 v171, v226, v227
v_mfma_f32_16x16x32_bf16 v[44:47], a[208:211], v[140:143], v[44:47]
ds_read_b64_tr_b16 a[206:207], v8 offset:6144
v_add_f32 v211, v211, v228
v_mfma_f32_16x16x32_bf16 v[44:47], a[212:215], v[156:159], v[44:47]
ds_read_b64_tr_b16 a[208:209], v5 offset:128
v_add_f32 v211, v211, v229
v_mfma_f32_16x16x32_bf16 v[48:51], a[216:219], v[64:67], v[192:195]
ds_read_b64_tr_b16 a[210:211], v5 offset:6272
v_cvt_pk_bf16_f32 v174, v228, v229
v_mfma_f32_16x16x32_bf16 v[48:51], a[220:223], v[80:83], v[48:51]
s_add_u32 m0, s25, 12288
ds_read_b64_tr_b16 a[212:213], v6 offset:128
v_add_f32 v211, v211, v230
v_mfma_f32_16x16x32_bf16 v[48:51], a[224:227], v[96:99], v[48:51]
s_waitcnt vmcnt(3)
buffer_load_dwordx4 v17, s[8:11], s27 offen offset:0 nt lds
v_mfma_f32_16x16x32_bf16 v[52:55], a[216:219], v[68:71], v[196:199]
ds_read_b64_tr_b16 a[214:215], v6 offset:6272
v_add_f32 v211, v211, v231
v_mfma_f32_16x16x32_bf16 v[52:55], a[220:223], v[84:87], v[52:55]
v_exp_f32 v220, v36
v_mfma_f32_16x16x32_bf16 v[52:55], a[224:227], v[100:103], v[52:55]
v_exp_f32 v221, v37
v_mfma_f32_16x16x32_bf16 v[56:59], a[216:219], v[72:75], v[200:203]
v_exp_f32 v222, v38
v_mfma_f32_16x16x32_bf16 v[56:59], a[220:223], v[88:91], v[56:59]
v_exp_f32 v223, v39
v_mfma_f32_16x16x32_bf16 v[56:59], a[224:227], v[104:107], v[56:59]
v_exp_f32 v224, v40
v_mfma_f32_16x16x32_bf16 v[60:63], a[216:219], v[76:79], v[204:207]
ds_read_b64_tr_b16 a[216:217], v7 offset:128
v_cvt_pk_bf16_f32 v175, v230, v231
v_mfma_f32_16x16x32_bf16 v[60:63], a[220:223], v[92:95], v[60:63]
ds_read_b64_tr_b16 a[218:219], v7 offset:6272
v_add_f32 v212, v216, v217
v_mfma_f32_16x16x32_bf16 v[60:63], a[224:227], v[108:111], v[60:63]
ds_read_b64_tr_b16 a[220:221], v8 offset:128
v_cvt_pk_bf16_f32 v176, v216, v217
v_mfma_f32_16x16x32_bf16 v[48:51], a[228:231], v[112:115], v[48:51]
s_waitcnt lgkmcnt(3)
ds_read_b64_tr_b16 a[222:223], v8 offset:6272
v_add_f32 v212, v212, v218
v_mfma_f32_16x16x32_bf16 v[48:51], a[232:235], v[128:131], v[48:51]
ds_read_b64_tr_b16 a[224:225], v5 offset:256
v_add_f32 v212, v212, v219
v_mfma_f32_16x16x32_bf16 v[48:51], a[236:239], v[144:147], v[48:51]
ds_read_b64_tr_b16 a[226:227], v5 offset:6400
v_cvt_pk_bf16_f32 v177, v218, v219
v_mfma_f32_16x16x32_bf16 v[52:55], a[228:231], v[116:119], v[52:55]
v_exp_f32 v225, v41
v_mfma_f32_16x16x32_bf16 v[52:55], a[232:235], v[132:135], v[52:55]
v_exp_f32 v226, v42
v_mfma_f32_16x16x32_bf16 v[52:55], a[236:239], v[148:151], v[52:55]
v_exp_f32 v227, v43
v_mfma_f32_16x16x32_bf16 v[56:59], a[228:231], v[120:123], v[56:59]
v_exp_f32 v228, v44
v_mfma_f32_16x16x32_bf16 v[56:59], a[232:235], v[136:139], v[56:59]
s_waitcnt vmcnt(3)
buffer_load_dwordx4 v18, s[8:11], s27 offen offset:1024 nt lds
v_mfma_f32_16x16x32_bf16 v[56:59], a[236:239], v[152:155], v[56:59]
v_exp_f32 v229, v45
v_mfma_f32_16x16x32_bf16 v[60:63], a[228:231], v[124:127], v[60:63]
ds_read_b64_tr_b16 a[228:229], v6 offset:256
v_add_f32 v213, v220, v221
v_mfma_f32_16x16x32_bf16 v[60:63], a[232:235], v[140:143], v[60:63]
ds_read_b64_tr_b16 a[230:231], v6 offset:6400
v_cvt_pk_bf16_f32 v180, v220, v221
v_mfma_f32_16x16x32_bf16 v[60:63], a[236:239], v[156:159], v[60:63]
ds_read_b64_tr_b16 a[232:233], v7 offset:256
v_add_f32 v213, v213, v222
v_mfma_f32_16x16x32_bf16 a[0:3], a[192:195], v[160:163], a[0:3]
ds_read_b64_tr_b16 a[234:235], v7 offset:6400
v_add_f32 v213, v213, v223
v_mfma_f32_16x16x32_bf16 a[4:7], a[192:195], v[164:167], a[4:7]
ds_read_b64_tr_b16 a[236:237], v8 offset:256
v_cvt_pk_bf16_f32 v181, v222, v223
v_mfma_f32_16x16x32_bf16 a[8:11], a[192:195], v[168:171], a[8:11]
ds_read_b64_tr_b16 a[238:239], v8 offset:6400
v_add_f32 v214, v224, v225
v_mfma_f32_16x16x32_bf16 a[12:15], a[192:195], v[172:175], a[12:15]
v_exp_f32 v230, v46
v_mfma_f32_16x16x32_bf16 a[28:31], a[196:199], v[172:175], a[28:31]
v_exp_f32 v231, v47
v_mfma_f32_16x16x32_bf16 a[24:27], a[196:199], v[168:171], a[24:27]
s_waitcnt lgkmcnt(0)
v_exp_f32 v216, v48
v_mfma_f32_16x16x32_bf16 a[20:23], a[196:199], v[164:167], a[20:23]
s_barrier
v_exp_f32 v217, v49
v_mfma_f32_16x16x32_bf16 a[16:19], a[196:199], v[160:163], a[16:19]
ds_read_b128 a[192:195], v1 offset:0
v_cvt_pk_bf16_f32 v184, v224, v225
v_mfma_f32_16x16x32_bf16 a[32:35], a[200:203], v[160:163], a[32:35]
ds_read_b128 a[196:199], v2 offset:0
v_add_f32 v214, v214, v226
v_mfma_f32_16x16x32_bf16 a[36:39], a[200:203], v[164:167], a[36:39]
v_exp_f32 v218, v50
v_mfma_f32_16x16x32_bf16 a[40:43], a[200:203], v[168:171], a[40:43]
v_exp_f32 v219, v51
v_mfma_f32_16x16x32_bf16 a[44:47], a[200:203], v[172:175], a[44:47]
ds_read_b128 a[200:203], v1 offset:128
v_add_f32 v214, v214, v227
v_mfma_f32_16x16x32_bf16 a[60:63], a[204:207], v[172:175], a[60:63]
s_waitcnt vmcnt(3)
buffer_load_dwordx4 v19, s[8:11], s27 offen offset:2048 nt lds
v_mfma_f32_16x16x32_bf16 a[56:59], a[204:207], v[168:171], a[56:59]
s_add_u32 s27, s27, 12288
v_exp_f32 v220, v52
v_mfma_f32_16x16x32_bf16 a[52:55], a[204:207], v[164:167], a[52:55]
v_exp_f32 v221, v53
v_mfma_f32_16x16x32_bf16 a[48:51], a[204:207], v[160:163], a[48:51]
ds_read_b128 a[204:207], v2 offset:128
v_cvt_pk_bf16_f32 v185, v226, v227
v_mfma_f32_16x16x32_bf16 a[64:67], a[208:211], v[160:163], a[64:67]
v_exp_f32 v222, v54
v_mfma_f32_16x16x32_bf16 a[68:71], a[208:211], v[164:167], a[68:71]
v_exp_f32 v223, v55
v_mfma_f32_16x16x32_bf16 a[72:75], a[208:211], v[168:171], a[72:75]
v_add_f32 v215, v228, v229
v_cvt_pk_bf16_f32 v188, v228, v229
v_mfma_f32_16x16x32_bf16 a[76:79], a[208:211], v[172:175], a[76:79]
ds_read_b128 a[208:211], v1 offset:256
v_add_f32 v215, v215, v230
v_mfma_f32_16x16x32_bf16 a[92:95], a[212:215], v[172:175], a[92:95]
v_add_f32 v215, v215, v231
v_cvt_pk_bf16_f32 v189, v230, v231
v_mfma_f32_16x16x32_bf16 a[88:91], a[212:215], v[168:171], a[88:91]
v_add_f32 v212, v212, v216
v_add_f32 v212, v212, v217
v_mfma_f32_16x16x32_bf16 a[84:87], a[212:215], v[164:167], a[84:87]
v_cvt_pk_bf16_f32 v178, v216, v217
v_add_f32 v212, v212, v218
v_mfma_f32_16x16x32_bf16 a[80:83], a[212:215], v[160:163], a[80:83]
ds_read_b128 a[212:215], v2 offset:256
v_add_f32 v212, v212, v219
v_mfma_f32_16x16x32_bf16 a[96:99], a[216:219], v[160:163], a[96:99]
v_cvt_pk_bf16_f32 v179, v218, v219
v_add_f32 v213, v213, v220
v_mfma_f32_16x16x32_bf16 a[100:103], a[216:219], v[164:167], a[100:103]
v_add_f32 v213, v213, v221
v_cvt_pk_bf16_f32 v182, v220, v221
v_mfma_f32_16x16x32_bf16 a[104:107], a[216:219], v[168:171], a[104:107]
v_add_f32 v213, v213, v222
v_add_f32 v213, v213, v223
v_mfma_f32_16x16x32_bf16 a[108:111], a[216:219], v[172:175], a[108:111]
ds_read_b128 a[216:219], v1 offset:6144
v_cvt_pk_bf16_f32 v183, v222, v223
v_mfma_f32_16x16x32_bf16 a[124:127], a[220:223], v[172:175], a[124:127]
s_mov_b32 m0, s29
v_max3_f32 v232, v56, v57, v58
v_max3_f32 v233, v59, v60, v61
v_mfma_f32_16x16x32_bf16 a[120:123], a[220:223], v[168:171], a[120:123]
s_waitcnt vmcnt(3)
buffer_load_dwordx4 v20, s[12:15], s28 offen offset:0 nt lds
v_mfma_f32_16x16x32_bf16 a[116:119], a[220:223], v[164:167], a[116:119]
v_max3_f32 v232, v232, v62, v63
v_max3_f32 v233, v233, v214, v215
v_mfma_f32_16x16x32_bf16 a[112:115], a[220:223], v[160:163], a[112:115]
s_add_u32 s29, s29, 12288
ds_read_b128 a[220:223], v2 offset:6144
v_max3_f32 v232, v232, v233, v212
v_mfma_f32_16x16x32_bf16 a[128:131], a[224:227], v[160:163], a[128:131]
v_max_f32 v232, v232, v213
v_cmp_lt_f32 vcc, 0x42800000, v232
v_mfma_f32_16x16x32_bf16 a[132:135], a[224:227], v[164:167], a[132:135]
s_cmp_eq_u32 s29, s25
s_cselect_b32 s29, s26, s29
v_mfma_f32_16x16x32_bf16 a[136:139], a[224:227], v[168:171], a[136:139]
v_mfma_f32_16x16x32_bf16 a[140:143], a[224:227], v[172:175], a[140:143]
ds_read_b128 a[224:227], v1 offset:6272
v_mfma_f32_16x16x32_bf16 a[156:159], a[228:231], v[172:175], a[156:159]
v_mfma_f32_16x16x32_bf16 a[152:155], a[228:231], v[168:171], a[152:155]
v_mfma_f32_16x16x32_bf16 a[148:151], a[228:231], v[164:167], a[148:151]
v_mfma_f32_16x16x32_bf16 a[144:147], a[228:231], v[160:163], a[144:147]
ds_read_b128 a[228:231], v2 offset:6272
v_mfma_f32_16x16x32_bf16 a[160:163], a[232:235], v[160:163], a[160:163]
v_mfma_f32_16x16x32_bf16 a[164:167], a[232:235], v[164:167], a[164:167]
v_mfma_f32_16x16x32_bf16 a[168:171], a[232:235], v[168:171], a[168:171]
v_mfma_f32_16x16x32_bf16 a[172:175], a[232:235], v[172:175], a[172:175]
ds_read_b128 a[232:235], v1 offset:6400
v_mfma_f32_16x16x32_bf16 a[188:191], a[236:239], v[172:175], a[188:191]
v_mfma_f32_16x16x32_bf16 a[184:187], a[236:239], v[168:171], a[184:187]
s_waitcnt lgkmcnt(1)
v_mfma_f32_16x16x32_bf16 a[180:183], a[236:239], v[164:167], a[180:183]
v_mfma_f32_16x16x32_bf16 a[176:179], a[236:239], v[160:163], a[176:179]
s_cbranch_vccnz L1_stub3
L1_back3:
v_mfma_f32_16x16x32_bf16 v[32:35], a[192:195], v[64:67], v[192:195]
ds_read_b128 a[236:239], v2 offset:6400
v_add_f32 v208, v208, v212
v_mfma_f32_16x16x32_bf16 v[32:35], a[196:199], v[80:83], v[32:35]
s_waitcnt vmcnt(3)
buffer_load_dwordx4 v21, s[12:15], s28 offen offset:1024 nt lds
v_mfma_f32_16x16x32_bf16 v[32:35], a[200:203], v[96:99], v[32:35]
v_exp_f32 v224, v56
v_mfma_f32_16x16x32_bf16 v[36:39], a[192:195], v[68:71], v[196:199]
v_exp_f32 v225, v57
v_mfma_f32_16x16x32_bf16 v[36:39], a[196:199], v[84:87], v[36:39]
v_exp_f32 v226, v58
v_mfma_f32_16x16x32_bf16 v[36:39], a[200:203], v[100:103], v[36:39]
v_exp_f32 v227, v59
v_mfma_f32_16x16x32_bf16 v[40:43], a[192:195], v[72:75], v[200:203]
v_exp_f32 v228, v60
v_mfma_f32_16x16x32_bf16 v[40:43], a[196:199], v[88:91], v[40:43]
v_exp_f32 v229, v61
v_mfma_f32_16x16x32_bf16 v[40:43], a[200:203], v[104:107], v[40:43]
v_exp_f32 v230, v62
v_mfma_f32_16x16x32_bf16 v[44:47], a[192:195], v[76:79], v[204:207]
ds_read_b64_tr_b16 a[192:193], v5 offset:12288
v_add_f32 v209, v209, v213
v_mfma_f32_16x16x32_bf16 v[44:47], a[196:199], v[92:95], v[44:47]
ds_read_b64_tr_b16 a[194:195], v5 offset:18432
v_add_f32 v210, v210, v214
v_mfma_f32_16x16x32_bf16 v[44:47], a[200:203], v[108:111], v[44:47]
ds_read_b64_tr_b16 a[196:197], v6 offset:12288
v_add_f32 v211, v211, v215
v_mfma_f32_16x16x32_bf16 v[32:35], a[204:207], v[112:115], v[32:35]
ds_read_b64_tr_b16 a[198:199], v6 offset:18432
v_add_f32 v210, v210, v224
v_mfma_f32_16x16x32_bf16 v[32:35], a[208:211], v[128:131], v[32:35]
ds_read_b64_tr_b16 a[200:201], v7 offset:12288
v_add_f32 v210, v210, v225
v_mfma_f32_16x16x32_bf16 v[32:35], a[212:215], v[144:147], v[32:35]
ds_read_b64_tr_b16 a[202:203], v7 offset:18432
v_cvt_pk_bf16_f32 v186, v224, v225
v_mfma_f32_16x16x32_bf16 v[36:39], a[204:207], v[116:119], v[36:39]
s_waitcnt vmcnt(3)
buffer_load_dwordx4 v22, s[12:15], s28 offen offset:2048 nt lds
v_mfma_f32_16x16x32_bf16 v[36:39], a[208:211], v[132:135], v[36:39]
s_add_u32 s28, s28, 12288
v_exp_f32 v231, v63
v_mfma_f32_16x16x32_bf16 v[36:39], a[212:215], v[148:151], v[36:39]
v_exp_f32 v216, v32
v_mfma_f32_16x16x32_bf16 v[40:43], a[204:207], v[120:123], v[40:43]
v_exp_f32 v217, v33
v_mfma_f32_16x16x32_bf16 v[40:43], a[208:211], v[136:139], v[40:43]
v_exp_f32 v218, v34
v_mfma_f32_16x16x32_bf16 v[40:43], a[212:215], v[152:155], v[40:43]
v_exp_f32 v219, v35
v_mfma_f32_16x16x32_bf16 v[44:47], a[204:207], v[124:127], v[44:47]
ds_read_b64_tr_b16 a[204:205], v8 offset:12288
v_add_f32 v210, v210, v226
v_mfma_f32_16x16x32_bf16 v[44:47], a[208:211], v[140:143], v[44:47]
ds_read_b64_tr_b16 a[206:207], v8 offset:18432
v_add_f32 v210, v210, v227
v_mfma_f32_16x16x32_bf16 v[44:47], a[212:215], v[156:159], v[44:47]
ds_read_b64_tr_b16 a[208:209], v5 offset:12416
v_cvt_pk_bf16_f32 v187, v226, v227
v_mfma_f32_16x16x32_bf16 v[48:51], a[216:219], v[64:67], v[192:195]
ds_read_b64_tr_b16 a[210:211], v5 offset:18560
v_add_f32 v211, v211, v228
v_mfma_f32_16x16x32_bf16 v[48:51], a[220:223], v[80:83], v[48:51]
ds_read_b64_tr_b16 a[212:213], v6 offset:12416
v_add_f32 v211, v211, v229
v_mfma_f32_16x16x32_bf16 v[48:51], a[224:227], v[96:99], v[48:51]
ds_read_b64_tr_b16 a[214:215], v6 offset:18560
v_cvt_pk_bf16_f32 v190, v228, v229
v_mfma_f32_16x16x32_bf16 v[52:55], a[216:219], v[68:71], v[196:199]
v_exp_f32 v220, v36
v_mfma_f32_16x16x32_bf16 v[52:55], a[220:223], v[84:87], v[52:55]
v_exp_f32 v221, v37
v_mfma_f32_16x16x32_bf16 v[52:55], a[224:227], v[100:103], v[52:55]
v_exp_f32 v222, v38
v_mfma_f32_16x16x32_bf16 v[56:59], a[216:219], v[72:75], v[200:203]
v_exp_f32 v223, v39
v_mfma_f32_16x16x32_bf16 v[56:59], a[220:223], v[88:91], v[56:59]
s_add_u32 m0, s25, 24576
v_add_f32 v211, v211, v230
v_add_f32 v211, v211, v231
v_mfma_f32_16x16x32_bf16 v[56:59], a[224:227], v[104:107], v[56:59]
s_waitcnt vmcnt(3)
buffer_load_dwordx4 v17, s[8:11], s27 offen offset:0 nt lds
v_mfma_f32_16x16x32_bf16 v[60:63], a[216:219], v[76:79], v[204:207]
ds_read_b64_tr_b16 a[216:217], v7 offset:12416
v_cvt_pk_bf16_f32 v191, v230, v231
v_mfma_f32_16x16x32_bf16 v[60:63], a[220:223], v[92:95], v[60:63]
ds_read_b64_tr_b16 a[218:219], v7 offset:18560
v_add_f32 v212, v216, v217
v_mfma_f32_16x16x32_bf16 v[60:63], a[224:227], v[108:111], v[60:63]
ds_read_b64_tr_b16 a[220:221], v8 offset:12416
v_cvt_pk_bf16_f32 v160, v216, v217
v_mfma_f32_16x16x32_bf16 v[48:51], a[228:231], v[112:115], v[48:51]
s_waitcnt lgkmcnt(3)
ds_read_b64_tr_b16 a[222:223], v8 offset:18560
v_add_f32 v212, v212, v218
v_mfma_f32_16x16x32_bf16 v[48:51], a[232:235], v[128:131], v[48:51]
ds_read_b64_tr_b16 a[224:225], v5 offset:12544
v_add_f32 v212, v212, v219
v_mfma_f32_16x16x32_bf16 v[48:51], a[236:239], v[144:147], v[48:51]
ds_read_b64_tr_b16 a[226:227], v5 offset:18688
v_cvt_pk_bf16_f32 v161, v218, v219
v_mfma_f32_16x16x32_bf16 v[52:55], a[228:231], v[116:119], v[52:55]
v_exp_f32 v224, v40
v_mfma_f32_16x16x32_bf16 v[52:55], a[232:235], v[132:135], v[52:55]
v_exp_f32 v225, v41
v_mfma_f32_16x16x32_bf16 v[52:55], a[236:239], v[148:151], v[52:55]
v_exp_f32 v226, v42
v_mfma_f32_16x16x32_bf16 v[56:59], a[228:231], v[120:123], v[56:59]
v_exp_f32 v227, v43
v_mfma_f32_16x16x32_bf16 v[56:59], a[232:235], v[136:139], v[56:59]
v_exp_f32 v228, v44
v_mfma_f32_16x16x32_bf16 v[56:59], a[236:239], v[152:155], v[56:59]
s_waitcnt vmcnt(3)
buffer_load_dwordx4 v18, s[8:11], s27 offen offset:1024 nt lds
v_mfma_f32_16x16x32_bf16 v[60:63], a[228:231], v[124:127], v[60:63]
ds_read_b64_tr_b16 a[228:229], v6 offset:12544
v_add_f32 v213, v220, v221
v_mfma_f32_16x16x32_bf16 v[60:63], a[232:235], v[140:143], v[60:63]
ds_read_b64_tr_b16 a[230:231], v6 offset:18688
v_cvt_pk_bf16_f32 v164, v220, v221
v_mfma_f32_16x16x32_bf16 v[60:63], a[236:239], v[156:159], v[60:63]
ds_read_b64_tr_b16 a[232:233], v7 offset:12544
v_add_f32 v213, v213, v222
v_mfma_f32_16x16x32_bf16 a[0:3], a[192:195], v[176:179], a[0:3]
ds_read_b64_tr_b16 a[234:235], v7 offset:18688
v_add_f32 v213, v213, v223
v_mfma_f32_16x16x32_bf16 a[4:7], a[192:195], v[180:183], a[4:7]
ds_read_b64_tr_b16 a[236:237], v8 offset:12544
v_cvt_pk_bf16_f32 v165, v222, v223
v_mfma_f32_16x16x32_bf16 a[8:11], a[192:195], v[184:187], a[8:11]
ds_read_b64_tr_b16 a[238:239], v8 offset:18688
v_add_f32 v214, v224, v225
v_mfma_f32_16x16x32_bf16 a[12:15], a[192:195], v[188:191], a[12:15]
v_exp_f32 v229, v45
v_mfma_f32_16x16x32_bf16 a[28:31], a[196:199], v[188:191], a[28:31]
v_exp_f32 v230, v46
v_mfma_f32_16x16x32_bf16 a[24:27], a[196:199], v[184:187], a[24:27]
s_waitcnt lgkmcnt(0)
v_exp_f32 v231, v47
v_mfma_f32_16x16x32_bf16 a[20:23], a[196:199], v[180:183], a[20:23]
s_barrier
v_exp_f32 v216, v48
v_mfma_f32_16x16x32_bf16 a[16:19], a[196:199], v[176:179], a[16:19]
ds_read_b128 a[192:195], v1 offset:12288
v_cvt_pk_bf16_f32 v168, v224, v225
v_mfma_f32_16x16x32_bf16 a[32:35], a[200:203], v[176:179], a[32:35]
ds_read_b128 a[196:199], v2 offset:12288
v_add_f32 v214, v214, v226
v_mfma_f32_16x16x32_bf16 a[36:39], a[200:203], v[180:183], a[36:39]
v_exp_f32 v217, v49
v_mfma_f32_16x16x32_bf16 a[40:43], a[200:203], v[184:187], a[40:43]
v_exp_f32 v218, v50
v_mfma_f32_16x16x32_bf16 a[44:47], a[200:203], v[188:191], a[44:47]
ds_read_b128 a[200:203], v1 offset:12416
v_add_f32 v214, v214, v227
v_mfma_f32_16x16x32_bf16 a[60:63], a[204:207], v[188:191], a[60:63]
v_exp_f32 v219, v51
v_mfma_f32_16x16x32_bf16 a[56:59], a[204:207], v[184:187], a[56:59]
v_exp_f32 v220, v52
v_mfma_f32_16x16x32_bf16 a[52:55], a[204:207], v[180:183], a[52:55]
v_exp_f32 v221, v53
v_mfma_f32_16x16x32_bf16 a[48:51], a[204:207], v[176:179], a[48:51]
ds_read_b128 a[204:207], v2 offset:12416
v_cvt_pk_bf16_f32 v169, v226, v227
v_mfma_f32_16x16x32_bf16 a[64:67], a[208:211], v[176:179], a[64:67]
v_exp_f32 v222, v54
v_mfma_f32_16x16x32_bf16 a[68:71], a[208:211], v[180:183], a[68:71]
v_exp_f32 v223, v55
v_mfma_f32_16x16x32_bf16 a[72:75], a[208:211], v[184:187], a[72:75]
s_waitcnt vmcnt(3)
buffer_load_dwordx4 v19, s[8:11], s27 offen offset:2048 nt lds
v_mfma_f32_16x16x32_bf16 a[76:79], a[208:211], v[188:191], a[76:79]
s_add_u32 s27, s27, 12288
ds_read_b128 a[208:211], v1 offset:12544
v_add_f32 v215, v228, v229
v_mfma_f32_16x16x32_bf16 a[92:95], a[212:215], v[188:191], a[92:95]
v_cvt_pk_bf16_f32 v172, v228, v229
v_add_f32 v215, v215, v230
v_mfma_f32_16x16x32_bf16 a[88:91], a[212:215], v[184:187], a[88:91]
v_add_f32 v215, v215, v231
v_cvt_pk_bf16_f32 v173, v230, v231
v_mfma_f32_16x16x32_bf16 a[84:87], a[212:215], v[180:183], a[84:87]
v_add_f32 v212, v212, v216
v_add_f32 v212, v212, v217
v_mfma_f32_16x16x32_bf16 a[80:83], a[212:215], v[176:179], a[80:83]
ds_read_b128 a[212:215], v2 offset:12544
v_cvt_pk_bf16_f32 v162, v216, v217
v_mfma_f32_16x16x32_bf16 a[96:99], a[216:219], v[176:179], a[96:99]
v_add_f32 v212, v212, v218
v_add_f32 v212, v212, v219
v_mfma_f32_16x16x32_bf16 a[100:103], a[216:219], v[180:183], a[100:103]
v_cvt_pk_bf16_f32 v163, v218, v219
v_add_f32 v213, v213, v220
v_mfma_f32_16x16x32_bf16 a[104:107], a[216:219], v[184:187], a[104:107]
v_add_f32 v213, v213, v221
v_cvt_pk_bf16_f32 v166, v220, v221
v_mfma_f32_16x16x32_bf16 a[108:111], a[216:219], v[188:191], a[108:111]
ds_read_b128 a[216:219], v1 offset:18432
v_add_f32 v213, v213, v222
v_mfma_f32_16x16x32_bf16 a[124:127], a[220:223], v[188:191], a[124:127]
v_add_f32 v213, v213, v223
v_cvt_pk_bf16_f32 v167, v222, v223
v_mfma_f32_16x16x32_bf16 a[120:123], a[220:223], v[184:187], a[120:123]
v_max3_f32 v232, v56, v57, v58
v_max3_f32 v233, v59, v60, v61
v_mfma_f32_16x16x32_bf16 a[116:119], a[220:223], v[180:183], a[116:119]
v_max3_f32 v232, v232, v62, v63
v_max3_f32 v233, v233, v214, v215
v_mfma_f32_16x16x32_bf16 a[112:115], a[220:223], v[176:179], a[112:115]
ds_read_b128 a[220:223], v2 offset:18432
v_max3_f32 v232, v232, v233, v212
v_mfma_f32_16x16x32_bf16 a[128:131], a[224:227], v[176:179], a[128:131]
v_max_f32 v232, v232, v213
v_cmp_lt_f32 vcc, 0x42800000, v232
v_mfma_f32_16x16x32_bf16 a[132:135], a[224:227], v[180:183], a[132:135]
v_mfma_f32_16x16x32_bf16 a[136:139], a[224:227], v[184:187], a[136:139]
s_mov_b32 m0, s29
v_mfma_f32_16x16x32_bf16 a[140:143], a[224:227], v[188:191], a[140:143]
s_waitcnt vmcnt(3)
buffer_load_dwordx4 v20, s[12:15], s28 offen offset:0 nt lds
v_mfma_f32_16x16x32_bf16 a[156:159], a[228:231], v[188:191], a[156:159]
ds_read_b128 a[224:227], v1 offset:18560
v_mfma_f32_16x16x32_bf16 a[152:155], a[228:231], v[184:187], a[152:155]
s_add_u32 s29, s29, 12288
v_mfma_f32_16x16x32_bf16 a[148:151], a[228:231], v[180:183], a[148:151]
v_mfma_f32_16x16x32_bf16 a[144:147], a[228:231], v[176:179], a[144:147]
s_cmp_eq_u32 s29, s25
s_cselect_b32 s29, s26, s29
ds_read_b128 a[228:231], v2 offset:18560
v_mfma_f32_16x16x32_bf16 a[160:163], a[232:235], v[176:179], a[160:163]
v_mfma_f32_16x16x32_bf16 a[164:167], a[232:235], v[180:183], a[164:167]
v_mfma_f32_16x16x32_bf16 a[168:171], a[232:235], v[184:187], a[168:171]
v_mfma_f32_16x16x32_bf16 a[172:175], a[232:235], v[188:191], a[172:175]
ds_read_b128 a[232:235], v1 offset:18688
v_mfma_f32_16x16x32_bf16 a[188:191], a[236:239], v[188:191], a[188:191]
v_mfma_f32_16x16x32_bf16 a[184:187], a[236:239], v[184:187], a[184:187]
s_waitcnt lgkmcnt(1)
v_mfma_f32_16x16x32_bf16 a[180:183], a[236:239], v[180:183], a[180:183]
v_mfma_f32_16x16x32_bf16 a[176:179], a[236:239], v[176:179], a[176:179]
s_cbranch_vccnz L1_stub4
L1_back4:
v_mfma_f32_16x16x32_bf16 v[32:35], a[192:195], v[64:67], v[192:195]
ds_read_b128 a[236:239], v2 offset:18688
v_add_f32 v208, v208, v212
v_mfma_f32_16x16x32_bf16 v[32:35], a[196:199], v[80:83], v[32:35]
v_exp_f32 v224, v56
v_mfma_f32_16x16x32_bf16 v[32:35], a[200:203], v[96:99], v[32:35]
v_exp_f32 v225, v57
v_mfma_f32_16x16x32_bf16 v[36:39], a[192:195], v[68:71], v[196:199]
v_exp_f32 v226, v58
v_mfma_f32_16x16x32_bf16 v[36:39], a[196:199], v[84:87], v[36:39]
s_waitcnt vmcnt(3)
buffer_load_dwordx4 v21, s[12:15], s28 offen offset:1024 nt lds
v_mfma_f32_16x16x32_bf16 v[36:39], a[200:203], v[100:103], v[36:39]
v_exp_f32 v227, v59
v_mfma_f32_16x16x32_bf16 v[40:43], a[192:195], v[72:75], v[200:203]
v_exp_f32 v228, v60
v_mfma_f32_16x16x32_bf16 v[40:43], a[196:199], v[88:91], v[40:43]
v_exp_f32 v229, v61
v_mfma_f32_16x16x32_bf16 v[40:43], a[200:203], v[104:107], v[40:43]
v_exp_f32 v230, v62
v_mfma_f32_16x16x32_bf16 v[44:47], a[192:195], v[76:79], v[204:207]
ds_read_b64_tr_b16 a[192:193], v5 offset:24576
v_add_f32 v209, v209, v213
v_mfma_f32_16x16x32_bf16 v[44:47], a[196:199], v[92:95], v[44:47]
ds_read_b64_tr_b16 a[194:195], v5 offset:30720
v_add_f32 v210, v210, v214
v_mfma_f32_16x16x32_bf16 v[44:47], a[200:203], v[108:111], v[44:47]
ds_read_b64_tr_b16 a[196:197], v6 offset:24576
v_add_f32 v211, v211, v215
v_mfma_f32_16x16x32_bf16 v[32:35], a[204:207], v[112:115], v[32:35]
ds_read_b64_tr_b16 a[198:199], v6 offset:30720
v_add_f32 v210, v210, v224
v_mfma_f32_16x16x32_bf16 v[32:35], a[208:211], v[128:131], v[32:35]
ds_read_b64_tr_b16 a[200:201], v7 offset:24576
v_add_f32 v210, v210, v225
v_mfma_f32_16x16x32_bf16 v[32:35], a[212:215], v[144:147], v[32:35]
ds_read_b64_tr_b16 a[202:203], v7 offset:30720
v_cvt_pk_bf16_f32 v170, v224, v225
v_mfma_f32_16x16x32_bf16 v[36:39], a[204:207], v[116:119], v[36:39]
v_exp_f32 v231, v63
v_mfma_f32_16x16x32_bf16 v[36:39], a[208:211], v[132:135], v[36:39]
v_add_f32 v210, v210, v226
v_add_f32 v210, v210, v227
v_mfma_f32_16x16x32_bf16 v[36:39], a[212:215], v[148:151], v[36:39]
v_exp_f32 v216, v32
v_mfma_f32_16x16x32_bf16 v[40:43], a[204:207], v[120:123], v[40:43]
v_exp_f32 v217, v33
v_mfma_f32_16x16x32_bf16 v[40:43], a[208:211], v[136:139], v[40:43]
v_exp_f32 v218, v34
v_mfma_f32_16x16x32_bf16 v[40:43], a[212:215], v[152:155], v[40:43]
v_exp_f32 v219, v35
v_mfma_f32_16x16x32_bf16 v[44:47], a[204:207], v[124:127], v[44:47]
s_waitcnt vmcnt(3)
buffer_load_dwordx4 v22, s[12:15], s28 offen offset:2048 nt lds
v_mfma_f32_16x16x32_bf16 v[44:47], a[208:211], v[140:143], v[44:47]
s_add_u32 s28, s28, 12288
ds_read_b64_tr_b16 a[204:205], v8 offset:24576
v_cvt_pk_bf16_f32 v171, v226, v227
v_mfma_f32_16x16x32_bf16 v[44:47], a[212:215], v[156:159], v[44:47]
ds_read_b64_tr_b16 a[206:207], v8 offset:30720
v_add_f32 v211, v211, v228
v_mfma_f32_16x16x32_bf16 v[48:51], a[216:219], v[64:67], v[192:195]
ds_read_b64_tr_b16 a[208:209], v5 offset:24704
v_add_f32 v211, v211, v229
v_mfma_f32_16x16x32_bf16 v[48:51], a[220:223], v[80:83], v[48:51]
ds_read_b64_tr_b16 a[210:211], v5 offset:30848
v_cvt_pk_bf16_f32 v174, v228, v229
v_mfma_f32_16x16x32_bf16 v[48:51], a[224:227], v[96:99], v[48:51]
ds_read_b64_tr_b16 a[212:213], v6 offset:24704
v_add_f32 v211, v211, v230
v_mfma_f32_16x16x32_bf16 v[52:55], a[216:219], v[68:71], v[196:199]
ds_read_b64_tr_b16 a[214:215], v6 offset:30848
v_add_f32 v211, v211, v231
v_mfma_f32_16x16x32_bf16 v[52:55], a[220:223], v[84:87], v[52:55]
v_exp_f32 v220, v36
v_mfma_f32_16x16x32_bf16 v[52:55], a[224:227], v[100:103], v[52:55]
v_exp_f32 v221, v37
v_mfma_f32_16x16x32_bf16 v[56:59], a[216:219], v[72:75], v[200:203]
v_exp_f32 v222, v38
v_mfma_f32_16x16x32_bf16 v[56:59], a[220:223], v[88:91], v[56:59]
v_exp_f32 v223, v39
v_mfma_f32_16x16x32_bf16 v[56:59], a[224:227], v[104:107], v[56:59]
v_exp_f32 v224, v40
v_mfma_f32_16x16x32_bf16 v[60:63], a[216:219], v[76:79], v[204:207]
ds_read_b64_tr_b16 a[216:217], v7 offset:24704
v_cvt_pk_bf16_f32 v175, v230, v231
v_mfma_f32_16x16x32_bf16 v[60:63], a[220:223], v[92:95], v[60:63]
ds_read_b64_tr_b16 a[218:219], v7 offset:30848
v_add_f32 v212, v216, v217
v_mfma_f32_16x16x32_bf16 v[60:63], a[224:227], v[108:111], v[60:63]
ds_read_b64_tr_b16 a[220:221], v8 offset:24704
v_cvt_pk_bf16_f32 v176, v216, v217
v_mfma_f32_16x16x32_bf16 v[48:51], a[228:231], v[112:115], v[48:51]
s_waitcnt lgkmcnt(3)
ds_read_b64_tr_b16 a[222:223], v8 offset:30848
v_add_f32 v212, v212, v218
v_mfma_f32_16x16x32_bf16 v[48:51], a[232:235], v[128:131], v[48:51]
s_add_u32 m0, s25, 36864
ds_read_b64_tr_b16 a[224:225], v5 offset:24832
v_add_f32 v212, v212, v219
v_mfma_f32_16x16x32_bf16 v[48:51], a[236:239], v[144:147], v[48:51]
s_waitcnt vmcnt(3)
buffer_load_dwordx4 v17, s[8:11], s27 offen offset:0 nt lds
v_mfma_f32_16x16x32_bf16 v[52:55], a[228:231], v[116:119], v[52:55]
ds_read_b64_tr_b16 a[226:227], v5 offset:30976
v_cvt_pk_bf16_f32 v177, v218, v219
v_mfma_f32_16x16x32_bf16 v[52:55], a[232:235], v[132:135], v[52:55]
v_exp_f32 v225, v41
v_mfma_f32_16x16x32_bf16 v[52:55], a[236:239], v[148:151], v[52:55]
v_exp_f32 v226, v42
v_mfma_f32_16x16x32_bf16 v[56:59], a[228:231], v[120:123], v[56:59]
v_exp_f32 v227, v43
v_mfma_f32_16x16x32_bf16 v[56:59], a[232:235], v[136:139], v[56:59]
v_exp_f32 v228, v44
v_mfma_f32_16x16x32_bf16 v[56:59], a[236:239], v[152:155], v[56:59]
v_exp_f32 v229, v45
v_mfma_f32_16x16x32_bf16 v[60:63], a[228:231], v[124:127], v[60:63]
ds_read_b64_tr_b16 a[228:229], v6 offset:24832
v_add_f32 v213, v220, v221
v_mfma_f32_16x16x32_bf16 v[60:63], a[232:235], v[140:143], v[60:63]
ds_read_b64_tr_b16 a[230:231], v6 offset:30976
v_cvt_pk_bf16_f32 v180, v220, v221
v_mfma_f32_16x16x32_bf16 v[60:63], a[236:239], v[156:159], v[60:63]
ds_read_b64_tr_b16 a[232:233], v7 offset:24832
v_add_f32 v213, v213, v222
v_mfma_f32_16x16x32_bf16 a[0:3], a[192:195], v[160:163], a[0:3]
ds_read_b64_tr_b16 a[234:235], v7 offset:30976
v_add_f32 v213, v213, v223
v_mfma_f32_16x16x32_bf16 a[4:7], a[192:195], v[164:167], a[4:7]
ds_read_b64_tr_b16 a[236:237], v8 offset:24832
v_cvt_pk_bf16_f32 v181, v222, v223
v_mfma_f32_16x16x32_bf16 a[8:11], a[192:195], v[168:171], a[8:11]
ds_read_b64_tr_b16 a[238:239], v8 offset:30976
v_add_f32 v214, v224, v225
v_mfma_f32_16x16x32_bf16 a[12:15], a[192:195], v[172:175], a[12:15]
v_exp_f32 v230, v46
v_mfma_f32_16x16x32_bf16 a[28:31], a[196:199], v[172:175], a[28:31]
v_exp_f32 v231, v47
v_mfma_f32_16x16x32_bf16 a[24:27], a[196:199], v[168:171], a[24:27]
s_waitcnt lgkmcnt(0)
v_exp_f32 v216, v48
v_mfma_f32_16x16x32_bf16 a[20:23], a[196:199], v[164:167], a[20:23]
s_barrier
v_exp_f32 v217, v49
v_mfma_f32_16x16x32_bf16 a[16:19], a[196:199], v[160:163], a[16:19]
ds_read_b128 a[192:195], v1 offset:24576
v_cvt_pk_bf16_f32 v184, v224, v225
v_mfma_f32_16x16x32_bf16 a[32:35], a[200:203], v[160:163], a[32:35]
s_waitcnt vmcnt(3)
buffer_load_dwordx4 v18, s[8:11], s27 offen offset:1024 nt lds
v_mfma_f32_16x16x32_bf16 a[36:39], a[200:203], v[164:167], a[36:39]
ds_read_b128 a[196:199], v2 offset:24576
v_add_f32 v214, v214, v226
v_mfma_f32_16x16x32_bf16 a[40:43], a[200:203], v[168:171], a[40:43]
v_exp_f32 v218, v50
v_mfma_f32_16x16x32_bf16 a[44:47], a[200:203], v[172:175], a[44:47]
ds_read_b128 a[200:203], v1 offset:24704
v_add_f32 v214, v214, v227
v_mfma_f32_16x16x32_bf16 a[60:63], a[204:207], v[172:175], a[60:63]
v_exp_f32 v219, v51
v_mfma_f32_16x16x32_bf16 a[56:59], a[204:207], v[168:171], a[56:59]
v_exp_f32 v220, v52
v_mfma_f32_16x16x32_bf16 a[52:55], a[204:207], v[164:167], a[52:55]
v_exp_f32 v221, v53
v_mfma_f32_16x16x32_bf16 a[48:51], a[204:207], v[160:163], a[48:51]
ds_read_b128 a[204:207], v2 offset:24704
v_cvt_pk_bf16_f32 v185, v226, v227
v_mfma_f32_16x16x32_bf16 a[64:67], a[208:211], v[160:163], a[64:67]
v_exp_f32 v222, v54
v_mfma_f32_16x16x32_bf16 a[68:71], a[208:211], v[164:167], a[68:71]
v_exp_f32 v223, v55
v_mfma_f32_16x16x32_bf16 a[72:75], a[208:211], v[168:171], a[72:75]
v_add_f32 v215, v228, v229
v_cvt_pk_bf16_f32 v188, v228, v229
v_mfma_f32_16x16x32_bf16 a[76:79], a[208:211], v[172:175], a[76:79]
ds_read_b128 a[208:211], v1 offset:24832
v_add_f32 v215, v215, v230
v_mfma_f32_16x16x32_bf16 a[92:95], a[212:215], v[172:175], a[92:95]
v_add_f32 v215, v215, v231
v_cvt_pk_bf16_f32 v189, v230, v231
v_mfma_f32_16x16x32_bf16 a[88:91], a[212:215], v[168:171], a[88:91]
v_add_f32 v212, v212, v216
v_add_f32 v212, v212, v217
v_mfma_f32_16x16x32_bf16 a[84:87], a[212:215], v[164:167], a[84:87]
v_cvt_pk_bf16_f32 v178, v216, v217
v_add_f32 v212, v212, v218
v_mfma_f32_16x16x32_bf16 a[80:83], a[212:215], v[160:163], a[80:83]
ds_read_b128 a[212:215], v2 offset:24832
v_add_f32 v212, v212, v219
v_mfma_f32_16x16x32_bf16 a[96:99], a[216:219], v[160:163], a[96:99]
s_waitcnt vmcnt(3)
buffer_load_dwordx4 v19, s[8:11], s27 offen offset:2048 nt lds
v_mfma_f32_16x16x32_bf16 a[100:103], a[216:219], v[164:167], a[100:103]
s_add_u32 s27, s27, 12288
v_cvt_pk_bf16_f32 v179, v218, v219
v_add_f32 v213, v213, v220
v_mfma_f32_16x16x32_bf16 a[104:107], a[216:219], v[168:171], a[104:107]
v_add_f32 v213, v213, v221
v_cvt_pk_bf16_f32 v182, v220, v221
v_mfma_f32_16x16x32_bf16 a[108:111], a[216:219], v[172:175], a[108:111]
ds_read_b128 a[216:219], v1 offset:30720
v_add_f32 v213, v213, v222
v_mfma_f32_16x16x32_bf16 a[124:127], a[220:223], v[172:175], a[124:127]
v_add_f32 v213, v213, v223
v_cvt_pk_bf16_f32 v183, v222, v223
v_mfma_f32_16x16x32_bf16 a[120:123], a[220:223], v[168:171], a[120:123]
v_max3_f32 v232, v56, v57, v58
v_max3_f32 v233, v59, v60, v61
v_mfma_f32_16x16x32_bf16 a[116:119], a[220:223], v[164:167], a[116:119]
v_max3_f32 v232, v232, v62, v63
v_max3_f32 v233, v233, v214, v215
v_mfma_f32_16x16x32_bf16 a[112:115], a[220:223], v[160:163], a[112:115]
ds_read_b128 a[220:223], v2 offset:30720
v_max3_f32 v232, v232, v233, v212
v_mfma_f32_16x16x32_bf16 a[128:131], a[224:227], v[160:163], a[128:131]
v_max_f32 v232, v232, v213
v_cmp_lt_f32 vcc, 0x42800000, v232
v_mfma_f32_16x16x32_bf16 a[132:135], a[224:227], v[164:167], a[132:135]
v_mfma_f32_16x16x32_bf16 a[136:139], a[224:227], v[168:171], a[136:139]
v_mfma_f32_16x16x32_bf16 a[140:143], a[224:227], v[172:175], a[140:143]
ds_read_b128 a[224:227], v1 offset:30848
v_mfma_f32_16x16x32_bf16 a[156:159], a[228:231], v[172:175], a[156:159]
v_mfma_f32_16x16x32_bf16 a[152:155], a[228:231], v[168:171], a[152:155]
v_mfma_f32_16x16x32_bf16 a[148:151], a[228:231], v[164:167], a[148:151]
v_mfma_f32_16x16x32_bf16 a[144:147], a[228:231], v[160:163], a[144:147]
ds_read_b128 a[228:231], v2 offset:30848
v_mfma_f32_16x16x32_bf16 a[160:163], a[232:235], v[160:163], a[160:163]
v_mfma_f32_16x16x32_bf16 a[164:167], a[232:235], v[164:167], a[164:167]
v_mfma_f32_16x16x32_bf16 a[168:171], a[232:235], v[168:171], a[168:171]
s_sub_u32 s34, s34, 1
v_mfma_f32_16x16x32_bf16 a[172:175], a[232:235], v[172:175], a[172:175]
ds_read_b128 a[232:235], v1 offset:30976
v_mfma_f32_16x16x32_bf16 a[188:191], a[236:239], v[172:175], a[188:191]
v_mfma_f32_16x16x32_bf16 a[184:187], a[236:239], v[168:171], a[184:187]
s_waitcnt lgkmcnt(1)
v_mfma_f32_16x16x32_bf16 a[180:183], a[236:239], v[164:167], a[180:183]
v_mfma_f32_16x16x32_bf16 a[176:179], a[236:239], v[160:163], a[176:179]
s_cbranch_vccnz L1_stub5
L1_back5:
s_cmp_lg_u32 s34, 0
s_cbranch_scc1 L1_loop
v_mfma_f32_16x16x32_bf16 v[32:35], a[192:195], v[64:67], v[192:195]
ds_read_b128 a[236:239], v2 offset:30976
v_add_f32 v208, v208, v212
v_mfma_f32_16x16x32_bf16 v[32:35], a[196:199], v[80:83], v[32:35]
s_add_u32 m0, s26, 61440
v_exp_f32 v224, v56
v_mfma_f32_16x16x32_bf16 v[32:35], a[200:203], v[96:99], v[32:35]
buffer_load_dwordx4 v20, s[12:15], s28 offen offset:0 nt lds
v_mfma_f32_16x16x32_bf16 v[36:39], a[192:195], v[68:71], v[196:199]
v_exp_f32 v225, v57
v_mfma_f32_16x16x32_bf16 v[36:39], a[196:199], v[84:87], v[36:39]
v_exp_f32 v226, v58
v_mfma_f32_16x16x32_bf16 v[36:39], a[200:203], v[100:103], v[36:39]
v_exp_f32 v227, v59
v_mfma_f32_16x16x32_bf16 v[40:43], a[192:195], v[72:75], v[200:203]
v_exp_f32 v228, v60
v_mfma_f32_16x16x32_bf16 v[40:43], a[196:199], v[88:91], v[40:43]
v_exp_f32 v229, v61
v_mfma_f32_16x16x32_bf16 v[40:43], a[200:203], v[104:107], v[40:43]
v_exp_f32 v230, v62
v_mfma_f32_16x16x32_bf16 v[44:47], a[192:195], v[76:79], v[204:207]
ds_read_b64_tr_b16 a[192:193], v9 offset:0
v_add_f32 v209, v209, v213
v_mfma_f32_16x16x32_bf16 v[44:47], a[196:199], v[92:95], v[44:47]
ds_read_b64_tr_b16 a[194:195], v9 offset:6144
v_add_f32 v210, v210, v214
v_mfma_f32_16x16x32_bf16 v[44:47], a[200:203], v[108:111], v[44:47]
ds_read_b64_tr_b16 a[196:197], v10 offset:0
v_add_f32 v211, v211, v215
v_mfma_f32_16x16x32_bf16 v[32:35], a[204:207], v[112:115], v[32:35]
ds_read_b64_tr_b16 a[198:199], v10 offset:6144
v_add_f32 v210, v210, v224
v_mfma_f32_16x16x32_bf16 v[32:35], a[208:211], v[128:131], v[32:35]
ds_read_b64_tr_b16 a[200:201], v11 offset:0
v_add_f32 v210, v210, v225
v_mfma_f32_16x16x32_bf16 v[32:35], a[212:215], v[144:147], v[32:35]
ds_read_b64_tr_b16 a[202:203], v11 offset:6144
v_cvt_pk_bf16_f32 v186, v224, v225
v_mfma_f32_16x16x32_bf16 v[36:39], a[204:207], v[116:119], v[36:39]
buffer_load_dwordx4 v21, s[12:15], s28 offen offset:1024 nt lds
v_mfma_f32_16x16x32_bf16 v[36:39], a[208:211], v[132:135], v[36:39]
v_exp_f32 v231, v63
v_mfma_f32_16x16x32_bf16 v[36:39], a[212:215], v[148:151], v[36:39]
v_add_f32 v210, v210, v226
v_add_f32 v210, v210, v227
v_mfma_f32_16x16x32_bf16 v[40:43], a[204:207], v[120:123], v[40:43]
v_exp_f32 v216, v32
v_mfma_f32_16x16x32_bf16 v[40:43], a[208:211], v[136:139], v[40:43]
v_exp_f32 v217, v33
v_mfma_f32_16x16x32_bf16 v[40:43], a[212:215], v[152:155], v[40:43]
v_exp_f32 v218, v34
v_mfma_f32_16x16x32_bf16 v[44:47], a[204:207], v[124:127], v[44:47]
ds_read_b64_tr_b16 a[204:205], v12 offset:0
v_cvt_pk_bf16_f32 v187, v226, v227
v_mfma_f32_16x16x32_bf16 v[44:47], a[208:211], v[140:143], v[44:47]
ds_read_b64_tr_b16 a[206:207], v12 offset:6144
v_add_f32 v211, v211, v228
v_mfma_f32_16x16x32_bf16 v[44:47], a[212:215], v[156:159], v[44:47]
ds_read_b64_tr_b16 a[208:209], v9 offset:128
v_add_f32 v211, v211, v229
v_mfma_f32_16x16x32_bf16 v[48:51], a[216:219], v[64:67], v[192:195]
ds_read_b64_tr_b16 a[210:211], v9 offset:6272
v_cvt_pk_bf16_f32 v190, v228, v229
v_mfma_f32_16x16x32_bf16 v[48:51], a[220:223], v[80:83], v[48:51]
ds_read_b64_tr_b16 a[212:213], v10 offset:128
v_add_f32 v211, v211, v230
v_mfma_f32_16x16x32_bf16 v[48:51], a[224:227], v[96:99], v[48:51]
ds_read_b64_tr_b16 a[214:215], v10 offset:6272
v_add_f32 v211, v211, v231
v_mfma_f32_16x16x32_bf16 v[52:55], a[216:219], v[68:71], v[196:199]
v_exp_f32 v219, v35
v_mfma_f32_16x16x32_bf16 v[52:55], a[220:223], v[84:87], v[52:55]
buffer_load_dwordx4 v22, s[12:15], s28 offen offset:2048 nt lds
v_mfma_f32_16x16x32_bf16 v[52:55], a[224:227], v[100:103], v[52:55]
s_add_u32 s28, s28, 12288
v_exp_f32 v220, v36
v_mfma_f32_16x16x32_bf16 v[56:59], a[216:219], v[72:75], v[200:203]
v_exp_f32 v221, v37
v_mfma_f32_16x16x32_bf16 v[56:59], a[220:223], v[88:91], v[56:59]
v_exp_f32 v222, v38
v_mfma_f32_16x16x32_bf16 v[56:59], a[224:227], v[104:107], v[56:59]
v_exp_f32 v223, v39
v_mfma_f32_16x16x32_bf16 v[60:63], a[216:219], v[76:79], v[204:207]
ds_read_b64_tr_b16 a[216:217], v11 offset:128
v_cvt_pk_bf16_f32 v191, v230, v231
v_mfma_f32_16x16x32_bf16 v[60:63], a[220:223], v[92:95], v[60:63]
ds_read_b64_tr_b16 a[218:219], v11 offset:6272
v_add_f32 v212, v216, v217
v_mfma_f32_16x16x32_bf16 v[60:63], a[224:227], v[108:111], v[60:63]
ds_read_b64_tr_b16 a[220:221], v12 offset:128
v_cvt_pk_bf16_f32 v160, v216, v217
v_mfma_f32_16x16x32_bf16 v[48:51], a[228:231], v[112:115], v[48:51]
s_waitcnt lgkmcnt(3)
ds_read_b64_tr_b16 a[222:223], v12 offset:6272
v_add_f32 v212, v212, v218
v_mfma_f32_16x16x32_bf16 v[48:51], a[232:235], v[128:131], v[48:51]
ds_read_b64_tr_b16 a[224:225], v9 offset:256
v_add_f32 v212, v212, v219
v_mfma_f32_16x16x32_bf16 v[48:51], a[236:239], v[144:147], v[48:51]
ds_read_b64_tr_b16 a[226:227], v9 offset:6400
v_cvt_pk_bf16_f32 v161, v218, v219
v_mfma_f32_16x16x32_bf16 v[52:55], a[228:231], v[116:119], v[52:55]
v_exp_f32 v224, v40
v_mfma_f32_16x16x32_bf16 v[52:55], a[232:235], v[132:135], v[52:55]
s_add_u32 m0, s25, 49152
v_exp_f32 v225, v41
v_mfma_f32_16x16x32_bf16 v[52:55], a[236:239], v[148:151], v[52:55]
buffer_load_dwordx4 v17, s[8:11], s27 offen offset:0 nt lds
v_mfma_f32_16x16x32_bf16 v[56:59], a[228:231], v[120:123], v[56:59]
v_exp_f32 v226, v42
v_mfma_f32_16x16x32_bf16 v[56:59], a[232:235], v[136:139], v[56:59]
v_exp_f32 v227, v43
v_mfma_f32_16x16x32_bf16 v[56:59], a[236:239], v[152:155], v[56:59]
v_exp_f32 v228, v44
v_mfma_f32_16x16x32_bf16 v[60:63], a[228:231], v[124:127], v[60:63]
ds_read_b64_tr_b16 a[228:229], v10 offset:256
v_add_f32 v213, v220, v221
v_mfma_f32_16x16x32_bf16 v[60:63], a[232:235], v[140:143], v[60:63]
ds_read_b64_tr_b16 a[230:231], v10 offset:6400
v_cvt_pk_bf16_f32 v164, v220, v221
v_mfma_f32_16x16x32_bf16 v[60:63], a[236:239], v[156:159], v[60:63]
ds_read_b64_tr_b16 a[232:233], v11 offset:256
v_add_f32 v213, v213, v222
v_mfma_f32_16x16x32_bf16 a[0:3], a[192:195], v[176:179], a[0:3]
ds_read_b64_tr_b16 a[234:235], v11 offset:6400
v_add_f32 v213, v213, v223
v_mfma_f32_16x16x32_bf16 a[4:7], a[192:195], v[180:183], a[4:7]
ds_read_b64_tr_b16 a[236:237], v12 offset:256
v_cvt_pk_bf16_f32 v165, v222, v223
v_mfma_f32_16x16x32_bf16 a[8:11], a[192:195], v[184:187], a[8:11]
ds_read_b64_tr_b16 a[238:239], v12 offset:6400
v_add_f32 v214, v224, v225
v_mfma_f32_16x16x32_bf16 a[12:15], a[192:195], v[188:191], a[12:15]
v_exp_f32 v229, v45
v_mfma_f32_16x16x32_bf16 a[28:31], a[196:199], v[188:191], a[28:31]
v_exp_f32 v230, v46
v_mfma_f32_16x16x32_bf16 a[24:27], a[196:199], v[184:187], a[24:27]
s_waitcnt vmcnt(4) lgkmcnt(0)
v_exp_f32 v231, v47
v_mfma_f32_16x16x32_bf16 a[20:23], a[196:199], v[180:183], a[20:23]
s_barrier
v_exp_f32 v216, v48
v_mfma_f32_16x16x32_bf16 a[16:19], a[196:199], v[176:179], a[16:19]
ds_read_b128 a[192:195], v3 offset:0
v_cvt_pk_bf16_f32 v168, v224, v225
v_mfma_f32_16x16x32_bf16 a[32:35], a[200:203], v[176:179], a[32:35]
buffer_load_dwordx4 v18, s[8:11], s27 offen offset:1024 nt lds
v_mfma_f32_16x16x32_bf16 a[36:39], a[200:203], v[180:183], a[36:39]
ds_read_b128 a[196:199], v4 offset:0
v_add_f32 v214, v214, v226
v_mfma_f32_16x16x32_bf16 a[40:43], a[200:203], v[184:187], a[40:43]
v_exp_f32 v217, v49
v_mfma_f32_16x16x32_bf16 a[44:47], a[200:203], v[188:191], a[44:47]
ds_read_b128 a[200:203], v3 offset:128
v_add_f32 v214, v214, v227
v_mfma_f32_16x16x32_bf16 a[60:63], a[204:207], v[188:191], a[60:63]
v_exp_f32 v218, v50
v_mfma_f32_16x16x32_bf16 a[56:59], a[204:207], v[184:187], a[56:59]
v_exp_f32 v219, v51
v_mfma_f32_16x16x32_bf16 a[52:55], a[204:207], v[180:183], a[52:55]
v_exp_f32 v220, v52
v_mfma_f32_16x16x32_bf16 a[48:51], a[204:207], v[176:179], a[48:51]
ds_read_b128 a[204:207], v4 offset:128
v_cvt_pk_bf16_f32 v169, v226, v227
v_mfma_f32_16x16x32_bf16 a[64:67], a[208:211], v[176:179], a[64:67]
v_exp_f32 v221, v53
v_mfma_f32_16x16x32_bf16 a[68:71], a[208:211], v[180:183], a[68:71]
v_exp_f32 v222, v54
v_mfma_f32_16x16x32_bf16 a[72:75], a[208:211], v[184:187], a[72:75]
v_exp_f32 v223, v55
v_mfma_f32_16x16x32_bf16 a[76:79], a[208:211], v[188:191], a[76:79]
ds_read_b128 a[208:211], v3 offset:256
v_add_f32 v215, v228, v229
v_mfma_f32_16x16x32_bf16 a[92:95], a[212:215], v[188:191], a[92:95]
v_cvt_pk_bf16_f32 v172, v228, v229
v_add_f32 v215, v215, v230
v_mfma_f32_16x16x32_bf16 a[88:91], a[212:215], v[184:187], a[88:91]
buffer_load_dwordx4 v19, s[8:11], s27 offen offset:2048 nt lds
v_mfma_f32_16x16x32_bf16 a[84:87], a[212:215], v[180:183], a[84:87]
s_add_u32 s27, s27, 12288
v_add_f32 v215, v215, v231
v_cvt_pk_bf16_f32 v173, v230, v231
v_mfma_f32_16x16x32_bf16 a[80:83], a[212:215], v[176:179], a[80:83]
s_add_u32 s88, s80, 0
ds_read_b128 a[212:215], v4 offset:256
v_add_f32 v212, v212, v216
v_mfma_f32_16x16x32_bf16 a[96:99], a[216:219], v[176:179], a[96:99]
s_add_u32 m0, s25, 24576
v_add_f32 v212, v212, v217
v_cvt_pk_bf16_f32 v162, v216, v217
v_mfma_f32_16x16x32_bf16 a[100:103], a[216:219], v[180:183], a[100:103]
buffer_load_dwordx4 v23, s[64:67], s88 offen offset:0 lds
v_mfma_f32_16x16x32_bf16 a[104:107], a[216:219], v[184:187], a[104:107]
v_add_f32 v212, v212, v218
v_add_f32 v212, v212, v219
v_mfma_f32_16x16x32_bf16 a[108:111], a[216:219], v[188:191], a[108:111]
ds_read_b128 a[216:219], v3 offset:6144
v_cvt_pk_bf16_f32 v163, v218, v219
v_mfma_f32_16x16x32_bf16 a[124:127], a[220:223], v[188:191], a[124:127]
v_add_f32 v213, v213, v220
v_add_f32 v213, v213, v221
v_mfma_f32_16x16x32_bf16 a[120:123], a[220:223], v[184:187], a[120:123]
v_cvt_pk_bf16_f32 v166, v220, v221
v_add_f32 v213, v213, v222
v_mfma_f32_16x16x32_bf16 a[116:119], a[220:223], v[180:183], a[116:119]
v_add_f32 v213, v213, v223
v_cvt_pk_bf16_f32 v167, v222, v223
v_mfma_f32_16x16x32_bf16 a[112:115], a[220:223], v[176:179], a[112:115]
buffer_load_dwordx4 v24, s[64:67], s88 offen offset:1024 lds
v_mfma_f32_16x16x32_bf16 a[128:131], a[224:227], v[176:179], a[128:131]
ds_read_b128 a[220:223], v4 offset:6144
v_max3_f32 v232, v56, v57, v58
v_mfma_f32_16x16x32_bf16 a[132:135], a[224:227], v[180:183], a[132:135]
v_max3_f32 v233, v59, v60, v61
v_max3_f32 v232, v232, v62, v63
v_mfma_f32_16x16x32_bf16 a[136:139], a[224:227], v[184:187], a[136:139]
v_max3_f32 v233, v233, v214, v215
v_max3_f32 v232, v232, v233, v212
v_mfma_f32_16x16x32_bf16 a[140:143], a[224:227], v[188:191], a[140:143]
ds_read_b128 a[224:227], v3 offset:6272
v_max_f32 v232, v232, v213
v_mfma_f32_16x16x32_bf16 a[156:159], a[228:231], v[188:191], a[156:159]
v_cmp_lt_f32 vcc, 0x42800000, v232
v_mfma_f32_16x16x32_bf16 a[152:155], a[228:231], v[184:187], a[152:155]
buffer_load_dwordx4 v25, s[64:67], s88 offen offset:2048 lds
v_mfma_f32_16x16x32_bf16 a[148:151], a[228:231], v[180:183], a[148:151]
v_mfma_f32_16x16x32_bf16 a[144:147], a[228:231], v[176:179], a[144:147]
ds_read_b128 a[228:231], v4 offset:6272
v_mfma_f32_16x16x32_bf16 a[160:163], a[232:235], v[176:179], a[160:163]
v_mfma_f32_16x16x32_bf16 a[164:167], a[232:235], v[180:183], a[164:167]
v_mfma_f32_16x16x32_bf16 a[168:171], a[232:235], v[184:187], a[168:171]
v_mfma_f32_16x16x32_bf16 a[172:175], a[232:235], v[188:191], a[172:175]
ds_read_b128 a[232:235], v3 offset:6400
v_mfma_f32_16x16x32_bf16 a[188:191], a[236:239], v[188:191], a[188:191]
v_mfma_f32_16x16x32_bf16 a[184:187], a[236:239], v[184:187], a[184:187]
s_waitcnt lgkmcnt(1)
v_mfma_f32_16x16x32_bf16 a[180:183], a[236:239], v[180:183], a[180:183]
v_mfma_f32_16x16x32_bf16 a[176:179], a[236:239], v[176:179], a[176:179]
s_cbranch_vccnz L1_stubt25
L1_backt25:
v_mfma_f32_16x16x32_bf16 v[32:35], a[192:195], v[64:67], v[192:195]
ds_read_b128 a[236:239], v4 offset:6400
v_add_f32 v208, v208, v212
v_mfma_f32_16x16x32_bf16 v[32:35], a[196:199], v[80:83], v[32:35]
s_add_u32 m0, s26, 0
v_exp_f32 v224, v56
v_mfma_f32_16x16x32_bf16 v[32:35], a[200:203], v[96:99], v[32:35]
buffer_load_dwordx4 v20, s[12:15], s28 offen offset:0 nt lds
v_mfma_f32_16x16x32_bf16 v[36:39], a[192:195], v[68:71], v[196:199]
v_exp_f32 v225, v57
v_mfma_f32_16x16x32_bf16 v[36:39], a[196:199], v[84:87], v[36:39]
v_exp_f32 v226, v58
v_mfma_f32_16x16x32_bf16 v[36:39], a[200:203], v[100:103], v[36:39]
v_exp_f32 v227, v59
v_mfma_f32_16x16x32_bf16 v[40:43], a[192:195], v[72:75], v[200:203]
v_exp_f32 v228, v60
v_mfma_f32_16x16x32_bf16 v[40:43], a[196:199], v[88:91], v[40:43]
v_exp_f32 v229, v61
v_mfma_f32_16x16x32_bf16 v[40:43], a[200:203], v[104:107], v[40:43]
v_exp_f32 v230, v62
v_mfma_f32_16x16x32_bf16 v[44:47], a[192:195], v[76:79], v[204:207]
ds_read_b64_tr_b16 a[192:193], v9 offset:12288
v_add_f32 v209, v209, v213
v_mfma_f32_16x16x32_bf16 v[44:47], a[196:199], v[92:95], v[44:47]
ds_read_b64_tr_b16 a[194:195], v9 offset:18432
v_add_f32 v210, v210, v214
v_mfma_f32_16x16x32_bf16 v[44:47], a[200:203], v[108:111], v[44:47]
ds_read_b64_tr_b16 a[196:197], v10 offset:12288
v_add_f32 v211, v211, v215
v_mfma_f32_16x16x32_bf16 v[32:35], a[204:207], v[112:115], v[32:35]
ds_read_b64_tr_b16 a[198:199], v10 offset:18432
v_add_f32 v210, v210, v224
v_mfma_f32_16x16x32_bf16 v[32:35], a[208:211], v[128:131], v[32:35]
ds_read_b64_tr_b16 a[200:201], v11 offset:12288
v_add_f32 v210, v210, v225
v_mfma_f32_16x16x32_bf16 v[32:35], a[212:215], v[144:147], v[32:35]
ds_read_b64_tr_b16 a[202:203], v11 offset:18432
v_cvt_pk_bf16_f32 v170, v224, v225
v_mfma_f32_16x16x32_bf16 v[36:39], a[204:207], v[116:119], v[36:39]
buffer_load_dwordx4 v21, s[12:15], s28 offen offset:1024 nt lds
v_mfma_f32_16x16x32_bf16 v[36:39], a[208:211], v[132:135], v[36:39]
v_exp_f32 v231, v63
v_mfma_f32_16x16x32_bf16 v[36:39], a[212:215], v[148:151], v[36:39]
v_add_f32 v210, v210, v226
v_add_f32 v210, v210, v227
v_mfma_f32_16x16x32_bf16 v[40:43], a[204:207], v[120:123], v[40:43]
v_exp_f32 v216, v32
v_mfma_f32_16x16x32_bf16 v[40:43], a[208:211], v[136:139], v[40:43]
v_exp_f32 v217, v33
v_mfma_f32_16x16x32_bf16 v[40:43], a[212:215], v[152:155], v[40:43]
v_exp_f32 v218, v34
v_mfma_f32_16x16x32_bf16 v[44:47], a[204:207], v[124:127], v[44:47]
ds_read_b64_tr_b16 a[204:205], v12 offset:12288
v_cvt_pk_bf16_f32 v171, v226, v227
v_mfma_f32_16x16x32_bf16 v[44:47], a[208:211], v[140:143], v[44:47]
ds_read_b64_tr_b16 a[206:207], v12 offset:18432
v_add_f32 v211, v211, v228
v_mfma_f32_16x16x32_bf16 v[44:47], a[212:215], v[156:159], v[44:47]
ds_read_b64_tr_b16 a[208:209], v9 offset:12416
v_add_f32 v211, v211, v229
v_mfma_f32_16x16x32_bf16 v[48:51], a[216:219], v[64:67], v[192:195]
ds_read_b64_tr_b16 a[210:211], v9 offset:18560
v_cvt_pk_bf16_f32 v174, v228, v229
v_mfma_f32_16x16x32_bf16 v[48:51], a[220:223], v[80:83], v[48:51]
ds_read_b64_tr_b16 a[212:213], v10 offset:12416
v_add_f32 v211, v211, v230
v_mfma_f32_16x16x32_bf16 v[48:51], a[224:227], v[96:99], v[48:51]
ds_read_b64_tr_b16 a[214:215], v10 offset:18560
v_add_f32 v211, v211, v231
v_mfma_f32_16x16x32_bf16 v[52:55], a[216:219], v[68:71], v[196:199]
v_exp_f32 v219, v35
v_mfma_f32_16x16x32_bf16 v[52:55], a[220:223], v[84:87], v[52:55]
buffer_load_dwordx4 v22, s[12:15], s28 offen offset:2048 nt lds
v_mfma_f32_16x16x32_bf16 v[52:55], a[224:227], v[100:103], v[52:55]
s_add_u32 s28, s28, 12288
v_exp_f32 v220, v36
v_mfma_f32_16x16x32_bf16 v[56:59], a[216:219], v[72:75], v[200:203]
v_exp_f32 v221, v37
v_mfma_f32_16x16x32_bf16 v[56:59], a[220:223], v[88:91], v[56:59]
v_exp_f32 v222, v38
v_mfma_f32_16x16x32_bf16 v[56:59], a[224:227], v[104:107], v[56:59]
v_exp_f32 v223, v39
v_mfma_f32_16x16x32_bf16 v[60:63], a[216:219], v[76:79], v[204:207]
ds_read_b64_tr_b16 a[216:217], v11 offset:12416
v_cvt_pk_bf16_f32 v175, v230, v231
v_mfma_f32_16x16x32_bf16 v[60:63], a[220:223], v[92:95], v[60:63]
ds_read_b64_tr_b16 a[218:219], v11 offset:18560
v_add_f32 v212, v216, v217
v_mfma_f32_16x16x32_bf16 v[60:63], a[224:227], v[108:111], v[60:63]
ds_read_b64_tr_b16 a[220:221], v12 offset:12416
v_cvt_pk_bf16_f32 v176, v216, v217
v_mfma_f32_16x16x32_bf16 v[48:51], a[228:231], v[112:115], v[48:51]
s_waitcnt lgkmcnt(3)
ds_read_b64_tr_b16 a[222:223], v12 offset:18560
v_add_f32 v212, v212, v218
v_mfma_f32_16x16x32_bf16 v[48:51], a[232:235], v[128:131], v[48:51]
ds_read_b64_tr_b16 a[224:225], v9 offset:12544
v_add_f32 v212, v212, v219
v_mfma_f32_16x16x32_bf16 v[48:51], a[236:239], v[144:147], v[48:51]
ds_read_b64_tr_b16 a[226:227], v9 offset:18688
v_cvt_pk_bf16_f32 v177, v218, v219
v_mfma_f32_16x16x32_bf16 v[52:55], a[228:231], v[116:119], v[52:55]
v_exp_f32 v224, v40
v_mfma_f32_16x16x32_bf16 v[52:55], a[232:235], v[132:135], v[52:55]
s_add_u32 m0, s25, 61440
v_exp_f32 v225, v41
v_mfma_f32_16x16x32_bf16 v[52:55], a[236:239], v[148:151], v[52:55]
buffer_load_dwordx4 v17, s[8:11], s27 offen offset:0 nt lds
v_mfma_f32_16x16x32_bf16 v[56:59], a[228:231], v[120:123], v[56:59]
v_exp_f32 v226, v42
v_mfma_f32_16x16x32_bf16 v[56:59], a[232:235], v[136:139], v[56:59]
v_exp_f32 v227, v43
v_mfma_f32_16x16x32_bf16 v[56:59], a[236:239], v[152:155], v[56:59]
v_exp_f32 v228, v44
v_mfma_f32_16x16x32_bf16 v[60:63], a[228:231], v[124:127], v[60:63]
ds_read_b64_tr_b16 a[228:229], v10 offset:12544
v_add_f32 v213, v220, v221
v_mfma_f32_16x16x32_bf16 v[60:63], a[232:235], v[140:143], v[60:63]
ds_read_b64_tr_b16 a[230:231], v10 offset:18688
v_cvt_pk_bf16_f32 v180, v220, v221
v_mfma_f32_16x16x32_bf16 v[60:63], a[236:239], v[156:159], v[60:63]
ds_read_b64_tr_b16 a[232:233], v11 offset:12544
v_add_f32 v213, v213, v222
v_mfma_f32_16x16x32_bf16 a[0:3], a[192:195], v[160:163], a[0:3]
ds_read_b64_tr_b16 a[234:235], v11 offset:18688
v_add_f32 v213, v213, v223
v_mfma_f32_16x16x32_bf16 a[4:7], a[192:195], v[164:167], a[4:7]
ds_read_b64_tr_b16 a[236:237], v12 offset:12544
v_cvt_pk_bf16_f32 v181, v222, v223
v_mfma_f32_16x16x32_bf16 a[8:11], a[192:195], v[168:171], a[8:11]
ds_read_b64_tr_b16 a[238:239], v12 offset:18688
v_add_f32 v214, v224, v225
v_mfma_f32_16x16x32_bf16 a[12:15], a[192:195], v[172:175], a[12:15]
v_exp_f32 v229, v45
v_mfma_f32_16x16x32_bf16 a[28:31], a[196:199], v[172:175], a[28:31]
v_exp_f32 v230, v46
v_mfma_f32_16x16x32_bf16 a[24:27], a[196:199], v[168:171], a[24:27]
s_waitcnt vmcnt(7) lgkmcnt(0)
v_exp_f32 v231, v47
v_mfma_f32_16x16x32_bf16 a[20:23], a[196:199], v[164:167], a[20:23]
s_barrier
v_exp_f32 v216, v48
v_mfma_f32_16x16x32_bf16 a[16:19], a[196:199], v[160:163], a[16:19]
ds_read_b128 a[192:195], v3 offset:12288
v_cvt_pk_bf16_f32 v184, v224, v225
v_mfma_f32_16x16x32_bf16 a[32:35], a[200:203], v[160:163], a[32:35]
buffer_load_dwordx4 v18, s[8:11], s27 offen offset:1024 nt lds
v_mfma_f32_16x16x32_bf16 a[36:39], a[200:203], v[164:167], a[36:39]
ds_read_b128 a[196:199], v4 offset:12288
v_add_f32 v214, v214, v226
v_mfma_f32_16x16x32_bf16 a[40:43], a[200:203], v[168:171], a[40:43]
v_exp_f32 v217, v49
v_mfma_f32_16x16x32_bf16 a[44:47], a[200:203], v[172:175], a[44:47]
ds_read_b128 a[200:203], v3 offset:12416
v_add_f32 v214, v214, v227
v_mfma_f32_16x16x32_bf16 a[60:63], a[204:207], v[172:175], a[60:63]
v_exp_f32 v218, v50
v_mfma_f32_16x16x32_bf16 a[56:59], a[204:207], v[168:171], a[56:59]
v_exp_f32 v219, v51
v_mfma_f32_16x16x32_bf16 a[52:55], a[204:207], v[164:167], a[52:55]
v_exp_f32 v220, v52
v_mfma_f32_16x16x32_bf16 a[48:51], a[204:207], v[160:163], a[48:51]
ds_read_b128 a[204:207], v4 offset:12416
v_cvt_pk_bf16_f32 v185, v226, v227
v_mfma_f32_16x16x32_bf16 a[64:67], a[208:211], v[160:163], a[64:67]
v_exp_f32 v221, v53
v_mfma_f32_16x16x32_bf16 a[68:71], a[208:211], v[164:167], a[68:71]
v_exp_f32 v222, v54
v_mfma_f32_16x16x32_bf16 a[72:75], a[208:211], v[168:171], a[72:75]
v_exp_f32 v223, v55
v_mfma_f32_16x16x32_bf16 a[76:79], a[208:211], v[172:175], a[76:79]
ds_read_b128 a[208:211], v3 offset:12544
v_add_f32 v215, v228, v229
v_mfma_f32_16x16x32_bf16 a[92:95], a[212:215], v[172:175], a[92:95]
v_cvt_pk_bf16_f32 v188, v228, v229
v_add_f32 v215, v215, v230
v_mfma_f32_16x16x32_bf16 a[88:91], a[212:215], v[168:171], a[88:91]
buffer_load_dwordx4 v19, s[8:11], s27 offen offset:2048 nt lds
v_mfma_f32_16x16x32_bf16 a[84:87], a[212:215], v[164:167], a[84:87]
s_add_u32 s27, s27, 12288
v_add_f32 v215, v215, v231
v_cvt_pk_bf16_f32 v189, v230, v231
v_mfma_f32_16x16x32_bf16 a[80:83], a[212:215], v[160:163], a[80:83]
s_add_u32 s88, s80, 40960
ds_read_b128 a[212:215], v4 offset:12544
v_add_f32 v212, v212, v216
v_mfma_f32_16x16x32_bf16 a[96:99], a[216:219], v[160:163], a[96:99]
s_add_u32 m0, s25, 36864
v_add_f32 v212, v212, v217
v_cvt_pk_bf16_f32 v178, v216, v217
v_mfma_f32_16x16x32_bf16 a[100:103], a[216:219], v[164:167], a[100:103]
buffer_load_dwordx4 v23, s[64:67], s88 offen offset:0 lds
v_mfma_f32_16x16x32_bf16 a[104:107], a[216:219], v[168:171], a[104:107]
v_add_f32 v212, v212, v218
v_add_f32 v212, v212, v219
v_mfma_f32_16x16x32_bf16 a[108:111], a[216:219], v[172:175], a[108:111]
buffer_load_dwordx4 v24, s[64:67], s88 offen offset:1024 lds
v_mfma_f32_16x16x32_bf16 a[124:127], a[220:223], v[172:175], a[124:127]
ds_read_b128 a[216:219], v3 offset:18432
v_cvt_pk_bf16_f32 v179, v218, v219
v_mfma_f32_16x16x32_bf16 a[120:123], a[220:223], v[168:171], a[120:123]
buffer_load_dwordx4 v25, s[64:67], s88 offen offset:2048 lds
v_mfma_f32_16x16x32_bf16 a[116:119], a[220:223], v[164:167], a[116:119]
s_add_u32 s88, s81, 0
v_add_f32 v213, v213, v220
v_add_f32 v213, v213, v221
v_mfma_f32_16x16x32_bf16 a[112:115], a[220:223], v[160:163], a[112:115]
s_add_u32 m0, s26, 49152
ds_read_b128 a[220:223], v4 offset:18432
v_cvt_pk_bf16_f32 v182, v220, v221
v_mfma_f32_16x16x32_bf16 a[128:131], a[224:227], v[160:163], a[128:131]
buffer_load_dwordx4 v23, s[64:67], s88 offen offset:0 lds
v_mfma_f32_16x16x32_bf16 a[132:135], a[224:227], v[164:167], a[132:135]
v_add_f32 v213, v213, v222
v_add_f32 v213, v213, v223
v_mfma_f32_16x16x32_bf16 a[136:139], a[224:227], v[168:171], a[136:139]
buffer_load_dwordx4 v24, s[64:67], s88 offen offset:1024 lds
v_mfma_f32_16x16x32_bf16 a[140:143], a[224:227], v[172:175], a[140:143]
ds_read_b128 a[224:227], v3 offset:18560
v_cvt_pk_bf16_f32 v183, v222, v223
v_mfma_f32_16x16x32_bf16 a[156:159], a[228:231], v[172:175], a[156:159]
buffer_load_dwordx4 v25, s[64:67], s88 offen offset:2048 lds
v_mfma_f32_16x16x32_bf16 a[152:155], a[228:231], v[168:171], a[152:155]
v_max3_f32 v232, v56, v57, v58
v_max3_f32 v233, v59, v60, v61
v_mfma_f32_16x16x32_bf16 a[148:151], a[228:231], v[164:167], a[148:151]
v_max3_f32 v232, v232, v62, v63
v_max3_f32 v233, v233, v214, v215
v_mfma_f32_16x16x32_bf16 a[144:147], a[228:231], v[160:163], a[144:147]
ds_read_b128 a[228:231], v4 offset:18560
v_max3_f32 v232, v232, v233, v212
v_mfma_f32_16x16x32_bf16 a[160:163], a[232:235], v[160:163], a[160:163]
v_max_f32 v232, v232, v213
v_cmp_lt_f32 vcc, 0x42800000, v232
v_mfma_f32_16x16x32_bf16 a[164:167], a[232:235], v[164:167], a[164:167]
v_mfma_f32_16x16x32_bf16 a[168:171], a[232:235], v[168:171], a[168:171]
v_mfma_f32_16x16x32_bf16 a[172:175], a[232:235], v[172:175], a[172:175]
ds_read_b128 a[232:235], v3 offset:18688
v_mfma_f32_16x16x32_bf16 a[188:191], a[236:239], v[172:175], a[188:191]
v_mfma_f32_16x16x32_bf16 a[184:187], a[236:239], v[168:171], a[184:187]
s_waitcnt lgkmcnt(1)
v_mfma_f32_16x16x32_bf16 a[180:183], a[236:239], v[164:167], a[180:183]
v_mfma_f32_16x16x32_bf16 a[176:179], a[236:239], v[160:163], a[176:179]
s_cbranch_vccnz L1_stubt26
L1_backt26:
v_mfma_f32_16x16x32_bf16 v[32:35], a[192:195], v[64:67], v[192:195]
ds_read_b128 a[236:239], v4 offset:18688
v_add_f32 v208, v208, v212
v_mfma_f32_16x16x32_bf16 v[32:35], a[196:199], v[80:83], v[32:35]
s_add_u32 m0, s26, 12288
v_exp_f32 v224, v56
v_mfma_f32_16x16x32_bf16 v[32:35], a[200:203], v[96:99], v[32:35]
buffer_load_dwordx4 v20, s[12:15], s28 offen offset:0 nt lds
v_mfma_f32_16x16x32_bf16 v[36:39], a[192:195], v[68:71], v[196:199]
v_exp_f32 v225, v57
v_mfma_f32_16x16x32_bf16 v[36:39], a[196:199], v[84:87], v[36:39]
v_exp_f32 v226, v58
v_mfma_f32_16x16x32_bf16 v[36:39], a[200:203], v[100:103], v[36:39]
v_exp_f32 v227, v59
v_mfma_f32_16x16x32_bf16 v[40:43], a[192:195], v[72:75], v[200:203]
v_exp_f32 v228, v60
v_mfma_f32_16x16x32_bf16 v[40:43], a[196:199], v[88:91], v[40:43]
v_exp_f32 v229, v61
v_mfma_f32_16x16x32_bf16 v[40:43], a[200:203], v[104:107], v[40:43]
v_exp_f32 v230, v62
v_mfma_f32_16x16x32_bf16 v[44:47], a[192:195], v[76:79], v[204:207]
ds_read_b64_tr_b16 a[192:193], v9 offset:24576
v_add_f32 v209, v209, v213
v_mfma_f32_16x16x32_bf16 v[44:47], a[196:199], v[92:95], v[44:47]
ds_read_b64_tr_b16 a[194:195], v9 offset:30720
v_add_f32 v210, v210, v214
v_mfma_f32_16x16x32_bf16 v[44:47], a[200:203], v[108:111], v[44:47]
ds_read_b64_tr_b16 a[196:197], v10 offset:24576
v_add_f32 v211, v211, v215
v_mfma_f32_16x16x32_bf16 v[32:35], a[204:207], v[112:115], v[32:35]
buffer_load_dword v250, off, s[76:79], 0 sc1
v_mfma_f32_16x16x32_bf16 v[32:35], a[208:211], v[128:131], v[32:35]
ds_read_b64_tr_b16 a[198:199], v10 offset:30720
v_add_f32 v210, v210, v224
v_mfma_f32_16x16x32_bf16 v[32:35], a[212:215], v[144:147], v[32:35]
ds_read_b64_tr_b16 a[200:201], v11 offset:24576
v_add_f32 v210, v210, v225
v_mfma_f32_16x16x32_bf16 v[36:39], a[204:207], v[116:119], v[36:39]
buffer_load_dwordx4 v21, s[12:15], s28 offen offset:1024 nt lds
v_mfma_f32_16x16x32_bf16 v[36:39], a[208:211], v[132:135], v[36:39]
ds_read_b64_tr_b16 a[202:203], v11 offset:30720
v_cvt_pk_bf16_f32 v186, v224, v225
v_mfma_f32_16x16x32_bf16 v[36:39], a[212:215], v[148:151], v[36:39]
v_exp_f32 v231, v63
v_mfma_f32_16x16x32_bf16 v[40:43], a[204:207], v[120:123], v[40:43]
v_exp_f32 v216, v32
v_mfma_f32_16x16x32_bf16 v[40:43], a[208:211], v[136:139], v[40:43]
v_exp_f32 v217, v33
v_mfma_f32_16x16x32_bf16 v[40:43], a[212:215], v[152:155], v[40:43]
v_exp_f32 v218, v34
v_mfma_f32_16x16x32_bf16 v[44:47], a[204:207], v[124:127], v[44:47]
ds_read_b64_tr_b16 a[204:205], v12 offset:24576
v_add_f32 v210, v210, v226
v_mfma_f32_16x16x32_bf16 v[44:47], a[208:211], v[140:143], v[44:47]
ds_read_b64_tr_b16 a[206:207], v12 offset:30720
v_add_f32 v210, v210, v227
v_mfma_f32_16x16x32_bf16 v[44:47], a[212:215], v[156:159], v[44:47]
ds_read_b64_tr_b16 a[208:209], v9 offset:24704
v_cvt_pk_bf16_f32 v187, v226, v227
v_mfma_f32_16x16x32_bf16 v[48:51], a[216:219], v[64:67], v[192:195]
ds_read_b64_tr_b16 a[210:211], v9 offset:30848
v_add_f32 v211, v211, v228
v_mfma_f32_16x16x32_bf16 v[48:51], a[220:223], v[80:83], v[48:51]
ds_read_b64_tr_b16 a[212:213], v10 offset:24704
v_add_f32 v211, v211, v229
v_mfma_f32_16x16x32_bf16 v[48:51], a[224:227], v[96:99], v[48:51]
ds_read_b64_tr_b16 a[214:215], v10 offset:30848
v_cvt_pk_bf16_f32 v190, v228, v229
v_mfma_f32_16x16x32_bf16 v[52:55], a[216:219], v[68:71], v[196:199]
v_exp_f32 v219, v35
v_mfma_f32_16x16x32_bf16 v[52:55], a[220:223], v[84:87], v[52:55]
buffer_load_dwordx4 v22, s[12:15], s28 offen offset:2048 nt lds
v_mfma_f32_16x16x32_bf16 v[52:55], a[224:227], v[100:103], v[52:55]
s_add_u32 s28, s28, 12288
v_exp_f32 v220, v36
v_mfma_f32_16x16x32_bf16 v[56:59], a[216:219], v[72:75], v[200:203]
v_exp_f32 v221, v37
v_mfma_f32_16x16x32_bf16 v[56:59], a[220:223], v[88:91], v[56:59]
v_exp_f32 v222, v38
v_mfma_f32_16x16x32_bf16 v[56:59], a[224:227], v[104:107], v[56:59]
v_exp_f32 v223, v39
v_mfma_f32_16x16x32_bf16 v[60:63], a[216:219], v[76:79], v[204:207]
ds_read_b64_tr_b16 a[216:217], v11 offset:24704
v_add_f32 v211, v211, v230
v_mfma_f32_16x16x32_bf16 v[60:63], a[220:223], v[92:95], v[60:63]
ds_read_b64_tr_b16 a[218:219], v11 offset:30848
v_add_f32 v211, v211, v231
v_mfma_f32_16x16x32_bf16 v[60:63], a[224:227], v[108:111], v[60:63]
ds_read_b64_tr_b16 a[220:221], v12 offset:24704
v_cvt_pk_bf16_f32 v191, v230, v231
v_mfma_f32_16x16x32_bf16 v[48:51], a[228:231], v[112:115], v[48:51]
s_waitcnt lgkmcnt(3)
ds_read_b64_tr_b16 a[222:223], v12 offset:30848
v_add_f32 v212, v216, v217
v_mfma_f32_16x16x32_bf16 v[48:51], a[232:235], v[128:131], v[48:51]
ds_read_b64_tr_b16 a[224:225], v9 offset:24832
v_cvt_pk_bf16_f32 v160, v216, v217
v_mfma_f32_16x16x32_bf16 v[48:51], a[236:239], v[144:147], v[48:51]
ds_read_b64_tr_b16 a[226:227], v9 offset:30976
v_add_f32 v212, v212, v218
v_mfma_f32_16x16x32_bf16 v[52:55], a[228:231], v[116:119], v[52:55]
v_exp_f32 v224, v40
v_mfma_f32_16x16x32_bf16 v[52:55], a[232:235], v[132:135], v[52:55]
s_add_u32 m0, s25, 0
v_exp_f32 v225, v41
v_mfma_f32_16x16x32_bf16 v[52:55], a[236:239], v[148:151], v[52:55]
buffer_load_dwordx4 v17, s[8:11], s27 offen offset:0 nt lds
v_mfma_f32_16x16x32_bf16 v[56:59], a[228:231], v[120:123], v[56:59]
v_exp_f32 v226, v42
v_mfma_f32_16x16x32_bf16 v[56:59], a[232:235], v[136:139], v[56:59]
v_exp_f32 v227, v43
v_mfma_f32_16x16x32_bf16 v[56:59], a[236:239], v[152:155], v[56:59]
v_exp_f32 v228, v44
v_mfma_f32_16x16x32_bf16 v[60:63], a[228:231], v[124:127], v[60:63]
ds_read_b64_tr_b16 a[228:229], v10 offset:24832
v_add_f32 v212, v212, v219
v_mfma_f32_16x16x32_bf16 v[60:63], a[232:235], v[140:143], v[60:63]
ds_read_b64_tr_b16 a[230:231], v10 offset:30976
v_cvt_pk_bf16_f32 v161, v218, v219
v_mfma_f32_16x16x32_bf16 v[60:63], a[236:239], v[156:159], v[60:63]
ds_read_b64_tr_b16 a[232:233], v11 offset:24832
v_add_f32 v213, v220, v221
v_mfma_f32_16x16x32_bf16 a[0:3], a[192:195], v[176:179], a[0:3]
ds_read_b64_tr_b16 a[234:235], v11 offset:30976
v_cvt_pk_bf16_f32 v164, v220, v221
v_mfma_f32_16x16x32_bf16 a[4:7], a[192:195], v[180:183], a[4:7]
ds_read_b64_tr_b16 a[236:237], v12 offset:24832
v_add_f32 v213, v213, v222
v_mfma_f32_16x16x32_bf16 a[8:11], a[192:195], v[184:187], a[8:11]
ds_read_b64_tr_b16 a[238:239], v12 offset:30976
v_add_f32 v213, v213, v223
v_mfma_f32_16x16x32_bf16 a[12:15], a[192:195], v[188:191], a[12:15]
v_exp_f32 v229, v45
v_mfma_f32_16x16x32_bf16 a[28:31], a[196:199], v[188:191], a[28:31]
v_exp_f32 v230, v46
v_mfma_f32_16x16x32_bf16 a[24:27], a[196:199], v[184:187], a[24:27]
s_waitcnt vmcnt(11) lgkmcnt(0)
v_exp_f32 v231, v47
v_mfma_f32_16x16x32_bf16 a[20:23], a[196:199], v[180:183], a[20:23]
s_barrier
v_exp_f32 v216, v48
v_mfma_f32_16x16x32_bf16 a[16:19], a[196:199], v[176:179], a[16:19]
ds_read_b128 a[192:195], v3 offset:24576
v_cvt_pk_bf16_f32 v165, v222, v223
v_mfma_f32_16x16x32_bf16 a[32:35], a[200:203], v[176:179], a[32:35]
buffer_load_dwordx4 v18, s[8:11], s27 offen offset:1024 nt lds
v_mfma_f32_16x16x32_bf16 a[36:39], a[200:203], v[180:183], a[36:39]
ds_read_b128 a[196:199], v4 offset:24576
v_add_f32 v214, v224, v225
v_mfma_f32_16x16x32_bf16 a[40:43], a[200:203], v[184:187], a[40:43]
v_exp_f32 v217, v49
v_mfma_f32_16x16x32_bf16 a[44:47], a[200:203], v[188:191], a[44:47]
ds_read_b128 a[200:203], v3 offset:24704
v_cvt_pk_bf16_f32 v168, v224, v225
v_mfma_f32_16x16x32_bf16 a[60:63], a[204:207], v[188:191], a[60:63]
v_exp_f32 v218, v50
v_mfma_f32_16x16x32_bf16 a[56:59], a[204:207], v[184:187], a[56:59]
v_exp_f32 v219, v51
v_mfma_f32_16x16x32_bf16 a[52:55], a[204:207], v[180:183], a[52:55]
v_add_f32 v214, v214, v226
v_add_f32 v214, v214, v227
v_mfma_f32_16x16x32_bf16 a[48:51], a[204:207], v[176:179], a[48:51]
ds_read_b128 a[204:207], v4 offset:24704
v_cvt_pk_bf16_f32 v169, v226, v227
v_mfma_f32_16x16x32_bf16 a[64:67], a[208:211], v[176:179], a[64:67]
v_exp_f32 v220, v52
v_mfma_f32_16x16x32_bf16 a[68:71], a[208:211], v[180:183], a[68:71]
v_exp_f32 v221, v53
v_mfma_f32_16x16x32_bf16 a[72:75], a[208:211], v[184:187], a[72:75]
v_exp_f32 v222, v54
v_mfma_f32_16x16x32_bf16 a[76:79], a[208:211], v[188:191], a[76:79]
ds_read_b128 a[208:211], v3 offset:24832
v_add_f32 v215, v228, v229
v_mfma_f32_16x16x32_bf16 a[92:95], a[212:215], v[188:191], a[92:95]
v_exp_f32 v223, v55
v_mfma_f32_16x16x32_bf16 a[88:91], a[212:215], v[184:187], a[88:91]
buffer_load_dwordx4 v19, s[8:11], s27 offen offset:2048 nt lds
v_mfma_f32_16x16x32_bf16 a[84:87], a[212:215], v[180:183], a[84:87]
s_add_u32 s27, s27, 12288
v_cvt_pk_bf16_f32 v172, v228, v229
v_add_f32 v215, v215, v230
v_mfma_f32_16x16x32_bf16 a[80:83], a[212:215], v[176:179], a[80:83]
s_add_u32 s88, s80, 81920
ds_read_b128 a[212:215], v4 offset:24832
v_add_f32 v215, v215, v231
v_mfma_f32_16x16x32_bf16 a[96:99], a[216:219], v[176:179], a[96:99]
s_add_u32 m0, s25, 49152
v_cvt_pk_bf16_f32 v173, v230, v231
v_add_f32 v212, v212, v216
v_mfma_f32_16x16x32_bf16 a[100:103], a[216:219], v[180:183], a[100:103]
buffer_load_dwordx4 v23, s[64:67], s88 offen offset:0 lds
v_mfma_f32_16x16x32_bf16 a[104:107], a[216:219], v[184:187], a[104:107]
v_add_f32 v212, v212, v217
v_cvt_pk_bf16_f32 v162, v216, v217
v_mfma_f32_16x16x32_bf16 a[108:111], a[216:219], v[188:191], a[108:111]
buffer_load_dwordx4 v24, s[64:67], s88 offen offset:1024 lds
v_mfma_f32_16x16x32_bf16 a[124:127], a[220:223], v[188:191], a[124:127]
ds_read_b128 a[216:219], v3 offset:30720
v_add_f32 v212, v212, v218
v_mfma_f32_16x16x32_bf16 a[120:123], a[220:223], v[184:187], a[120:123]
buffer_load_dwordx4 v25, s[64:67], s88 offen offset:2048 lds
v_mfma_f32_16x16x32_bf16 a[116:119], a[220:223], v[180:183], a[116:119]
s_add_u32 s88, s82, 0
v_add_f32 v212, v212, v219
v_cvt_pk_bf16_f32 v163, v218, v219
v_mfma_f32_16x16x32_bf16 a[112:115], a[220:223], v[176:179], a[112:115]
s_add_u32 m0, s26, 61440
ds_read_b128 a[220:223], v4 offset:30720
v_add_f32 v213, v213, v220
v_mfma_f32_16x16x32_bf16 a[128:131], a[224:227], v[176:179], a[128:131]
buffer_load_dwordx4 v23, s[64:67], s88 offen offset:0 lds
v_mfma_f32_16x16x32_bf16 a[132:135], a[224:227], v[180:183], a[132:135]
v_add_f32 v213, v213, v221
v_cvt_pk_bf16_f32 v166, v220, v221
v_mfma_f32_16x16x32_bf16 a[136:139], a[224:227], v[184:187], a[136:139]
buffer_load_dwordx4 v24, s[64:67], s88 offen offset:1024 lds
v_mfma_f32_16x16x32_bf16 a[140:143], a[224:227], v[188:191], a[140:143]
ds_read_b128 a[224:227], v3 offset:30848
v_add_f32 v213, v213, v222
v_mfma_f32_16x16x32_bf16 a[156:159], a[228:231], v[188:191], a[156:159]
buffer_load_dwordx4 v25, s[64:67], s88 offen offset:2048 lds
v_mfma_f32_16x16x32_bf16 a[152:155], a[228:231], v[184:187], a[152:155]
v_add_f32 v213, v213, v223
v_cvt_pk_bf16_f32 v167, v222, v223
v_mfma_f32_16x16x32_bf16 a[148:151], a[228:231], v[180:183], a[148:151]
v_max3_f32 v232, v56, v57, v58
v_max3_f32 v233, v59, v60, v61
v_mfma_f32_16x16x32_bf16 a[144:147], a[228:231], v[176:179], a[144:147]
ds_read_b128 a[228:231], v4 offset:30848
v_max3_f32 v232, v232, v62, v63
v_mfma_f32_16x16x32_bf16 a[160:163], a[232:235], v[176:179], a[160:163]
v_max3_f32 v233, v233, v214, v215
v_max3_f32 v232, v232, v233, v212
v_mfma_f32_16x16x32_bf16 a[164:167], a[232:235], v[180:183], a[164:167]
v_max_f32 v232, v232, v213
v_cmp_lt_f32 vcc, 0x42800000, v232
v_mfma_f32_16x16x32_bf16 a[168:171], a[232:235], v[184:187], a[168:171]
v_mfma_f32_16x16x32_bf16 a[172:175], a[232:235], v[188:191], a[172:175]
ds_read_b128 a[232:235], v3 offset:30976
v_mfma_f32_16x16x32_bf16 a[188:191], a[236:239], v[188:191], a[188:191]
v_mfma_f32_16x16x32_bf16 a[184:187], a[236:239], v[184:187], a[184:187]
s_waitcnt lgkmcnt(1)
v_mfma_f32_16x16x32_bf16 a[180:183], a[236:239], v[180:183], a[180:183]
v_mfma_f32_16x16x32_bf16 a[176:179], a[236:239], v[176:179], a[176:179]
s_cbranch_vccnz L1_stubt27
L1_backt27:
v_mfma_f32_16x16x32_bf16 v[32:35], a[192:195], v[64:67], v[192:195]
ds_read_b128 a[236:239], v4 offset:30976
v_add_f32 v208, v208, v212
v_mfma_f32_16x16x32_bf16 v[32:35], a[196:199], v[80:83], v[32:35]
s_add_u32 m0, s26, 24576
v_exp_f32 v224, v56
v_mfma_f32_16x16x32_bf16 v[32:35], a[200:203], v[96:99], v[32:35]
buffer_load_dwordx4 v20, s[12:15], s28 offen offset:0 nt lds
v_mfma_f32_16x16x32_bf16 v[36:39], a[192:195], v[68:71], v[196:199]
v_exp_f32 v225, v57
v_mfma_f32_16x16x32_bf16 v[36:39], a[196:199], v[84:87], v[36:39]
v_exp_f32 v226, v58
v_mfma_f32_16x16x32_bf16 v[36:39], a[200:203], v[100:103], v[36:39]
v_exp_f32 v227, v59
v_mfma_f32_16x16x32_bf16 v[40:43], a[192:195], v[72:75], v[200:203]
v_exp_f32 v228, v60
v_mfma_f32_16x16x32_bf16 v[40:43], a[196:199], v[88:91], v[40:43]
v_exp_f32 v229, v61
v_mfma_f32_16x16x32_bf16 v[40:43], a[200:203], v[104:107], v[40:43]
v_exp_f32 v230, v62
v_mfma_f32_16x16x32_bf16 v[44:47], a[192:195], v[76:79], v[204:207]
ds_read_b64_tr_b16 a[192:193], v5 offset:0
v_add_f32 v209, v209, v213
v_mfma_f32_16x16x32_bf16 v[44:47], a[196:199], v[92:95], v[44:47]
ds_read_b64_tr_b16 a[194:195], v5 offset:6144
v_add_f32 v210, v210, v214
v_mfma_f32_16x16x32_bf16 v[44:47], a[200:203], v[108:111], v[44:47]
ds_read_b64_tr_b16 a[196:197], v6 offset:0
v_add_f32 v211, v211, v215
v_mfma_f32_16x16x32_bf16 v[32:35], a[204:207], v[112:115], v[32:35]
ds_read_b64_tr_b16 a[198:199], v6 offset:6144
v_add_f32 v210, v210, v224
v_mfma_f32_16x16x32_bf16 v[32:35], a[208:211], v[128:131], v[32:35]
ds_read_b64_tr_b16 a[200:201], v7 offset:0
v_add_f32 v210, v210, v225
v_mfma_f32_16x16x32_bf16 v[32:35], a[212:215], v[144:147], v[32:35]
ds_read_b64_tr_b16 a[202:203], v7 offset:6144
v_cvt_pk_bf16_f32 v170, v224, v225
v_mfma_f32_16x16x32_bf16 v[36:39], a[204:207], v[116:119], v[36:39]
buffer_load_dwordx4 v21, s[12:15], s28 offen offset:1024 nt lds
v_mfma_f32_16x16x32_bf16 v[36:39], a[208:211], v[132:135], v[36:39]
v_exp_f32 v231, v63
v_mfma_f32_16x16x32_bf16 v[36:39], a[212:215], v[148:151], v[36:39]
v_add_f32 v210, v210, v226
v_add_f32 v210, v210, v227
v_mfma_f32_16x16x32_bf16 v[40:43], a[204:207], v[120:123], v[40:43]
v_exp_f32 v216, v32
v_mfma_f32_16x16x32_bf16 v[40:43], a[208:211], v[136:139], v[40:43]
v_exp_f32 v217, v33
v_mfma_f32_16x16x32_bf16 v[40:43], a[212:215], v[152:155], v[40:43]
v_exp_f32 v218, v34
v_mfma_f32_16x16x32_bf16 v[44:47], a[204:207], v[124:127], v[44:47]
ds_read_b64_tr_b16 a[204:205], v8 offset:0
v_cvt_pk_bf16_f32 v171, v226, v227
v_mfma_f32_16x16x32_bf16 v[44:47], a[208:211], v[140:143], v[44:47]
ds_read_b64_tr_b16 a[206:207], v8 offset:6144
v_add_f32 v211, v211, v228
v_mfma_f32_16x16x32_bf16 v[44:47], a[212:215], v[156:159], v[44:47]
ds_read_b64_tr_b16 a[208:209], v5 offset:128
v_add_f32 v211, v211, v229
v_mfma_f32_16x16x32_bf16 v[48:51], a[216:219], v[64:67], v[192:195]
ds_read_b64_tr_b16 a[210:211], v5 offset:6272
v_cvt_pk_bf16_f32 v174, v228, v229
v_mfma_f32_16x16x32_bf16 v[48:51], a[220:223], v[80:83], v[48:51]
ds_read_b64_tr_b16 a[212:213], v6 offset:128
v_add_f32 v211, v211, v230
v_mfma_f32_16x16x32_bf16 v[48:51], a[224:227], v[96:99], v[48:51]
ds_read_b64_tr_b16 a[214:215], v6 offset:6272
v_add_f32 v211, v211, v231
v_mfma_f32_16x16x32_bf16 v[52:55], a[216:219], v[68:71], v[196:199]
v_exp_f32 v219, v35
v_mfma_f32_16x16x32_bf16 v[52:55], a[220:223], v[84:87], v[52:55]
buffer_load_dwordx4 v22, s[12:15], s28 offen offset:2048 nt lds
v_mfma_f32_16x16x32_bf16 v[52:55], a[224:227], v[100:103], v[52:55]
s_add_u32 s28, s28, 12288
v_exp_f32 v220, v36
v_mfma_f32_16x16x32_bf16 v[56:59], a[216:219], v[72:75], v[200:203]
v_exp_f32 v221, v37
v_mfma_f32_16x16x32_bf16 v[56:59], a[220:223], v[88:91], v[56:59]
v_exp_f32 v222, v38
v_mfma_f32_16x16x32_bf16 v[56:59], a[224:227], v[104:107], v[56:59]
v_exp_f32 v223, v39
v_mfma_f32_16x16x32_bf16 v[60:63], a[216:219], v[76:79], v[204:207]
ds_read_b64_tr_b16 a[216:217], v7 offset:128
v_cvt_pk_bf16_f32 v175, v230, v231
v_mfma_f32_16x16x32_bf16 v[60:63], a[220:223], v[92:95], v[60:63]
ds_read_b64_tr_b16 a[218:219], v7 offset:6272
v_add_f32 v212, v216, v217
v_mfma_f32_16x16x32_bf16 v[60:63], a[224:227], v[108:111], v[60:63]
ds_read_b64_tr_b16 a[220:221], v8 offset:128
v_cvt_pk_bf16_f32 v176, v216, v217
v_mfma_f32_16x16x32_bf16 v[48:51], a[228:231], v[112:115], v[48:51]
s_waitcnt lgkmcnt(3)
ds_read_b64_tr_b16 a[222:223], v8 offset:6272
v_add_f32 v212, v212, v218
v_mfma_f32_16x16x32_bf16 v[48:51], a[232:235], v[128:131], v[48:51]
ds_read_b64_tr_b16 a[224:225], v5 offset:256
v_add_f32 v212, v212, v219
v_mfma_f32_16x16x32_bf16 v[48:51], a[236:239], v[144:147], v[48:51]
ds_read_b64_tr_b16 a[226:227], v5 offset:6400
v_cvt_pk_bf16_f32 v177, v218, v219
v_mfma_f32_16x16x32_bf16 v[52:55], a[228:231], v[116:119], v[52:55]
v_exp_f32 v224, v40
v_mfma_f32_16x16x32_bf16 v[52:55], a[232:235], v[132:135], v[52:55]
s_add_u32 m0, s25, 12288
v_exp_f32 v225, v41
v_mfma_f32_16x16x32_bf16 v[52:55], a[236:239], v[148:151], v[52:55]
buffer_load_dwordx4 v17, s[8:11], s27 offen offset:0 nt lds
v_mfma_f32_16x16x32_bf16 v[56:59], a[228:231], v[120:123], v[56:59]
v_exp_f32 v226, v42
v_mfma_f32_16x16x32_bf16 v[56:59], a[232:235], v[136:139], v[56:59]
v_exp_f32 v227, v43
v_mfma_f32_16x16x32_bf16 v[56:59], a[236:239], v[152:155], v[56:59]
v_exp_f32 v228, v44
v_mfma_f32_16x16x32_bf16 v[60:63], a[228:231], v[124:127], v[60:63]
ds_read_b64_tr_b16 a[228:229], v6 offset:256
v_add_f32 v213, v220, v221
v_mfma_f32_16x16x32_bf16 v[60:63], a[232:235], v[140:143], v[60:63]
ds_read_b64_tr_b16 a[230:231], v6 offset:6400
v_cvt_pk_bf16_f32 v180, v220, v221
v_mfma_f32_16x16x32_bf16 v[60:63], a[236:239], v[156:159], v[60:63]
ds_read_b64_tr_b16 a[232:233], v7 offset:256
v_add_f32 v213, v213, v222
v_mfma_f32_16x16x32_bf16 a[0:3], a[192:195], v[160:163], a[0:3]
ds_read_b64_tr_b16 a[234:235], v7 offset:6400
v_add_f32 v213, v213, v223
v_mfma_f32_16x16x32_bf16 a[4:7], a[192:195], v[164:167], a[4:7]
ds_read_b64_tr_b16 a[236:237], v8 offset:256
v_cvt_pk_bf16_f32 v181, v222, v223
v_mfma_f32_16x16x32_bf16 a[8:11], a[192:195], v[168:171], a[8:11]
ds_read_b64_tr_b16 a[238:239], v8 offset:6400
v_add_f32 v214, v224, v225
v_mfma_f32_16x16x32_bf16 a[12:15], a[192:195], v[172:175], a[12:15]
v_exp_f32 v229, v45
v_mfma_f32_16x16x32_bf16 a[28:31], a[196:199], v[172:175], a[28:31]
v_exp_f32 v230, v46
v_mfma_f32_16x16x32_bf16 a[24:27], a[196:199], v[168:171], a[24:27]
s_waitcnt vmcnt(10) lgkmcnt(0)
v_exp_f32 v231, v47
v_mfma_f32_16x16x32_bf16 a[20:23], a[196:199], v[164:167], a[20:23]
s_barrier
v_exp_f32 v216, v48
v_mfma_f32_16x16x32_bf16 a[16:19], a[196:199], v[160:163], a[16:19]
ds_read_b128 a[192:195], v1 offset:0
v_cvt_pk_bf16_f32 v184, v224, v225
v_mfma_f32_16x16x32_bf16 a[32:35], a[200:203], v[160:163], a[32:35]
buffer_load_dwordx4 v18, s[8:11], s27 offen offset:1024 nt lds
v_mfma_f32_16x16x32_bf16 a[36:39], a[200:203], v[164:167], a[36:39]
ds_read_b128 a[196:199], v2 offset:0
v_add_f32 v214, v214, v226
v_mfma_f32_16x16x32_bf16 a[40:43], a[200:203], v[168:171], a[40:43]
v_exp_f32 v217, v49
v_mfma_f32_16x16x32_bf16 a[44:47], a[200:203], v[172:175], a[44:47]
ds_read_b128 a[200:203], v1 offset:128
v_add_f32 v214, v214, v227
v_mfma_f32_16x16x32_bf16 a[60:63], a[204:207], v[172:175], a[60:63]
v_exp_f32 v218, v50
v_mfma_f32_16x16x32_bf16 a[56:59], a[204:207], v[168:171], a[56:59]
v_exp_f32 v219, v51
v_mfma_f32_16x16x32_bf16 a[52:55], a[204:207], v[164:167], a[52:55]
v_exp_f32 v220, v52
v_mfma_f32_16x16x32_bf16 a[48:51], a[204:207], v[160:163], a[48:51]
ds_read_b128 a[204:207], v2 offset:128
v_cvt_pk_bf16_f32 v185, v226, v227
v_mfma_f32_16x16x32_bf16 a[64:67], a[208:211], v[160:163], a[64:67]
v_exp_f32 v221, v53
v_mfma_f32_16x16x32_bf16 a[68:71], a[208:211], v[164:167], a[68:71]
v_exp_f32 v222, v54
v_mfma_f32_16x16x32_bf16 a[72:75], a[208:211], v[168:171], a[72:75]
v_exp_f32 v223, v55
v_mfma_f32_16x16x32_bf16 a[76:79], a[208:211], v[172:175], a[76:79]
ds_read_b128 a[208:211], v1 offset:256
v_add_f32 v215, v228, v229
v_mfma_f32_16x16x32_bf16 a[92:95], a[212:215], v[172:175], a[92:95]
v_cvt_pk_bf16_f32 v188, v228, v229
v_add_f32 v215, v215, v230
v_mfma_f32_16x16x32_bf16 a[88:91], a[212:215], v[168:171], a[88:91]
buffer_load_dwordx4 v19, s[8:11], s27 offen offset:2048 nt lds
v_mfma_f32_16x16x32_bf16 a[84:87], a[212:215], v[164:167], a[84:87]
s_add_u32 s27, s27, 12288
v_add_f32 v215, v215, v231
v_cvt_pk_bf16_f32 v189, v230, v231
v_mfma_f32_16x16x32_bf16 a[80:83], a[212:215], v[160:163], a[80:83]
s_add_u32 s88, s80, 122880
ds_read_b128 a[212:215], v2 offset:256
v_add_f32 v212, v212, v216
v_mfma_f32_16x16x32_bf16 a[96:99], a[216:219], v[160:163], a[96:99]
s_add_u32 m0, s25, 61440
v_add_f32 v212, v212, v217
v_cvt_pk_bf16_f32 v178, v216, v217
v_mfma_f32_16x16x32_bf16 a[100:103], a[216:219], v[164:167], a[100:103]
buffer_load_dwordx4 v23, s[64:67], s88 offen offset:0 lds
v_mfma_f32_16x16x32_bf16 a[104:107], a[216:219], v[168:171], a[104:107]
v_add_f32 v212, v212, v218
v_add_f32 v212, v212, v219
v_mfma_f32_16x16x32_bf16 a[108:111], a[216:219], v[172:175], a[108:111]
buffer_load_dwordx4 v24, s[64:67], s88 offen offset:1024 lds
v_mfma_f32_16x16x32_bf16 a[124:127], a[220:223], v[172:175], a[124:127]
ds_read_b128 a[216:219], v1 offset:6144
v_cvt_pk_bf16_f32 v179, v218, v219
v_mfma_f32_16x16x32_bf16 a[120:123], a[220:223], v[168:171], a[120:123]
buffer_load_dwordx4 v25, s[64:67], s88 offen offset:2048 lds
v_mfma_f32_16x16x32_bf16 a[116:119], a[220:223], v[164:167], a[116:119]
s_add_u32 s88, s83, 0
v_add_f32 v213, v213, v220
v_add_f32 v213, v213, v221
v_mfma_f32_16x16x32_bf16 a[112:115], a[220:223], v[160:163], a[112:115]
s_add_u32 m0, s26, 0
ds_read_b128 a[220:223], v2 offset:6144
v_cvt_pk_bf16_f32 v182, v220, v221
v_mfma_f32_16x16x32_bf16 a[128:131], a[224:227], v[160:163], a[128:131]
buffer_load_dwordx4 v23, s[64:67], s88 offen offset:0 lds
v_mfma_f32_16x16x32_bf16 a[132:135], a[224:227], v[164:167], a[132:135]
v_add_f32 v213, v213, v222
v_add_f32 v213, v213, v223
v_mfma_f32_16x16x32_bf16 a[136:139], a[224:227], v[168:171], a[136:139]
buffer_load_dwordx4 v24, s[64:67], s88 offen offset:1024 lds
v_mfma_f32_16x16x32_bf16 a[140:143], a[224:227], v[172:175], a[140:143]
ds_read_b128 a[224:227], v1 offset:6272
v_cvt_pk_bf16_f32 v183, v222, v223
v_mfma_f32_16x16x32_bf16 a[156:159], a[228:231], v[172:175], a[156:159]
buffer_load_dwordx4 v25, s[64:67], s88 offen offset:2048 lds
v_mfma_f32_16x16x32_bf16 a[152:155], a[228:231], v[168:171], a[152:155]
v_max3_f32 v232, v56, v57, v58
v_max3_f32 v233, v59, v60, v61
v_mfma_f32_16x16x32_bf16 a[148:151], a[228:231], v[164:167], a[148:151]
v_max3_f32 v232, v232, v62, v63
v_max3_f32 v233, v233, v214, v215
v_mfma_f32_16x16x32_bf16 a[144:147], a[228:231], v[160:163], a[144:147]
ds_read_b128 a[228:231], v2 offset:6272
v_max3_f32 v232, v232, v233, v212
v_mfma_f32_16x16x32_bf16 a[160:163], a[232:235], v[160:163], a[160:163]
v_max_f32 v232, v232, v213
v_cmp_lt_f32 vcc, 0x42800000, v232
v_mfma_f32_16x16x32_bf16 a[164:167], a[232:235], v[164:167], a[164:167]
v_mfma_f32_16x16x32_bf16 a[168:171], a[232:235], v[168:171], a[168:171]
v_mfma_f32_16x16x32_bf16 a[172:175], a[232:235], v[172:175], a[172:175]
ds_read_b128 a[232:235], v1 offset:6400
v_mfma_f32_16x16x32_bf16 a[188:191], a[236:239], v[172:175], a[188:191]
v_mfma_f32_16x16x32_bf16 a[184:187], a[236:239], v[168:171], a[184:187]
s_waitcnt lgkmcnt(1)
v_mfma_f32_16x16x32_bf16 a[180:183], a[236:239], v[164:167], a[180:183]
v_mfma_f32_16x16x32_bf16 a[176:179], a[236:239], v[160:163], a[176:179]
s_cbranch_vccnz L1_stubt28
L1_backt28:
v_mfma_f32_16x16x32_bf16 v[32:35], a[192:195], v[64:67], v[192:195]
ds_read_b128 a[236:239], v2 offset:6400
v_add_f32 v208, v208, v212
v_mfma_f32_16x16x32_bf16 v[32:35], a[196:199], v[80:83], v[32:35]
s_add_u32 m0, s26, 36864
v_exp_f32 v224, v56
v_mfma_f32_16x16x32_bf16 v[32:35], a[200:203], v[96:99], v[32:35]
buffer_load_dwordx4 v20, s[12:15], s28 offen offset:0 nt lds
v_mfma_f32_16x16x32_bf16 v[36:39], a[192:195], v[68:71], v[196:199]
v_exp_f32 v225, v57
v_mfma_f32_16x16x32_bf16 v[36:39], a[196:199], v[84:87], v[36:39]
v_exp_f32 v226, v58
v_mfma_f32_16x16x32_bf16 v[36:39], a[200:203], v[100:103], v[36:39]
v_exp_f32 v227, v59
v_mfma_f32_16x16x32_bf16 v[40:43], a[192:195], v[72:75], v[200:203]
v_exp_f32 v228, v60
v_mfma_f32_16x16x32_bf16 v[40:43], a[196:199], v[88:91], v[40:43]
v_exp_f32 v229, v61
v_mfma_f32_16x16x32_bf16 v[40:43], a[200:203], v[104:107], v[40:43]
v_exp_f32 v230, v62
v_mfma_f32_16x16x32_bf16 v[44:47], a[192:195], v[76:79], v[204:207]
ds_read_b64_tr_b16 a[192:193], v5 offset:12288
v_add_f32 v209, v209, v213
v_mfma_f32_16x16x32_bf16 v[44:47], a[196:199], v[92:95], v[44:47]
v_readfirstlane_b32 s91, v250
v_add_f32 v210, v210, v214
v_mfma_f32_16x16x32_bf16 v[44:47], a[200:203], v[108:111], v[44:47]
ds_read_b64_tr_b16 a[194:195], v5 offset:18432
v_add_f32 v211, v211, v215
v_mfma_f32_16x16x32_bf16 v[32:35], a[204:207], v[112:115], v[32:35]
s_cmp_lg_u32 s91, 4
s_cbranch_scc1 L1_dspin
L1_dback:
v_mfma_f32_16x16x32_bf16 v[32:35], a[208:211], v[128:131], v[32:35]
ds_read_b64_tr_b16 a[196:197], v6 offset:12288
v_add_f32 v210, v210, v224
v_mfma_f32_16x16x32_bf16 v[32:35], a[212:215], v[144:147], v[32:35]
ds_read_b64_tr_b16 a[198:199], v6 offset:18432
v_add_f32 v210, v210, v225
v_mfma_f32_16x16x32_bf16 v[36:39], a[204:207], v[116:119], v[36:39]
buffer_load_dwordx4 v21, s[12:15], s28 offen offset:1024 nt lds
v_mfma_f32_16x16x32_bf16 v[36:39], a[208:211], v[132:135], v[36:39]
ds_read_b64_tr_b16 a[200:201], v7 offset:12288
v_cvt_pk_bf16_f32 v186, v224, v225
v_mfma_f32_16x16x32_bf16 v[36:39], a[212:215], v[148:151], v[36:39]
ds_read_b64_tr_b16 a[202:203], v7 offset:18432
v_add_f32 v210, v210, v226
v_mfma_f32_16x16x32_bf16 v[40:43], a[204:207], v[120:123], v[40:43]
v_exp_f32 v231, v63
v_mfma_f32_16x16x32_bf16 v[40:43], a[208:211], v[136:139], v[40:43]
v_exp_f32 v216, v32
v_mfma_f32_16x16x32_bf16 v[40:43], a[212:215], v[152:155], v[40:43]
v_exp_f32 v217, v33
v_mfma_f32_16x16x32_bf16 v[44:47], a[204:207], v[124:127], v[44:47]
ds_read_b64_tr_b16 a[204:205], v8 offset:12288
v_add_f32 v210, v210, v227
v_mfma_f32_16x16x32_bf16 v[44:47], a[208:211], v[140:143], v[44:47]
ds_read_b64_tr_b16 a[206:207], v8 offset:18432
v_cvt_pk_bf16_f32 v187, v226, v227
v_mfma_f32_16x16x32_bf16 v[44:47], a[212:215], v[156:159], v[44:47]
ds_read_b64_tr_b16 a[208:209], v5 offset:12416
v_add_f32 v211, v211, v228
v_mfma_f32_16x16x32_bf16 v[48:51], a[216:219], v[64:67], v[192:195]
ds_read_b64_tr_b16 a[210:211], v5 offset:18560
v_add_f32 v211, v211, v229
v_mfma_f32_16x16x32_bf16 v[48:51], a[220:223], v[80:83], v[48:51]
ds_read_b64_tr_b16 a[212:213], v6 offset:12416
v_cvt_pk_bf16_f32 v190, v228, v229
v_mfma_f32_16x16x32_bf16 v[48:51], a[224:227], v[96:99], v[48:51]
ds_read_b64_tr_b16 a[214:215], v6 offset:18560
v_add_f32 v211, v211, v230
v_mfma_f32_16x16x32_bf16 v[52:55], a[216:219], v[68:71], v[196:199]
v_exp_f32 v218, v34
v_mfma_f32_16x16x32_bf16 v[52:55], a[220:223], v[84:87], v[52:55]
buffer_load_dwordx4 v22, s[12:15], s28 offen offset:2048 nt lds
v_mfma_f32_16x16x32_bf16 v[52:55], a[224:227], v[100:103], v[52:55]
s_add_u32 s28, s28, 12288
v_exp_f32 v219, v35
v_mfma_f32_16x16x32_bf16 v[56:59], a[216:219], v[72:75], v[200:203]
v_exp_f32 v220, v36
v_mfma_f32_16x16x32_bf16 v[56:59], a[220:223], v[88:91], v[56:59]
v_exp_f32 v221, v37
v_mfma_f32_16x16x32_bf16 v[56:59], a[224:227], v[104:107], v[56:59]
v_exp_f32 v222, v38
v_mfma_f32_16x16x32_bf16 v[60:63], a[216:219], v[76:79], v[204:207]
ds_read_b64_tr_b16 a[216:217], v7 offset:12416
v_add_f32 v211, v211, v231
v_mfma_f32_16x16x32_bf16 v[60:63], a[220:223], v[92:95], v[60:63]
ds_read_b64_tr_b16 a[218:219], v7 offset:18560
v_cvt_pk_bf16_f32 v191, v230, v231
v_mfma_f32_16x16x32_bf16 v[60:63], a[224:227], v[108:111], v[60:63]
ds_read_b64_tr_b16 a[220:221], v8 offset:12416
v_add_f32 v212, v216, v217
v_mfma_f32_16x16x32_bf16 v[48:51], a[228:231], v[112:115], v[48:51]
s_waitcnt lgkmcnt(3)
ds_read_b64_tr_b16 a[222:223], v8 offset:18560
v_cvt_pk_bf16_f32 v160, v216, v217
v_mfma_f32_16x16x32_bf16 v[48:51], a[232:235], v[128:131], v[48:51]
ds_read_b64_tr_b16 a[224:225], v5 offset:12544
v_add_f32 v212, v212, v218
v_mfma_f32_16x16x32_bf16 v[48:51], a[236:239], v[144:147], v[48:51]
ds_read_b64_tr_b16 a[226:227], v5 offset:18688
v_add_f32 v212, v212, v219
v_mfma_f32_16x16x32_bf16 v[52:55], a[228:231], v[116:119], v[52:55]
v_exp_f32 v223, v39
v_mfma_f32_16x16x32_bf16 v[52:55], a[232:235], v[132:135], v[52:55]
v_exp_f32 v224, v40
v_mfma_f32_16x16x32_bf16 v[52:55], a[236:239], v[148:151], v[52:55]
v_exp_f32 v225, v41
v_mfma_f32_16x16x32_bf16 v[56:59], a[228:231], v[120:123], v[56:59]
v_exp_f32 v226, v42
v_mfma_f32_16x16x32_bf16 v[56:59], a[232:235], v[136:139], v[56:59]
v_exp_f32 v227, v43
v_mfma_f32_16x16x32_bf16 v[56:59], a[236:239], v[152:155], v[56:59]
v_exp_f32 v228, v44
v_mfma_f32_16x16x32_bf16 v[60:63], a[228:231], v[124:127], v[60:63]
ds_read_b64_tr_b16 a[228:229], v6 offset:12544
v_cvt_pk_bf16_f32 v161, v218, v219
v_mfma_f32_16x16x32_bf16 v[60:63], a[232:235], v[140:143], v[60:63]
ds_read_b64_tr_b16 a[230:231], v6 offset:18688
v_add_f32 v213, v220, v221
v_mfma_f32_16x16x32_bf16 v[60:63], a[236:239], v[156:159], v[60:63]
ds_read_b64_tr_b16 a[232:233], v7 offset:12544
v_cvt_pk_bf16_f32 v164, v220, v221
v_mfma_f32_16x16x32_bf16 a[0:3], a[192:195], v[176:179], a[0:3]
ds_read_b64_tr_b16 a[234:235], v7 offset:18688
v_add_f32 v213, v213, v222
v_mfma_f32_16x16x32_bf16 a[4:7], a[192:195], v[180:183], a[4:7]
ds_read_b64_tr_b16 a[236:237], v8 offset:12544
v_add_f32 v213, v213, v223
v_mfma_f32_16x16x32_bf16 a[8:11], a[192:195], v[184:187], a[8:11]
ds_read_b64_tr_b16 a[238:239], v8 offset:18688
v_cvt_pk_bf16_f32 v165, v222, v223
v_mfma_f32_16x16x32_bf16 a[12:15], a[192:195], v[188:191], a[12:15]
v_exp_f32 v229, v45
v_mfma_f32_16x16x32_bf16 a[28:31], a[196:199], v[188:191], a[28:31]
v_exp_f32 v230, v46
v_mfma_f32_16x16x32_bf16 a[24:27], a[196:199], v[184:187], a[24:27]
s_waitcnt vmcnt(9) lgkmcnt(0)
v_exp_f32 v231, v47
v_mfma_f32_16x16x32_bf16 a[20:23], a[196:199], v[180:183], a[20:23]
s_barrier
v_exp_f32 v216, v48
v_mfma_f32_16x16x32_bf16 a[16:19], a[196:199], v[176:179], a[16:19]
ds_read_b128 a[192:195], v1 offset:12288
v_add_f32 v214, v224, v225
v_mfma_f32_16x16x32_bf16 a[32:35], a[200:203], v[176:179], a[32:35]
s_add_u32 s88, s80, 163840
ds_read_b128 a[196:199], v2 offset:12288
v_cvt_pk_bf16_f32 v168, v224, v225
v_mfma_f32_16x16x32_bf16 a[36:39], a[200:203], v[180:183], a[36:39]
s_add_u32 m0, s25, 0
v_exp_f32 v217, v49
v_mfma_f32_16x16x32_bf16 a[40:43], a[200:203], v[184:187], a[40:43]
buffer_load_dwordx4 v23, s[64:67], s88 offen offset:0 lds
v_mfma_f32_16x16x32_bf16 a[44:47], a[200:203], v[188:191], a[44:47]
ds_read_b128 a[200:203], v1 offset:12416
v_add_f32 v214, v214, v226
v_mfma_f32_16x16x32_bf16 a[60:63], a[204:207], v[188:191], a[60:63]
v_exp_f32 v218, v50
v_mfma_f32_16x16x32_bf16 a[56:59], a[204:207], v[184:187], a[56:59]
v_exp_f32 v219, v51
v_mfma_f32_16x16x32_bf16 a[52:55], a[204:207], v[180:183], a[52:55]
v_add_f32 v214, v214, v227
v_cvt_pk_bf16_f32 v169, v226, v227
v_mfma_f32_16x16x32_bf16 a[48:51], a[204:207], v[176:179], a[48:51]
buffer_load_dwordx4 v24, s[64:67], s88 offen offset:1024 lds
v_mfma_f32_16x16x32_bf16 a[64:67], a[208:211], v[176:179], a[64:67]
ds_read_b128 a[204:207], v2 offset:12416
v_add_f32 v215, v228, v229
v_mfma_f32_16x16x32_bf16 a[68:71], a[208:211], v[180:183], a[68:71]
v_exp_f32 v220, v52
v_mfma_f32_16x16x32_bf16 a[72:75], a[208:211], v[184:187], a[72:75]
v_exp_f32 v221, v53
v_mfma_f32_16x16x32_bf16 a[76:79], a[208:211], v[188:191], a[76:79]
ds_read_b128 a[208:211], v1 offset:12544
v_cvt_pk_bf16_f32 v172, v228, v229
v_mfma_f32_16x16x32_bf16 a[92:95], a[212:215], v[188:191], a[92:95]
buffer_load_dwordx4 v25, s[64:67], s88 offen offset:2048 lds
v_mfma_f32_16x16x32_bf16 a[88:91], a[212:215], v[184:187], a[88:91]
v_exp_f32 v222, v54
v_mfma_f32_16x16x32_bf16 a[84:87], a[212:215], v[180:183], a[84:87]
v_exp_f32 v223, v55
v_mfma_f32_16x16x32_bf16 a[80:83], a[212:215], v[176:179], a[80:83]
ds_read_b128 a[212:215], v2 offset:12544
v_add_f32 v215, v215, v230
v_mfma_f32_16x16x32_bf16 a[96:99], a[216:219], v[176:179], a[96:99]
s_add_u32 s88, s81, 40960
v_add_f32 v215, v215, v231
v_cvt_pk_bf16_f32 v173, v230, v231
v_mfma_f32_16x16x32_bf16 a[100:103], a[216:219], v[180:183], a[100:103]
s_add_u32 m0, s26, 12288
v_add_f32 v212, v212, v216
v_add_f32 v212, v212, v217
v_mfma_f32_16x16x32_bf16 a[104:107], a[216:219], v[184:187], a[104:107]
buffer_load_dwordx4 v23, s[64:67], s88 offen offset:0 lds
v_mfma_f32_16x16x32_bf16 a[108:111], a[216:219], v[188:191], a[108:111]
ds_read_b128 a[216:219], v1 offset:18432
v_cvt_pk_bf16_f32 v162, v216, v217
v_mfma_f32_16x16x32_bf16 a[124:127], a[220:223], v[188:191], a[124:127]
v_add_f32 v212, v212, v218
v_add_f32 v212, v212, v219
v_mfma_f32_16x16x32_bf16 a[120:123], a[220:223], v[184:187], a[120:123]
v_cvt_pk_bf16_f32 v163, v218, v219
v_add_f32 v213, v213, v220
v_mfma_f32_16x16x32_bf16 a[116:119], a[220:223], v[180:183], a[116:119]
v_add_f32 v213, v213, v221
v_cvt_pk_bf16_f32 v166, v220, v221
v_mfma_f32_16x16x32_bf16 a[112:115], a[220:223], v[176:179], a[112:115]
buffer_load_dwordx4 v24, s[64:67], s88 offen offset:1024 lds
v_mfma_f32_16x16x32_bf16 a[128:131], a[224:227], v[176:179], a[128:131]
ds_read_b128 a[220:223], v2 offset:18432
v_add_f32 v213, v213, v222
v_mfma_f32_16x16x32_bf16 a[132:135], a[224:227], v[180:183], a[132:135]
v_add_f32 v213, v213, v223
v_cvt_pk_bf16_f32 v167, v222, v223
v_mfma_f32_16x16x32_bf16 a[136:139], a[224:227], v[184:187], a[136:139]
v_max3_f32 v232, v56, v57, v58
v_max3_f32 v233, v59, v60, v61
v_mfma_f32_16x16x32_bf16 a[140:143], a[224:227], v[188:191], a[140:143]
ds_read_b128 a[224:227], v1 offset:18560
v_max3_f32 v232, v232, v62, v63
v_mfma_f32_16x16x32_bf16 a[156:159], a[228:231], v[188:191], a[156:159]
buffer_load_dwordx4 v25, s[64:67], s88 offen offset:2048 lds
v_mfma_f32_16x16x32_bf16 a[152:155], a[228:231], v[184:187], a[152:155]
v_max3_f32 v233, v233, v214, v215
v_max3_f32 v232, v232, v233, v212
v_mfma_f32_16x16x32_bf16 a[148:151], a[228:231], v[180:183], a[148:151]
v_max_f32 v232, v232, v213
v_cmp_lt_f32 vcc, 0x42800000, v232
v_mfma_f32_16x16x32_bf16 a[144:147], a[228:231], v[176:179], a[144:147]
ds_read_b128 a[228:231], v2 offset:18560
v_mfma_f32_16x16x32_bf16 a[160:163], a[232:235], v[176:179], a[160:163]
v_mfma_f32_16x16x32_bf16 a[164:167], a[232:235], v[180:183], a[164:167]
v_mfma_f32_16x16x32_bf16 a[168:171], a[232:235], v[184:187], a[168:171]
v_mfma_f32_16x16x32_bf16 a[172:175], a[232:235], v[188:191], a[172:175]
ds_read_b128 a[232:235], v1 offset:18688
v_mfma_f32_16x16x32_bf16 a[188:191], a[236:239], v[188:191], a[188:191]
v_mfma_f32_16x16x32_bf16 a[184:187], a[236:239], v[184:187], a[184:187]
s_waitcnt lgkmcnt(1)
v_mfma_f32_16x16x32_bf16 a[180:183], a[236:239], v[180:183], a[180:183]
v_mfma_f32_16x16x32_bf16 a[176:179], a[236:239], v[176:179], a[176:179]
s_cbranch_vccnz L1_stubt29
L1_backt29:
v_mfma_f32_16x16x32_bf16 v[32:35], a[192:195], v[64:67], v[192:195]
ds_read_b128 a[236:239], v2 offset:18688
v_add_f32 v208, v208, v212
v_mfma_f32_16x16x32_bf16 v[32:35], a[196:199], v[80:83], v[32:35]
v_exp_f32 v224, v56
v_mfma_f32_16x16x32_bf16 v[32:35], a[200:203], v[96:99], v[32:35]
v_exp_f32 v225, v57
v_mfma_f32_16x16x32_bf16 v[36:39], a[192:195], v[68:71], v[196:199]
v_exp_f32 v226, v58
v_mfma_f32_16x16x32_bf16 v[36:39], a[196:199], v[84:87], v[36:39]
v_exp_f32 v227, v59
v_mfma_f32_16x16x32_bf16 v[36:39], a[200:203], v[100:103], v[36:39]
v_exp_f32 v228, v60
v_mfma_f32_16x16x32_bf16 v[40:43], a[192:195], v[72:75], v[200:203]
v_exp_f32 v229, v61
v_mfma_f32_16x16x32_bf16 v[40:43], a[196:199], v[88:91], v[40:43]
v_exp_f32 v230, v62
v_mfma_f32_16x16x32_bf16 v[40:43], a[200:203], v[104:107], v[40:43]
v_exp_f32 v231, v63
v_mfma_f32_16x16x32_bf16 v[44:47], a[192:195], v[76:79], v[204:207]
ds_read_b64_tr_b16 a[192:193], v5 offset:24576
v_add_f32 v209, v209, v213
v_mfma_f32_16x16x32_bf16 v[44:47], a[196:199], v[92:95], v[44:47]
ds_read_b64_tr_b16 a[194:195], v5 offset:30720
v_add_f32 v210, v210, v214
v_mfma_f32_16x16x32_bf16 v[44:47], a[200:203], v[108:111], v[44:47]
ds_read_b64_tr_b16 a[196:197], v6 offset:24576
v_add_f32 v211, v211, v215
v_mfma_f32_16x16x32_bf16 v[32:35], a[204:207], v[112:115], v[32:35]
ds_read_b64_tr_b16 a[198:199], v6 offset:30720
v_add_f32 v210, v210, v224
v_mfma_f32_16x16x32_bf16 v[32:35], a[208:211], v[128:131], v[32:35]
ds_read_b64_tr_b16 a[200:201], v7 offset:24576
v_add_f32 v210, v210, v225
v_mfma_f32_16x16x32_bf16 v[32:35], a[212:215], v[144:147], v[32:35]
ds_read_b64_tr_b16 a[202:203], v7 offset:30720
v_cvt_pk_bf16_f32 v170, v224, v225
v_mfma_f32_16x16x32_bf16 v[36:39], a[204:207], v[116:119], v[36:39]
v_add_f32 v210, v210, v226
v_add_f32 v210, v210, v227
v_mfma_f32_16x16x32_bf16 v[36:39], a[208:211], v[132:135], v[36:39]
v_cvt_pk_bf16_f32 v171, v226, v227
v_add_f32 v211, v211, v228
v_mfma_f32_16x16x32_bf16 v[36:39], a[212:215], v[148:151], v[36:39]
v_exp_f32 v216, v32
v_mfma_f32_16x16x32_bf16 v[40:43], a[204:207], v[120:123], v[40:43]
v_exp_f32 v217, v33
v_mfma_f32_16x16x32_bf16 v[40:43], a[208:211], v[136:139], v[40:43]
v_exp_f32 v218, v34
v_mfma_f32_16x16x32_bf16 v[40:43], a[212:215], v[152:155], v[40:43]
v_exp_f32 v219, v35
v_mfma_f32_16x16x32_bf16 v[44:47], a[204:207], v[124:127], v[44:47]
ds_read_b64_tr_b16 a[204:205], v8 offset:24576
v_add_f32 v211, v211, v229
v_mfma_f32_16x16x32_bf16 v[44:47], a[208:211], v[140:143], v[44:47]
ds_read_b64_tr_b16 a[206:207], v8 offset:30720
v_cvt_pk_bf16_f32 v174, v228, v229
v_mfma_f32_16x16x32_bf16 v[44:47], a[212:215], v[156:159], v[44:47]
ds_read_b64_tr_b16 a[208:209], v5 offset:24704
v_add_f32 v211, v211, v230
v_mfma_f32_16x16x32_bf16 v[48:51], a[216:219], v[64:67], v[192:195]
ds_read_b64_tr_b16 a[210:211], v5 offset:30848
v_add_f32 v211, v211, v231
v_mfma_f32_16x16x32_bf16 v[48:51], a[220:223], v[80:83], v[48:51]
ds_read_b64_tr_b16 a[212:213], v6 offset:24704
v_cvt_pk_bf16_f32 v175, v230, v231
v_mfma_f32_16x16x32_bf16 v[48:51], a[224:227], v[96:99], v[48:51]
ds_read_b64_tr_b16 a[214:215], v6 offset:30848
v_add_f32 v212, v216, v217
v_mfma_f32_16x16x32_bf16 v[52:55], a[216:219], v[68:71], v[196:199]
v_exp_f32 v220, v36
v_mfma_f32_16x16x32_bf16 v[52:55], a[220:223], v[84:87], v[52:55]
v_exp_f32 v221, v37
v_mfma_f32_16x16x32_bf16 v[52:55], a[224:227], v[100:103], v[52:55]
v_exp_f32 v222, v38
v_mfma_f32_16x16x32_bf16 v[56:59], a[216:219], v[72:75], v[200:203]
v_exp_f32 v223, v39
v_mfma_f32_16x16x32_bf16 v[56:59], a[220:223], v[88:91], v[56:59]
v_exp_f32 v224, v40
v_mfma_f32_16x16x32_bf16 v[56:59], a[224:227], v[104:107], v[56:59]
v_exp_f32 v225, v41
v_mfma_f32_16x16x32_bf16 v[60:63], a[216:219], v[76:79], v[204:207]
ds_read_b64_tr_b16 a[216:217], v7 offset:24704
v_cvt_pk_bf16_f32 v176, v216, v217
v_mfma_f32_16x16x32_bf16 v[60:63], a[220:223], v[92:95], v[60:63]
ds_read_b64_tr_b16 a[218:219], v7 offset:30848
v_add_f32 v212, v212, v218
v_mfma_f32_16x16x32_bf16 v[60:63], a[224:227], v[108:111], v[60:63]
ds_read_b64_tr_b16 a[220:221], v8 offset:24704
v_add_f32 v212, v212, v219
v_mfma_f32_16x16x32_bf16 v[48:51], a[228:231], v[112:115], v[48:51]
s_waitcnt lgkmcnt(3)
ds_read_b64_tr_b16 a[222:223], v8 offset:30848
v_cvt_pk_bf16_f32 v177, v218, v219
v_mfma_f32_16x16x32_bf16 v[48:51], a[232:235], v[128:131], v[48:51]
ds_read_b64_tr_b16 a[224:225], v5 offset:24832
v_add_f32 v213, v220, v221
v_mfma_f32_16x16x32_bf16 v[48:51], a[236:239], v[144:147], v[48:51]
ds_read_b64_tr_b16 a[226:227], v5 offset:30976
v_cvt_pk_bf16_f32 v180, v220, v221
v_mfma_f32_16x16x32_bf16 v[52:55], a[228:231], v[116:119], v[52:55]
v_exp_f32 v226, v42
v_mfma_f32_16x16x32_bf16 v[52:55], a[232:235], v[132:135], v[52:55]
v_exp_f32 v227, v43
v_mfma_f32_16x16x32_bf16 v[52:55], a[236:239], v[148:151], v[52:55]
v_exp_f32 v228, v44
v_mfma_f32_16x16x32_bf16 v[56:59], a[228:231], v[120:123], v[56:59]
v_exp_f32 v229, v45
v_mfma_f32_16x16x32_bf16 v[56:59], a[232:235], v[136:139], v[56:59]
v_exp_f32 v230, v46
v_mfma_f32_16x16x32_bf16 v[56:59], a[236:239], v[152:155], v[56:59]
v_exp_f32 v231, v47
v_mfma_f32_16x16x32_bf16 v[60:63], a[228:231], v[124:127], v[60:63]
ds_read_b64_tr_b16 a[228:229], v6 offset:24832
v_add_f32 v213, v213, v222
v_mfma_f32_16x16x32_bf16 v[60:63], a[232:235], v[140:143], v[60:63]
ds_read_b64_tr_b16 a[230:231], v6 offset:30976
v_add_f32 v213, v213, v223
v_mfma_f32_16x16x32_bf16 v[60:63], a[236:239], v[156:159], v[60:63]
ds_read_b64_tr_b16 a[232:233], v7 offset:24832
v_cvt_pk_bf16_f32 v181, v222, v223
v_mfma_f32_16x16x32_bf16 a[0:3], a[192:195], v[160:163], a[0:3]
ds_read_b64_tr_b16 a[234:235], v7 offset:30976
v_add_f32 v214, v224, v225
v_mfma_f32_16x16x32_bf16 a[4:7], a[192:195], v[164:167], a[4:7]
ds_read_b64_tr_b16 a[236:237], v8 offset:24832
v_cvt_pk_bf16_f32 v184, v224, v225
v_mfma_f32_16x16x32_bf16 a[8:11], a[192:195], v[168:171], a[8:11]
ds_read_b64_tr_b16 a[238:239], v8 offset:30976
v_add_f32 v214, v214, v226
v_mfma_f32_16x16x32_bf16 a[12:15], a[192:195], v[172:175], a[12:15]
v_exp_f32 v216, v48
v_mfma_f32_16x16x32_bf16 a[28:31], a[196:199], v[172:175], a[28:31]
v_exp_f32 v217, v49
v_mfma_f32_16x16x32_bf16 a[24:27], a[196:199], v[168:171], a[24:27]
s_waitcnt vmcnt(6) lgkmcnt(0)
v_exp_f32 v218, v50
v_mfma_f32_16x16x32_bf16 a[20:23], a[196:199], v[164:167], a[20:23]
s_barrier
v_exp_f32 v219, v51
v_mfma_f32_16x16x32_bf16 a[16:19], a[196:199], v[160:163], a[16:19]
ds_read_b64_tr_b16 a[192:193], v9 offset:0
v_add_f32 v214, v214, v227
v_mfma_f32_16x16x32_bf16 a[32:35], a[200:203], v[160:163], a[32:35]
s_add_u32 s88, s80, 204800
ds_read_b64_tr_b16 a[194:195], v9 offset:6144
v_cvt_pk_bf16_f32 v185, v226, v227
v_mfma_f32_16x16x32_bf16 a[36:39], a[200:203], v[164:167], a[36:39]
s_add_u32 m0, s25, 12288
ds_read_b64_tr_b16 a[196:197], v10 offset:0
v_add_f32 v215, v228, v229
v_mfma_f32_16x16x32_bf16 a[40:43], a[200:203], v[168:171], a[40:43]
buffer_load_dwordx4 v23, s[64:67], s88 offen offset:0 lds
v_mfma_f32_16x16x32_bf16 a[44:47], a[200:203], v[172:175], a[44:47]
ds_read_b64_tr_b16 a[198:199], v10 offset:6144
v_cvt_pk_bf16_f32 v188, v228, v229
v_mfma_f32_16x16x32_bf16 a[60:63], a[204:207], v[172:175], a[60:63]
ds_read_b64_tr_b16 a[200:201], v11 offset:0
v_add_f32 v215, v215, v230
v_mfma_f32_16x16x32_bf16 a[56:59], a[204:207], v[168:171], a[56:59]
ds_read_b64_tr_b16 a[202:203], v11 offset:6144
v_add_f32 v215, v215, v231
v_mfma_f32_16x16x32_bf16 a[52:55], a[204:207], v[164:167], a[52:55]
v_exp_f32 v220, v52
v_mfma_f32_16x16x32_bf16 a[48:51], a[204:207], v[160:163], a[48:51]
buffer_load_dwordx4 v24, s[64:67], s88 offen offset:1024 lds
v_mfma_f32_16x16x32_bf16 a[64:67], a[208:211], v[160:163], a[64:67]
ds_read_b64_tr_b16 a[204:205], v12 offset:0
v_cvt_pk_bf16_f32 v189, v230, v231
v_mfma_f32_16x16x32_bf16 a[68:71], a[208:211], v[164:167], a[68:71]
ds_read_b64_tr_b16 a[206:207], v12 offset:6144
v_add_f32 v212, v212, v216
v_mfma_f32_16x16x32_bf16 a[72:75], a[208:211], v[168:171], a[72:75]
v_exp_f32 v221, v53
v_mfma_f32_16x16x32_bf16 a[76:79], a[208:211], v[172:175], a[76:79]
ds_read_b64_tr_b16 a[208:209], v9 offset:128
v_add_f32 v212, v212, v217
v_mfma_f32_16x16x32_bf16 a[92:95], a[212:215], v[172:175], a[92:95]
buffer_load_dwordx4 v25, s[64:67], s88 offen offset:2048 lds
v_mfma_f32_16x16x32_bf16 a[88:91], a[212:215], v[168:171], a[88:91]
ds_read_b64_tr_b16 a[210:211], v9 offset:6272
v_cvt_pk_bf16_f32 v178, v216, v217
v_mfma_f32_16x16x32_bf16 a[84:87], a[212:215], v[164:167], a[84:87]
v_exp_f32 v222, v54
v_mfma_f32_16x16x32_bf16 a[80:83], a[212:215], v[160:163], a[80:83]
ds_read_b64_tr_b16 a[212:213], v10 offset:128
v_add_f32 v212, v212, v218
v_mfma_f32_16x16x32_bf16 a[96:99], a[216:219], v[160:163], a[96:99]
s_add_u32 s88, s81, 81920
ds_read_b64_tr_b16 a[214:215], v10 offset:6272
v_add_f32 v212, v212, v219
v_mfma_f32_16x16x32_bf16 a[100:103], a[216:219], v[164:167], a[100:103]
s_add_u32 m0, s26, 24576
v_exp_f32 v223, v55
v_mfma_f32_16x16x32_bf16 a[104:107], a[216:219], v[168:171], a[104:107]
buffer_load_dwordx4 v23, s[64:67], s88 offen offset:0 lds
v_mfma_f32_16x16x32_bf16 a[108:111], a[216:219], v[172:175], a[108:111]
ds_read_b64_tr_b16 a[216:217], v11 offset:128
v_cvt_pk_bf16_f32 v179, v218, v219
v_mfma_f32_16x16x32_bf16 a[124:127], a[220:223], v[172:175], a[124:127]
ds_read_b64_tr_b16 a[218:219], v11 offset:6272
v_add_f32 v213, v213, v220
v_mfma_f32_16x16x32_bf16 a[120:123], a[220:223], v[168:171], a[120:123]
v_add_f32 v213, v213, v221
v_cvt_pk_bf16_f32 v182, v220, v221
v_mfma_f32_16x16x32_bf16 a[116:119], a[220:223], v[164:167], a[116:119]
v_add_f32 v213, v213, v222
v_add_f32 v213, v213, v223
v_mfma_f32_16x16x32_bf16 a[112:115], a[220:223], v[160:163], a[112:115]
buffer_load_dwordx4 v24, s[64:67], s88 offen offset:1024 lds
v_mfma_f32_16x16x32_bf16 a[128:131], a[224:227], v[160:163], a[128:131]
ds_read_b64_tr_b16 a[220:221], v12 offset:128
v_cvt_pk_bf16_f32 v183, v222, v223
v_mfma_f32_16x16x32_bf16 a[132:135], a[224:227], v[164:167], a[132:135]
ds_read_b64_tr_b16 a[222:223], v12 offset:6272
v_max3_f32 v232, v56, v57, v58
v_mfma_f32_16x16x32_bf16 a[136:139], a[224:227], v[168:171], a[136:139]
v_max3_f32 v233, v59, v60, v61
v_max3_f32 v232, v232, v62, v63
v_mfma_f32_16x16x32_bf16 a[140:143], a[224:227], v[172:175], a[140:143]
ds_read_b64_tr_b16 a[224:225], v9 offset:256
v_max3_f32 v233, v233, v214, v215
v_mfma_f32_16x16x32_bf16 a[156:159], a[228:231], v[172:175], a[156:159]
buffer_load_dwordx4 v25, s[64:67], s88 offen offset:2048 lds
v_mfma_f32_16x16x32_bf16 a[152:155], a[228:231], v[168:171], a[152:155]
ds_read_b64_tr_b16 a[226:227], v9 offset:6400
v_max3_f32 v232, v232, v233, v212
v_mfma_f32_16x16x32_bf16 a[148:151], a[228:231], v[164:167], a[148:151]
v_max_f32 v232, v232, v213
v_cmp_lt_f32 vcc, 0x42800000, v232
v_mfma_f32_16x16x32_bf16 a[144:147], a[228:231], v[160:163], a[144:147]
ds_read_b64_tr_b16 a[228:229], v10 offset:256
v_mfma_f32_16x16x32_bf16 a[160:163], a[232:235], v[160:163], a[160:163]
ds_read_b64_tr_b16 a[230:231], v10 offset:6400
v_mfma_f32_16x16x32_bf16 a[164:167], a[232:235], v[164:167], a[164:167]
v_mfma_f32_16x16x32_bf16 a[168:171], a[232:235], v[168:171], a[168:171]
v_mfma_f32_16x16x32_bf16 a[172:175], a[232:235], v[172:175], a[172:175]
ds_read_b64_tr_b16 a[232:233], v11 offset:256
v_mfma_f32_16x16x32_bf16 a[188:191], a[236:239], v[172:175], a[188:191]
ds_read_b64_tr_b16 a[234:235], v11 offset:6400
v_mfma_f32_16x16x32_bf16 a[184:187], a[236:239], v[168:171], a[184:187]
s_waitcnt lgkmcnt(2)
v_mfma_f32_16x16x32_bf16 a[180:183], a[236:239], v[164:167], a[180:183]
v_mfma_f32_16x16x32_bf16 a[176:179], a[236:239], v[160:163], a[176:179]
s_cbranch_vccnz L1_stubt30
L1_backt30:
s_cmp_eq_u32 s24, 3
s_cselect_b32 s40, 0x40000000, 0
s_add_u32 s42, s84, 0
s_add_u32 s43, s84, 15360
s_add_u32 s44, s84, 30720
s_add_u32 s45, s84, 46080
s_add_u32 s46, s84, 61440
s_add_u32 s47, s84, 76800
s_mul_i32 s41, s24, 20480
s_mov_b32 s30, 0
s_mov_b32 s31, 5120
s_mov_b32 s32, 10240
s_mov_b32 s33, 15360
v_mfma_f32_16x16x32_bf16 a[0:3], a[192:195], v[176:179], a[0:3]
ds_read_b64_tr_b16 a[236:237], v12 offset:256
v_add_f32 v208, v208, v212
v_mfma_f32_16x16x32_bf16 a[4:7], a[192:195], v[180:183], a[4:7]
ds_read_b64_tr_b16 a[238:239], v12 offset:6400
v_add_f32 v209, v209, v213
v_add_f32 v210, v210, v214
v_add_f32 v211, v211, v215
v_exp_f32 v224, v56
v_exp_f32 v225, v57
v_exp_f32 v226, v58
v_exp_f32 v227, v59
v_add_f32 v210, v210, v224
v_add_f32 v210, v210, v225
v_cvt_pk_bf16_f32 v186, v224, v225
v_add_f32 v210, v210, v226
v_add_f32 v210, v210, v227
v_cvt_pk_bf16_f32 v187, v226, v227
v_exp_f32 v228, v60
v_exp_f32 v229, v61
v_exp_f32 v230, v62
v_exp_f32 v231, v63
v_add_f32 v211, v211, v228
v_add_f32 v211, v211, v229
v_cvt_pk_bf16_f32 v190, v228, v229
v_add_f32 v211, v211, v230
v_add_f32 v211, v211, v231
v_cvt_pk_bf16_f32 v191, v230, v231
v_mfma_f32_16x16x32_bf16 a[8:11], a[192:195], v[184:187], a[8:11]
v_lshlrev_b32 v17, 4, v0
v_add_u32 v18, s41, v17
v_mfma_f32_16x16x32_bf16 a[12:15], a[192:195], v[188:191], a[12:15]
ds_read_b64_tr_b16 a[192:193], v26 offset:24576
v_add_u32 v19, 4096, v18
v_mfma_f32_16x16x32_bf16 a[16:19], a[196:199], v[176:179], a[16:19]
ds_read_b64_tr_b16 a[194:195], v26 offset:30720
v_lshl_add_u32 v17, s24, 12, v17
v_mfma_f32_16x16x32_bf16 a[20:23], a[196:199], v[180:183], a[20:23]
v_add_u32 v20, s40, v17
v_mov_b32 v232, v208
v_mfma_f32_16x16x32_bf16 a[24:27], a[196:199], v[184:187], a[24:27]
v_mov_b32 v233, v209
v_permlane32_swap_b32 v208, v232
v_mfma_f32_16x16x32_bf16 a[28:31], a[196:199], v[188:191], a[28:31]
ds_read_b64_tr_b16 a[196:197], v26 offset:24584
v_add_f32 v208, v208, v232
v_mfma_f32_16x16x32_bf16 a[32:35], a[200:203], v[176:179], a[32:35]
ds_read_b64_tr_b16 a[198:199], v26 offset:30728
v_mov_b32 v232, v208
v_mfma_f32_16x16x32_bf16 a[36:39], a[200:203], v[180:183], a[36:39]
v_permlane32_swap_b32 v209, v233
v_permlane16_swap_b32 v208, v232
v_mfma_f32_16x16x32_bf16 a[40:43], a[200:203], v[184:187], a[40:43]
v_add_f32 v208, v208, v232
v_add_f32 v209, v209, v233
v_mfma_f32_16x16x32_bf16 a[44:47], a[200:203], v[188:191], a[44:47]
ds_read_b64_tr_b16 a[200:201], v27 offset:24576
v_mov_b32 v233, v209
v_mfma_f32_16x16x32_bf16 a[48:51], a[204:207], v[176:179], a[48:51]
ds_read_b64_tr_b16 a[202:203], v27 offset:30720
v_permlane16_swap_b32 v209, v233
v_mfma_f32_16x16x32_bf16 a[52:55], a[204:207], v[180:183], a[52:55]
v_rcp_f32 v208, v208
v_mfma_f32_16x16x32_bf16 a[56:59], a[204:207], v[184:187], a[56:59]
v_add_f32 v209, v209, v233
v_mov_b32 v234, v210
v_mfma_f32_16x16x32_bf16 a[60:63], a[204:207], v[188:191], a[60:63]
ds_read_b64_tr_b16 a[204:205], v27 offset:24584
v_permlane32_swap_b32 v210, v234
v_mfma_f32_16x16x32_bf16 a[64:67], a[208:211], v[176:179], a[64:67]
ds_read_b64_tr_b16 a[206:207], v27 offset:30728
v_add_f32 v210, v210, v234
v_mfma_f32_16x16x32_bf16 a[68:71], a[208:211], v[180:183], a[68:71]
v_rcp_f32 v209, v209
v_mfma_f32_16x16x32_bf16 a[72:75], a[208:211], v[184:187], a[72:75]
v_mov_b32 v234, v210
v_mov_b32 v235, v211
v_mfma_f32_16x16x32_bf16 a[76:79], a[208:211], v[188:191], a[76:79]
ds_read_b64_tr_b16 a[208:209], v26 offset:24704
v_permlane16_swap_b32 v210, v234
v_mfma_f32_16x16x32_bf16 a[80:83], a[212:215], v[176:179], a[80:83]
ds_read_b64_tr_b16 a[210:211], v26 offset:30848
v_add_f32 v210, v210, v234
v_mfma_f32_16x16x32_bf16 a[84:87], a[212:215], v[180:183], a[84:87]
v_rcp_f32 v210, v210
v_mfma_f32_16x16x32_bf16 a[88:91], a[212:215], v[184:187], a[88:91]
v_permlane32_swap_b32 v211, v235
v_add_f32 v211, v211, v235
v_mfma_f32_16x16x32_bf16 a[92:95], a[212:215], v[188:191], a[92:95]
ds_read_b64_tr_b16 a[212:213], v26 offset:24712
v_mov_b32 v235, v211
v_mfma_f32_16x16x32_bf16 a[96:99], a[216:219], v[176:179], a[96:99]
ds_read_b64_tr_b16 a[214:215], v26 offset:30856
v_permlane16_swap_b32 v211, v235
v_mfma_f32_16x16x32_bf16 a[100:103], a[216:219], v[180:183], a[100:103]
v_add_f32 v211, v211, v235
v_accvgpr_read_b32 v232, a0
v_mfma_f32_16x16x32_bf16 a[104:107], a[216:219], v[184:187], a[104:107]
v_rcp_f32 v211, v211
v_mfma_f32_16x16x32_bf16 a[108:111], a[216:219], v[188:191], a[108:111]
ds_read_b64_tr_b16 a[216:217], v27 offset:24704
v_accvgpr_read_b32 v233, a1
v_mfma_f32_16x16x32_bf16 a[112:115], a[220:223], v[176:179], a[112:115]
ds_read_b64_tr_b16 a[218:219], v27 offset:30848
v_accvgpr_read_b32 v234, a2
v_mfma_f32_16x16x32_bf16 a[116:119], a[220:223], v[180:183], a[116:119]
v_accvgpr_read_b32 v235, a3
v_accvgpr_read_b32 v236, a16
v_mfma_f32_16x16x32_bf16 a[120:123], a[220:223], v[184:187], a[120:123]
v_accvgpr_read_b32 v237, a17
v_accvgpr_read_b32 v238, a18
v_mfma_f32_16x16x32_bf16 a[124:127], a[220:223], v[188:191], a[124:127]
ds_read_b64_tr_b16 a[220:221], v27 offset:24712
v_accvgpr_read_b32 v239, a19
v_mfma_f32_16x16x32_bf16 a[128:131], a[224:227], v[176:179], a[128:131]
ds_read_b64_tr_b16 a[222:223], v27 offset:30856
v_mul_f32 v232, v208, v232
v_mfma_f32_16x16x32_bf16 a[132:135], a[224:227], v[180:183], a[132:135]
v_mul_f32 v233, v208, v233
v_mul_f32 v234, v208, v234
v_mfma_f32_16x16x32_bf16 a[136:139], a[224:227], v[184:187], a[136:139]
v_mul_f32 v235, v208, v235
v_mul_f32 v236, v208, v236
v_mfma_f32_16x16x32_bf16 a[140:143], a[224:227], v[188:191], a[140:143]
ds_read_b64_tr_b16 a[224:225], v26 offset:24832
v_mul_f32 v237, v208, v237
v_mfma_f32_16x16x32_bf16 a[144:147], a[228:231], v[176:179], a[144:147]
ds_read_b64_tr_b16 a[226:227], v26 offset:30976
v_mul_f32 v238, v208, v238
v_mfma_f32_16x16x32_bf16 a[148:151], a[228:231], v[180:183], a[148:151]
v_mul_f32 v239, v208, v239
v_cvt_pk_bf16_f32 v64, v232, v233
v_mfma_f32_16x16x32_bf16 a[152:155], a[228:231], v[184:187], a[152:155]
v_cvt_pk_bf16_f32 v65, v234, v235
v_cvt_pk_bf16_f32 v66, v236, v237
v_mfma_f32_16x16x32_bf16 a[156:159], a[228:231], v[188:191], a[156:159]
s_waitcnt lgkmcnt(2)
ds_read_b64_tr_b16 a[228:229], v26 offset:24840
v_cvt_pk_bf16_f32 v67, v238, v239
v_mfma_f32_16x16x32_bf16 a[160:163], a[232:235], v[176:179], a[160:163]
ds_read_b64_tr_b16 a[230:231], v26 offset:30984
v_accvgpr_read_b32 v212, a4
v_mfma_f32_16x16x32_bf16 a[164:167], a[232:235], v[180:183], a[164:167]
buffer_store_dwordx4 v[64:67], v17, s[20:23], s42 offen offset:0 sc1
v_mfma_f32_16x16x32_bf16 a[168:171], a[232:235], v[184:187], a[168:171]
v_accvgpr_read_b32 v213, a5
v_accvgpr_read_b32 v214, a6
v_mfma_f32_16x16x32_bf16 a[172:175], a[232:235], v[188:191], a[172:175]
ds_read_b64_tr_b16 a[232:233], v28 offset:0
v_accvgpr_read_b32 v215, a7
v_mfma_f32_16x16x32_bf16 a[176:179], a[236:239], v[176:179], a[176:179]
ds_read_b64_tr_b16 a[234:235], v28 offset:6144
v_accvgpr_read_b32 v1, a20
v_mfma_f32_16x16x32_bf16 a[180:183], a[236:239], v[180:183], a[180:183]
v_accvgpr_read_b32 v2, a21
v_accvgpr_read_b32 v3, a22
v_mfma_f32_16x16x32_bf16 a[184:187], a[236:239], v[184:187], a[184:187]
v_accvgpr_read_b32 v4, a23
v_mul_f32 v212, v209, v212
v_mfma_f32_16x16x32_bf16 a[188:191], a[236:239], v[188:191], a[188:191]
ds_read_b64_tr_b16 a[236:237], v28 offset:8
v_mul_f32 v213, v209, v213
v_mfma_f32_16x16x32_bf16 v[192:195], a[192:195], v[64:67], 0
ds_read_b64_tr_b16 a[238:239], v28 offset:6152
v_mul_f32 v214, v209, v214
v_mul_f32 v215, v209, v215
v_mul_f32 v1, v209, v1
v_mul_f32 v2, v209, v2
v_mul_f32 v3, v209, v3
v_mul_f32 v4, v209, v4
v_cvt_pk_bf16_f32 v68, v212, v213
v_cvt_pk_bf16_f32 v69, v214, v215
v_cvt_pk_bf16_f32 v70, v1, v2
v_cvt_pk_bf16_f32 v71, v3, v4
s_nop 1
v_mfma_f32_16x16x32_bf16 v[196:199], a[192:195], v[68:71], 0
buffer_store_dwordx4 v[68:71], v17, s[20:23], s42 offen offset:1024 sc1
v_accvgpr_read_b32 v232, a8
v_accvgpr_read_b32 v233, a9
v_accvgpr_read_b32 v234, a10
v_accvgpr_read_b32 v235, a11
v_accvgpr_read_b32 v236, a24
v_accvgpr_read_b32 v237, a25
v_accvgpr_read_b32 v238, a26
v_accvgpr_read_b32 v239, a27
v_mul_f32 v232, v210, v232
v_mul_f32 v233, v210, v233
v_mul_f32 v234, v210, v234
v_mul_f32 v235, v210, v235
v_mul_f32 v236, v210, v236
v_mul_f32 v237, v210, v237
v_mul_f32 v238, v210, v238
v_mul_f32 v239, v210, v239
v_cvt_pk_bf16_f32 v72, v232, v233
v_cvt_pk_bf16_f32 v73, v234, v235
v_cvt_pk_bf16_f32 v74, v236, v237
v_cvt_pk_bf16_f32 v75, v238, v239
s_nop 1
v_mfma_f32_16x16x32_bf16 v[200:203], a[192:195], v[72:75], 0
buffer_store_dwordx4 v[72:75], v17, s[20:23], s42 offen offset:2048 sc1
v_accvgpr_read_b32 v212, a12
v_accvgpr_read_b32 v213, a13
v_accvgpr_read_b32 v214, a14
v_accvgpr_read_b32 v215, a15
v_accvgpr_read_b32 v1, a28
v_accvgpr_read_b32 v2, a29
v_accvgpr_read_b32 v3, a30
v_accvgpr_read_b32 v4, a31
v_mul_f32 v212, v211, v212
v_mul_f32 v213, v211, v213
v_mul_f32 v214, v211, v214
v_mul_f32 v215, v211, v215
v_mul_f32 v1, v211, v1
v_mul_f32 v2, v211, v2
v_mul_f32 v3, v211, v3
v_mul_f32 v4, v211, v4
v_cvt_pk_bf16_f32 v76, v212, v213
v_cvt_pk_bf16_f32 v77, v214, v215
v_cvt_pk_bf16_f32 v78, v1, v2
v_cvt_pk_bf16_f32 v79, v3, v4
s_nop 1
v_mfma_f32_16x16x32_bf16 v[204:207], a[192:195], v[76:79], 0
ds_read_b64_tr_b16 a[192:193], v29 offset:0
v_accvgpr_read_b32 v232, a32
v_mfma_f32_16x16x32_bf16 v[252:255], a[196:199], v[76:79], 0
ds_read_b64_tr_b16 a[194:195], v29 offset:6144
v_accvgpr_read_b32 v233, a33
buffer_store_dwordx4 v[76:79], v20, s[20:23], s42 offen offset:3072 sc1
v_mfma_f32_16x16x32_bf16 v[248:251], a[196:199], v[72:75], 0
v_accvgpr_read_b32 v234, a34
v_accvgpr_read_b32 v235, a35
v_mfma_f32_16x16x32_bf16 v[244:247], a[196:199], v[68:71], 0
v_accvgpr_read_b32 v236, a48
v_accvgpr_read_b32 v237, a49
v_mfma_f32_16x16x32_bf16 v[240:243], a[196:199], v[64:67], 0
ds_read_b64_tr_b16 a[196:197], v29 offset:8
v_accvgpr_read_b32 v238, a50
v_mfma_f32_16x16x32_bf16 a[240:243], a[200:203], v[64:67], 0
ds_read_b64_tr_b16 a[198:199], v29 offset:6152
v_accvgpr_read_b32 v239, a51
v_mfma_f32_16x16x32_bf16 a[244:247], a[200:203], v[68:71], 0
v_mul_f32 v232, v208, v232
v_mul_f32 v233, v208, v233
v_mfma_f32_16x16x32_bf16 a[248:251], a[200:203], v[72:75], 0
v_mul_f32 v234, v208, v234
v_mul_f32 v235, v208, v235
v_mfma_f32_16x16x32_bf16 a[252:255], a[200:203], v[76:79], 0
ds_read_b64_tr_b16 a[200:201], v28 offset:128
v_mul_f32 v236, v208, v236
v_mfma_f32_16x16x32_bf16 v[172:175], a[204:207], v[76:79], 0
ds_read_b64_tr_b16 a[202:203], v28 offset:6272
v_mul_f32 v237, v208, v237
v_mfma_f32_16x16x32_bf16 v[168:171], a[204:207], v[72:75], 0
v_mul_f32 v238, v208, v238
v_mul_f32 v239, v208, v239
v_mfma_f32_16x16x32_bf16 v[164:167], a[204:207], v[68:71], 0
v_cvt_pk_bf16_f32 v80, v232, v233
v_cvt_pk_bf16_f32 v81, v234, v235
v_mfma_f32_16x16x32_bf16 v[160:163], a[204:207], v[64:67], 0
ds_read_b64_tr_b16 a[204:205], v28 offset:136
v_cvt_pk_bf16_f32 v82, v236, v237
v_mfma_f32_16x16x32_bf16 v[32:35], a[208:211], v[64:67], 0
ds_read_b64_tr_b16 a[206:207], v28 offset:6280
v_cvt_pk_bf16_f32 v83, v238, v239
v_mfma_f32_16x16x32_bf16 v[36:39], a[208:211], v[68:71], 0
buffer_store_dwordx4 v[80:83], v17, s[20:23], s43 offen offset:0 sc1
v_mfma_f32_16x16x32_bf16 v[40:43], a[208:211], v[72:75], 0
v_accvgpr_read_b32 v212, a36
v_accvgpr_read_b32 v213, a37
v_mfma_f32_16x16x32_bf16 v[44:47], a[208:211], v[76:79], 0
ds_read_b64_tr_b16 a[208:209], v29 offset:128
v_accvgpr_read_b32 v214, a38
v_mfma_f32_16x16x32_bf16 v[60:63], a[212:215], v[76:79], 0
ds_read_b64_tr_b16 a[210:211], v29 offset:6272
v_accvgpr_read_b32 v215, a39
v_mfma_f32_16x16x32_bf16 v[56:59], a[212:215], v[72:75], 0
v_accvgpr_read_b32 v1, a52
v_accvgpr_read_b32 v2, a53
v_mfma_f32_16x16x32_bf16 v[52:55], a[212:215], v[68:71], 0
v_accvgpr_read_b32 v3, a54
v_accvgpr_read_b32 v4, a55
v_mfma_f32_16x16x32_bf16 v[48:51], a[212:215], v[64:67], 0
ds_read_b64_tr_b16 a[212:213], v29 offset:136
v_mul_f32 v212, v209, v212
v_mfma_f32_16x16x32_bf16 v[176:179], a[216:219], v[64:67], 0
ds_read_b64_tr_b16 a[214:215], v29 offset:6280
v_mul_f32 v213, v209, v213
v_mfma_f32_16x16x32_bf16 v[180:183], a[216:219], v[68:71], 0
v_mul_f32 v214, v209, v214
v_mul_f32 v215, v209, v215
v_mfma_f32_16x16x32_bf16 v[184:187], a[216:219], v[72:75], 0
v_mul_f32 v1, v209, v1
v_mul_f32 v2, v209, v2
v_mfma_f32_16x16x32_bf16 v[188:191], a[216:219], v[76:79], 0
ds_read_b64_tr_b16 a[216:217], v28 offset:256
v_mul_f32 v3, v209, v3
v_mfma_f32_16x16x32_bf16 a[12:15], a[220:223], v[76:79], 0
ds_read_b64_tr_b16 a[218:219], v28 offset:6400
v_mul_f32 v4, v209, v4
v_mfma_f32_16x16x32_bf16 a[8:11], a[220:223], v[72:75], 0
v_cvt_pk_bf16_f32 v84, v212, v213
v_cvt_pk_bf16_f32 v85, v214, v215
v_mfma_f32_16x16x32_bf16 a[4:7], a[220:223], v[68:71], 0
v_cvt_pk_bf16_f32 v86, v1, v2
v_cvt_pk_bf16_f32 v87, v3, v4
v_mfma_f32_16x16x32_bf16 a[0:3], a[220:223], v[64:67], 0
s_waitcnt lgkmcnt(2)
ds_read_b64_tr_b16 a[220:221], v28 offset:264
v_accvgpr_read_b32 v232, a40
v_mfma_f32_16x16x32_bf16 a[16:19], a[224:227], v[64:67], 0
ds_read_b64_tr_b16 a[222:223], v28 offset:6408
v_accvgpr_read_b32 v233, a41
v_mfma_f32_16x16x32_bf16 a[20:23], a[224:227], v[68:71], 0
buffer_store_dwordx4 v[84:87], v17, s[20:23], s43 offen offset:1024 sc1
v_mfma_f32_16x16x32_bf16 a[24:27], a[224:227], v[72:75], 0
v_accvgpr_read_b32 v234, a42
v_accvgpr_read_b32 v235, a43
v_mfma_f32_16x16x32_bf16 a[28:31], a[224:227], v[76:79], 0
v_accvgpr_read_b32 v236, a56
v_accvgpr_read_b32 v237, a57
v_mfma_f32_16x16x32_bf16 v[228:231], a[228:231], v[76:79], 0
v_accvgpr_read_b32 v238, a58
v_accvgpr_read_b32 v239, a59
v_mfma_f32_16x16x32_bf16 v[224:227], a[228:231], v[72:75], 0
v_mul_f32 v232, v210, v232
v_mul_f32 v233, v210, v233
v_mfma_f32_16x16x32_bf16 v[220:223], a[228:231], v[68:71], 0
v_mul_f32 v234, v210, v234
v_mul_f32 v235, v210, v235
v_mfma_f32_16x16x32_bf16 v[216:219], a[228:231], v[64:67], 0
v_mov_b32 v12, 1
v_mul_f32 v236, v210, v236
v_mfma_f32_16x16x32_bf16 v[192:195], a[232:235], v[80:83], v[192:195]
v_mul_f32 v237, v210, v237
v_mul_f32 v238, v210, v238
v_mfma_f32_16x16x32_bf16 v[196:199], a[232:235], v[84:87], v[196:199]
v_mul_f32 v239, v210, v239
v_cvt_pk_bf16_f32 v88, v232, v233
v_cvt_pk_bf16_f32 v89, v234, v235
v_cvt_pk_bf16_f32 v90, v236, v237
v_cvt_pk_bf16_f32 v91, v238, v239
s_nop 1
v_mfma_f32_16x16x32_bf16 v[200:203], a[232:235], v[88:91], v[200:203]
buffer_store_dwordx4 v[88:91], v17, s[20:23], s43 offen offset:2048 sc1
v_accvgpr_read_b32 v212, a44
v_accvgpr_read_b32 v213, a45
v_accvgpr_read_b32 v214, a46
v_accvgpr_read_b32 v215, a47
v_accvgpr_read_b32 v1, a60
v_accvgpr_read_b32 v2, a61
v_accvgpr_read_b32 v3, a62
v_accvgpr_read_b32 v4, a63
v_mul_f32 v212, v211, v212
v_mul_f32 v213, v211, v213
v_mul_f32 v214, v211, v214
v_mul_f32 v215, v211, v215
v_mul_f32 v1, v211, v1
v_mul_f32 v2, v211, v2
v_mul_f32 v3, v211, v3
v_mul_f32 v4, v211, v4
v_cvt_pk_bf16_f32 v92, v212, v213
v_cvt_pk_bf16_f32 v93, v214, v215
v_cvt_pk_bf16_f32 v94, v1, v2
v_cvt_pk_bf16_f32 v95, v3, v4
s_nop 1
v_mfma_f32_16x16x32_bf16 v[204:207], a[232:235], v[92:95], v[204:207]
s_waitcnt vmcnt(3) lgkmcnt(0)
buffer_store_dwordx4 v[92:95], v20, s[20:23], s43 offen offset:3072 sc1
v_mfma_f32_16x16x32_bf16 v[252:255], a[236:239], v[92:95], v[252:255]
s_barrier
v_accvgpr_read_b32 v232, a64
v_accvgpr_read_b32 v233, a65
v_mfma_f32_16x16x32_bf16 v[248:251], a[236:239], v[88:91], v[248:251]
buffer_store_dword v12, v30, s[72:75], 0 offen sc1
v_mfma_f32_16x16x32_bf16 v[244:247], a[236:239], v[84:87], v[244:247]
ds_read_b64_tr_b16 a[224:225], v28 offset:12288
v_accvgpr_read_b32 v234, a66
v_mfma_f32_16x16x32_bf16 v[240:243], a[236:239], v[80:83], v[240:243]
s_add_u32 s88, s82, 40960
ds_read_b64_tr_b16 a[226:227], v28 offset:18432
v_accvgpr_read_b32 v235, a67
v_mfma_f32_16x16x32_bf16 a[240:243], a[192:195], v[80:83], a[240:243]
s_add_u32 m0, s26, 36864
ds_read_b64_tr_b16 a[228:229], v28 offset:12296
v_accvgpr_read_b32 v236, a80
v_mfma_f32_16x16x32_bf16 a[244:247], a[192:195], v[84:87], a[244:247]
buffer_load_dwordx4 v23, s[64:67], s88 offen offset:0 lds
v_mfma_f32_16x16x32_bf16 a[248:251], a[192:195], v[88:91], a[248:251]
ds_read_b64_tr_b16 a[230:231], v28 offset:18440
v_accvgpr_read_b32 v237, a81
v_mfma_f32_16x16x32_bf16 a[252:255], a[192:195], v[92:95], a[252:255]
ds_read_b64_tr_b16 a[232:233], v29 offset:12288
v_accvgpr_read_b32 v238, a82
v_mfma_f32_16x16x32_bf16 v[172:175], a[196:199], v[92:95], v[172:175]
ds_read_b64_tr_b16 a[234:235], v29 offset:18432
v_accvgpr_read_b32 v239, a83
v_mfma_f32_16x16x32_bf16 v[168:171], a[196:199], v[88:91], v[168:171]
buffer_load_dwordx4 v24, s[64:67], s88 offen offset:1024 lds
v_mfma_f32_16x16x32_bf16 v[164:167], a[196:199], v[84:87], v[164:167]
ds_read_b64_tr_b16 a[236:237], v29 offset:12296
v_mul_f32 v232, v208, v232
v_mfma_f32_16x16x32_bf16 v[160:163], a[196:199], v[80:83], v[160:163]
ds_read_b64_tr_b16 a[238:239], v29 offset:18440
v_mul_f32 v233, v208, v233
v_mfma_f32_16x16x32_bf16 v[32:35], a[200:203], v[80:83], v[32:35]
ds_read_b64_tr_b16 a[192:193], v28 offset:12416
v_mul_f32 v234, v208, v234
v_mfma_f32_16x16x32_bf16 v[36:39], a[200:203], v[84:87], v[36:39]
buffer_load_dwordx4 v25, s[64:67], s88 offen offset:2048 lds
v_mfma_f32_16x16x32_bf16 v[40:43], a[200:203], v[88:91], v[40:43]
ds_read_b64_tr_b16 a[194:195], v28 offset:18560
v_mul_f32 v235, v208, v235
v_mfma_f32_16x16x32_bf16 v[44:47], a[200:203], v[92:95], v[44:47]
ds_read_b64_tr_b16 a[196:197], v28 offset:12424
v_mul_f32 v236, v208, v236
v_mfma_f32_16x16x32_bf16 v[60:63], a[204:207], v[92:95], v[60:63]
ds_read_b64_tr_b16 a[198:199], v28 offset:18568
v_mul_f32 v237, v208, v237
v_mfma_f32_16x16x32_bf16 v[56:59], a[204:207], v[88:91], v[56:59]
s_add_u32 s88, s82, 81920
ds_read_b64_tr_b16 a[200:201], v29 offset:12416
v_mul_f32 v238, v208, v238
v_mfma_f32_16x16x32_bf16 v[52:55], a[204:207], v[84:87], v[52:55]
s_add_u32 m0, s25, 24576
ds_read_b64_tr_b16 a[202:203], v29 offset:18560
v_mul_f32 v239, v208, v239
v_mfma_f32_16x16x32_bf16 v[48:51], a[204:207], v[80:83], v[48:51]
buffer_load_dwordx4 v23, s[64:67], s88 offen offset:0 lds
v_mfma_f32_16x16x32_bf16 v[176:179], a[208:211], v[80:83], v[176:179]
ds_read_b64_tr_b16 a[204:205], v29 offset:12424
v_cvt_pk_bf16_f32 v96, v232, v233
v_mfma_f32_16x16x32_bf16 v[180:183], a[208:211], v[84:87], v[180:183]
ds_read_b64_tr_b16 a[206:207], v29 offset:18568
v_cvt_pk_bf16_f32 v97, v234, v235
v_mfma_f32_16x16x32_bf16 v[184:187], a[208:211], v[88:91], v[184:187]
v_cvt_pk_bf16_f32 v98, v236, v237
v_cvt_pk_bf16_f32 v99, v238, v239
v_mfma_f32_16x16x32_bf16 v[188:191], a[208:211], v[92:95], v[188:191]
buffer_load_dwordx4 v24, s[64:67], s88 offen offset:1024 lds
v_mfma_f32_16x16x32_bf16 a[12:15], a[212:215], v[92:95], a[12:15]
ds_read_b64_tr_b16 a[208:209], v28 offset:12544
v_accvgpr_read_b32 v212, a68
v_mfma_f32_16x16x32_bf16 a[8:11], a[212:215], v[88:91], a[8:11]
ds_read_b64_tr_b16 a[210:211], v28 offset:18688
v_accvgpr_read_b32 v213, a69
v_mfma_f32_16x16x32_bf16 a[4:7], a[212:215], v[84:87], a[4:7]
buffer_store_dwordx4 v[96:99], v17, s[20:23], s44 offen offset:0 sc1
v_mfma_f32_16x16x32_bf16 a[0:3], a[212:215], v[80:83], a[0:3]
buffer_load_dwordx4 v25, s[64:67], s88 offen offset:2048 lds
v_mfma_f32_16x16x32_bf16 a[16:19], a[216:219], v[80:83], a[16:19]
ds_read_b64_tr_b16 a[212:213], v28 offset:12552
v_accvgpr_read_b32 v214, a70
v_mfma_f32_16x16x32_bf16 a[20:23], a[216:219], v[84:87], a[20:23]
ds_read_b64_tr_b16 a[214:215], v28 offset:18696
v_accvgpr_read_b32 v215, a71
v_mfma_f32_16x16x32_bf16 a[24:27], a[216:219], v[88:91], a[24:27]
v_accvgpr_read_b32 v1, a84
v_accvgpr_read_b32 v2, a85
v_mfma_f32_16x16x32_bf16 a[28:31], a[216:219], v[92:95], a[28:31]
s_add_u32 s88, s83, 40960
ds_read_b64_tr_b16 a[216:217], v28 offset:24576
v_accvgpr_read_b32 v3, a86
v_mfma_f32_16x16x32_bf16 v[228:231], a[220:223], v[92:95], v[228:231]
s_add_u32 m0, s25, 36864
ds_read_b64_tr_b16 a[218:219], v28 offset:30720
v_accvgpr_read_b32 v4, a87
v_mfma_f32_16x16x32_bf16 v[224:227], a[220:223], v[88:91], v[224:227]
buffer_load_dwordx4 v23, s[64:67], s88 offen offset:0 lds
v_mfma_f32_16x16x32_bf16 v[220:223], a[220:223], v[84:87], v[220:223]
v_mul_f32 v212, v209, v212
v_mul_f32 v213, v209, v213
v_mfma_f32_16x16x32_bf16 v[216:219], a[220:223], v[80:83], v[216:219]
s_waitcnt lgkmcnt(2)
ds_read_b64_tr_b16 a[220:221], v28 offset:24584
v_mul_f32 v214, v209, v214
v_mfma_f32_16x16x32_bf16 v[192:195], a[224:227], v[96:99], v[192:195]
ds_read_b64_tr_b16 a[222:223], v28 offset:30728
v_mul_f32 v215, v209, v215
v_mul_f32 v1, v209, v1
v_mul_f32 v2, v209, v2
v_mul_f32 v3, v209, v3
v_mul_f32 v4, v209, v4
v_cvt_pk_bf16_f32 v100, v212, v213
v_cvt_pk_bf16_f32 v101, v214, v215
v_cvt_pk_bf16_f32 v102, v1, v2
v_cvt_pk_bf16_f32 v103, v3, v4
s_nop 1
v_mfma_f32_16x16x32_bf16 v[196:199], a[224:227], v[100:103], v[196:199]
buffer_load_dwordx4 v24, s[64:67], s88 offen offset:1024 lds
v_accvgpr_read_b32 v232, a72
v_accvgpr_read_b32 v233, a73
v_accvgpr_read_b32 v234, a74
v_accvgpr_read_b32 v235, a75
v_accvgpr_read_b32 v236, a88
v_accvgpr_read_b32 v237, a89
v_accvgpr_read_b32 v238, a90
v_accvgpr_read_b32 v239, a91
v_mul_f32 v232, v210, v232
v_mul_f32 v233, v210, v233
v_mul_f32 v234, v210, v234
v_mul_f32 v235, v210, v235
v_mul_f32 v236, v210, v236
v_mul_f32 v237, v210, v237
v_mul_f32 v238, v210, v238
v_mul_f32 v239, v210, v239
v_cvt_pk_bf16_f32 v104, v232, v233
v_cvt_pk_bf16_f32 v105, v234, v235
v_cvt_pk_bf16_f32 v106, v236, v237
v_cvt_pk_bf16_f32 v107, v238, v239
s_nop 1
v_mfma_f32_16x16x32_bf16 v[200:203], a[224:227], v[104:107], v[200:203]
buffer_store_dwordx4 v[100:103], v17, s[20:23], s44 offen offset:1024 sc1
v_accvgpr_read_b32 v212, a76
v_accvgpr_read_b32 v213, a77
v_accvgpr_read_b32 v214, a78
v_accvgpr_read_b32 v215, a79
v_accvgpr_read_b32 v1, a92
v_accvgpr_read_b32 v2, a93
v_accvgpr_read_b32 v3, a94
v_accvgpr_read_b32 v4, a95
v_mul_f32 v212, v211, v212
v_mul_f32 v213, v211, v213
v_mul_f32 v214, v211, v214
v_mul_f32 v215, v211, v215
v_mul_f32 v1, v211, v1
v_mul_f32 v2, v211, v2
v_mul_f32 v3, v211, v3
v_mul_f32 v4, v211, v4
v_cvt_pk_bf16_f32 v108, v212, v213
v_cvt_pk_bf16_f32 v109, v214, v215
v_cvt_pk_bf16_f32 v110, v1, v2
v_cvt_pk_bf16_f32 v111, v3, v4
s_nop 1
v_mfma_f32_16x16x32_bf16 v[204:207], a[224:227], v[108:111], v[204:207]
ds_read_b64_tr_b16 a[224:225], v29 offset:24576
v_accvgpr_read_b32 v232, a96
buffer_store_dwordx4 v[104:107], v17, s[20:23], s44 offen offset:2048 sc1
v_mfma_f32_16x16x32_bf16 v[252:255], a[228:231], v[108:111], v[252:255]
ds_read_b64_tr_b16 a[226:227], v29 offset:30720
v_accvgpr_read_b32 v233, a97
buffer_store_dwordx4 v[108:111], v20, s[20:23], s44 offen offset:3072 sc1
v_mfma_f32_16x16x32_bf16 v[248:251], a[228:231], v[104:107], v[248:251]
buffer_load_dwordx4 v25, s[64:67], s88 offen offset:2048 lds
v_mfma_f32_16x16x32_bf16 v[244:247], a[228:231], v[100:103], v[244:247]
v_accvgpr_read_b32 v234, a98
v_accvgpr_read_b32 v235, a99
v_mfma_f32_16x16x32_bf16 v[240:243], a[228:231], v[96:99], v[240:243]
ds_read_b64_tr_b16 a[228:229], v29 offset:24584
v_accvgpr_read_b32 v236, a112
v_mfma_f32_16x16x32_bf16 a[240:243], a[232:235], v[96:99], a[240:243]
ds_read_b64_tr_b16 a[230:231], v29 offset:30728
v_accvgpr_read_b32 v237, a113
v_mfma_f32_16x16x32_bf16 a[244:247], a[232:235], v[100:103], a[244:247]
v_accvgpr_read_b32 v238, a114
v_accvgpr_read_b32 v239, a115
v_mfma_f32_16x16x32_bf16 a[248:251], a[232:235], v[104:107], a[248:251]
v_mul_f32 v232, v208, v232
v_mul_f32 v233, v208, v233
v_mfma_f32_16x16x32_bf16 a[252:255], a[232:235], v[108:111], a[252:255]
ds_read_b64_tr_b16 a[232:233], v28 offset:24704
v_mul_f32 v234, v208, v234
v_mfma_f32_16x16x32_bf16 v[172:175], a[236:239], v[108:111], v[172:175]
ds_read_b64_tr_b16 a[234:235], v28 offset:30848
v_mul_f32 v235, v208, v235
v_mfma_f32_16x16x32_bf16 v[168:171], a[236:239], v[104:107], v[168:171]
v_mul_f32 v236, v208, v236
v_mul_f32 v237, v208, v237
v_mfma_f32_16x16x32_bf16 v[164:167], a[236:239], v[100:103], v[164:167]
v_mul_f32 v238, v208, v238
v_mul_f32 v239, v208, v239
v_mfma_f32_16x16x32_bf16 v[160:163], a[236:239], v[96:99], v[160:163]
ds_read_b64_tr_b16 a[236:237], v28 offset:24712
v_cvt_pk_bf16_f32 v112, v232, v233
v_mfma_f32_16x16x32_bf16 v[32:35], a[192:195], v[96:99], v[32:35]
ds_read_b64_tr_b16 a[238:239], v28 offset:30856
v_cvt_pk_bf16_f32 v113, v234, v235
v_mfma_f32_16x16x32_bf16 v[36:39], a[192:195], v[100:103], v[36:39]
v_cvt_pk_bf16_f32 v114, v236, v237
v_cvt_pk_bf16_f32 v115, v238, v239
v_mfma_f32_16x16x32_bf16 v[40:43], a[192:195], v[104:107], v[40:43]
buffer_store_dwordx4 v[112:115], v17, s[20:23], s45 offen offset:0 sc1
v_mfma_f32_16x16x32_bf16 v[44:47], a[192:195], v[108:111], v[44:47]
ds_read_b64_tr_b16 a[192:193], v29 offset:24704
v_accvgpr_read_b32 v212, a100
v_mfma_f32_16x16x32_bf16 v[60:63], a[196:199], v[108:111], v[60:63]
ds_read_b64_tr_b16 a[194:195], v29 offset:30848
v_accvgpr_read_b32 v213, a101
v_mfma_f32_16x16x32_bf16 v[56:59], a[196:199], v[104:107], v[56:59]
v_accvgpr_read_b32 v214, a102
v_accvgpr_read_b32 v215, a103
v_mfma_f32_16x16x32_bf16 v[52:55], a[196:199], v[100:103], v[52:55]
v_accvgpr_read_b32 v1, a116
v_accvgpr_read_b32 v2, a117
v_mfma_f32_16x16x32_bf16 v[48:51], a[196:199], v[96:99], v[48:51]
ds_read_b64_tr_b16 a[196:197], v29 offset:24712
v_accvgpr_read_b32 v3, a118
v_mfma_f32_16x16x32_bf16 v[176:179], a[200:203], v[96:99], v[176:179]
ds_read_b64_tr_b16 a[198:199], v29 offset:30856
v_accvgpr_read_b32 v4, a119
v_mfma_f32_16x16x32_bf16 v[180:183], a[200:203], v[100:103], v[180:183]
v_mul_f32 v212, v209, v212
v_mul_f32 v213, v209, v213
v_mfma_f32_16x16x32_bf16 v[184:187], a[200:203], v[104:107], v[184:187]
v_mul_f32 v214, v209, v214
v_mul_f32 v215, v209, v215
v_mfma_f32_16x16x32_bf16 v[188:191], a[200:203], v[108:111], v[188:191]
ds_read_b64_tr_b16 a[200:201], v28 offset:24832
v_mul_f32 v1, v209, v1
v_mfma_f32_16x16x32_bf16 a[12:15], a[204:207], v[108:111], a[12:15]
ds_read_b64_tr_b16 a[202:203], v28 offset:30976
v_mul_f32 v2, v209, v2
v_mfma_f32_16x16x32_bf16 a[8:11], a[204:207], v[104:107], a[8:11]
v_mul_f32 v3, v209, v3
v_mul_f32 v4, v209, v4
v_mfma_f32_16x16x32_bf16 a[4:7], a[204:207], v[100:103], a[4:7]
v_cvt_pk_bf16_f32 v116, v212, v213
v_cvt_pk_bf16_f32 v117, v214, v215
v_mfma_f32_16x16x32_bf16 a[0:3], a[204:207], v[96:99], a[0:3]
ds_read_b64_tr_b16 a[204:205], v28 offset:24840
v_cvt_pk_bf16_f32 v118, v1, v2
v_mfma_f32_16x16x32_bf16 a[16:19], a[208:211], v[96:99], a[16:19]
ds_read_b64_tr_b16 a[206:207], v28 offset:30984
v_cvt_pk_bf16_f32 v119, v3, v4
v_mfma_f32_16x16x32_bf16 a[20:23], a[208:211], v[100:103], a[20:23]
buffer_store_dwordx4 v[116:119], v17, s[20:23], s45 offen offset:1024 sc1
v_mfma_f32_16x16x32_bf16 a[24:27], a[208:211], v[104:107], a[24:27]
v_accvgpr_read_b32 v232, a104
v_accvgpr_read_b32 v233, a105
v_mfma_f32_16x16x32_bf16 a[28:31], a[208:211], v[108:111], a[28:31]
v_accvgpr_read_b32 v234, a106
v_accvgpr_read_b32 v235, a107
v_mfma_f32_16x16x32_bf16 v[228:231], a[212:215], v[108:111], v[228:231]
v_accvgpr_read_b32 v236, a120
v_accvgpr_read_b32 v237, a121
v_mfma_f32_16x16x32_bf16 v[224:227], a[212:215], v[104:107], v[224:227]
v_accvgpr_read_b32 v238, a122
v_accvgpr_read_b32 v239, a123
v_mfma_f32_16x16x32_bf16 v[220:223], a[212:215], v[100:103], v[220:223]
v_mul_f32 v232, v210, v232
v_mul_f32 v233, v210, v233
v_mfma_f32_16x16x32_bf16 v[216:219], a[212:215], v[96:99], v[216:219]
s_waitcnt lgkmcnt(0)
v_mul_f32 v234, v210, v234
v_mul_f32 v235, v210, v235
v_mfma_f32_16x16x32_bf16 v[192:195], a[216:219], v[112:115], v[192:195]
v_mul_f32 v236, v210, v236
v_mul_f32 v237, v210, v237
v_mfma_f32_16x16x32_bf16 v[196:199], a[216:219], v[116:119], v[196:199]
v_mul_f32 v238, v210, v238
v_mul_f32 v239, v210, v239
v_cvt_pk_bf16_f32 v120, v232, v233
v_cvt_pk_bf16_f32 v121, v234, v235
v_cvt_pk_bf16_f32 v122, v236, v237
v_cvt_pk_bf16_f32 v123, v238, v239
s_nop 1
v_mfma_f32_16x16x32_bf16 v[200:203], a[216:219], v[120:123], v[200:203]
buffer_store_dwordx4 v[120:123], v17, s[20:23], s45 offen offset:2048 sc1
v_accvgpr_read_b32 v212, a108
v_accvgpr_read_b32 v213, a109
v_accvgpr_read_b32 v214, a110
v_accvgpr_read_b32 v215, a111
v_accvgpr_read_b32 v1, a124
v_accvgpr_read_b32 v2, a125
v_accvgpr_read_b32 v3, a126
v_accvgpr_read_b32 v4, a127
v_mul_f32 v212, v211, v212
v_mul_f32 v213, v211, v213
v_mul_f32 v214, v211, v214
v_mul_f32 v215, v211, v215
v_mul_f32 v1, v211, v1
v_mul_f32 v2, v211, v2
v_mul_f32 v3, v211, v3
v_mul_f32 v4, v211, v4
v_cvt_pk_bf16_f32 v124, v212, v213
v_cvt_pk_bf16_f32 v125, v214, v215
v_cvt_pk_bf16_f32 v126, v1, v2
v_cvt_pk_bf16_f32 v127, v3, v4
s_nop 1
v_mfma_f32_16x16x32_bf16 v[204:207], a[216:219], v[124:127], v[204:207]
buffer_store_dwordx4 v[124:127], v20, s[20:23], s45 offen offset:3072 sc1
v_mfma_f32_16x16x32_bf16 v[252:255], a[220:223], v[124:127], v[252:255]
s_barrier
v_accvgpr_read_b32 v232, a128
v_accvgpr_read_b32 v233, a129
v_mfma_f32_16x16x32_bf16 v[248:251], a[220:223], v[120:123], v[248:251]
ds_read_b64_tr_b16 a[208:209], v26 offset:0
v_accvgpr_read_b32 v234, a130
v_mfma_f32_16x16x32_bf16 v[244:247], a[220:223], v[116:119], v[244:247]
ds_read_b64_tr_b16 a[210:211], v26 offset:6144
v_accvgpr_read_b32 v235, a131
v_mfma_f32_16x16x32_bf16 v[240:243], a[220:223], v[112:115], v[240:243]
s_add_u32 s88, s83, 81920
ds_read_b64_tr_b16 a[212:213], v26 offset:8
v_accvgpr_read_b32 v236, a144
v_mfma_f32_16x16x32_bf16 a[240:243], a[224:227], v[112:115], a[240:243]
s_add_u32 m0, s25, 49152
ds_read_b64_tr_b16 a[214:215], v26 offset:6152
v_accvgpr_read_b32 v237, a145
v_mfma_f32_16x16x32_bf16 a[244:247], a[224:227], v[116:119], a[244:247]
buffer_load_dwordx4 v23, s[64:67], s88 offen offset:0 lds
v_mfma_f32_16x16x32_bf16 a[248:251], a[224:227], v[120:123], a[248:251]
ds_read_b64_tr_b16 a[216:217], v27 offset:0
v_accvgpr_read_b32 v238, a146
v_mfma_f32_16x16x32_bf16 a[252:255], a[224:227], v[124:127], a[252:255]
ds_read_b64_tr_b16 a[218:219], v27 offset:6144
v_accvgpr_read_b32 v239, a147
v_mfma_f32_16x16x32_bf16 v[172:175], a[228:231], v[124:127], v[172:175]
ds_read_b64_tr_b16 a[220:221], v27 offset:8
v_mul_f32 v232, v208, v232
v_mfma_f32_16x16x32_bf16 v[168:171], a[228:231], v[120:123], v[168:171]
buffer_load_dwordx4 v24, s[64:67], s88 offen offset:1024 lds
v_mfma_f32_16x16x32_bf16 v[164:167], a[228:231], v[116:119], v[164:167]
ds_read_b64_tr_b16 a[222:223], v27 offset:6152
v_mul_f32 v233, v208, v233
v_mfma_f32_16x16x32_bf16 v[160:163], a[228:231], v[112:115], v[160:163]
ds_read_b64_tr_b16 a[224:225], v26 offset:128
v_mul_f32 v234, v208, v234
v_mfma_f32_16x16x32_bf16 v[32:35], a[232:235], v[112:115], v[32:35]
ds_read_b64_tr_b16 a[226:227], v26 offset:6272
v_mul_f32 v235, v208, v235
v_mfma_f32_16x16x32_bf16 v[36:39], a[232:235], v[116:119], v[36:39]
buffer_load_dwordx4 v25, s[64:67], s88 offen offset:2048 lds
v_mfma_f32_16x16x32_bf16 v[40:43], a[232:235], v[120:123], v[40:43]
ds_read_b64_tr_b16 a[228:229], v26 offset:136
v_mul_f32 v236, v208, v236
v_mfma_f32_16x16x32_bf16 v[44:47], a[232:235], v[124:127], v[44:47]
ds_read_b64_tr_b16 a[230:231], v26 offset:6280
v_mul_f32 v237, v208, v237
v_mfma_f32_16x16x32_bf16 v[60:63], a[236:239], v[124:127], v[60:63]
ds_read_b64_tr_b16 a[232:233], v27 offset:128
v_mul_f32 v238, v208, v238
v_mfma_f32_16x16x32_bf16 v[56:59], a[236:239], v[120:123], v[56:59]
s_add_u32 s88, s81, 122880
ds_read_b64_tr_b16 a[234:235], v27 offset:6272
v_mul_f32 v239, v208, v239
v_mfma_f32_16x16x32_bf16 v[52:55], a[236:239], v[116:119], v[52:55]
s_add_u32 m0, s25, 61440
buffer_load_dwordx4 v[8:11], off, s[72:75], 0 sc1
v_mfma_f32_16x16x32_bf16 v[48:51], a[236:239], v[112:115], v[48:51]
buffer_load_dwordx4 v23, s[64:67], s88 offen offset:0 lds
v_mfma_f32_16x16x32_bf16 v[176:179], a[192:195], v[112:115], v[176:179]
ds_read_b64_tr_b16 a[236:237], v27 offset:136
v_cvt_pk_bf16_f32 v128, v232, v233
v_mfma_f32_16x16x32_bf16 v[180:183], a[192:195], v[116:119], v[180:183]
ds_read_b64_tr_b16 a[238:239], v27 offset:6280
v_cvt_pk_bf16_f32 v129, v234, v235
v_mfma_f32_16x16x32_bf16 v[184:187], a[192:195], v[120:123], v[184:187]
v_cvt_pk_bf16_f32 v130, v236, v237
v_cvt_pk_bf16_f32 v131, v238, v239
v_mfma_f32_16x16x32_bf16 v[188:191], a[192:195], v[124:127], v[188:191]
buffer_load_dwordx4 v24, s[64:67], s88 offen offset:1024 lds
v_mfma_f32_16x16x32_bf16 a[12:15], a[196:199], v[124:127], a[12:15]
ds_read_b64_tr_b16 a[192:193], v26 offset:256
v_accvgpr_read_b32 v212, a132
v_mfma_f32_16x16x32_bf16 a[8:11], a[196:199], v[120:123], a[8:11]
ds_read_b64_tr_b16 a[194:195], v26 offset:6400
v_accvgpr_read_b32 v213, a133
v_mfma_f32_16x16x32_bf16 a[4:7], a[196:199], v[116:119], a[4:7]
buffer_store_dwordx4 v[128:131], v17, s[20:23], s46 offen offset:0 sc1
v_mfma_f32_16x16x32_bf16 a[0:3], a[196:199], v[112:115], a[0:3]
buffer_load_dwordx4 v25, s[64:67], s88 offen offset:2048 lds
v_mfma_f32_16x16x32_bf16 a[16:19], a[200:203], v[112:115], a[16:19]
ds_read_b64_tr_b16 a[196:197], v26 offset:264
v_accvgpr_read_b32 v214, a134
v_mfma_f32_16x16x32_bf16 a[20:23], a[200:203], v[116:119], a[20:23]
ds_read_b64_tr_b16 a[198:199], v26 offset:6408
v_accvgpr_read_b32 v215, a135
v_mfma_f32_16x16x32_bf16 a[24:27], a[200:203], v[120:123], a[24:27]
v_accvgpr_read_b32 v1, a148
v_accvgpr_read_b32 v2, a149
v_mfma_f32_16x16x32_bf16 a[28:31], a[200:203], v[124:127], a[28:31]
ds_read_b64_tr_b16 a[200:201], v26 offset:12288
v_accvgpr_read_b32 v3, a150
v_mfma_f32_16x16x32_bf16 v[228:231], a[204:207], v[124:127], v[228:231]
ds_read_b64_tr_b16 a[202:203], v26 offset:18432
v_accvgpr_read_b32 v4, a151
v_mfma_f32_16x16x32_bf16 v[224:227], a[204:207], v[120:123], v[224:227]
v_mul_f32 v212, v209, v212
v_mul_f32 v213, v209, v213
v_mfma_f32_16x16x32_bf16 v[220:223], a[204:207], v[116:119], v[220:223]
v_mul_f32 v214, v209, v214
v_mul_f32 v215, v209, v215
v_mfma_f32_16x16x32_bf16 v[216:219], a[204:207], v[112:115], v[216:219]
s_waitcnt lgkmcnt(2)
ds_read_b64_tr_b16 a[204:205], v26 offset:12296
v_mul_f32 v1, v209, v1
v_mfma_f32_16x16x32_bf16 v[192:195], a[208:211], v[128:131], v[192:195]
ds_read_b64_tr_b16 a[206:207], v26 offset:18440
v_mul_f32 v2, v209, v2
v_mul_f32 v3, v209, v3
v_mul_f32 v4, v209, v4
v_cvt_pk_bf16_f32 v132, v212, v213
v_cvt_pk_bf16_f32 v133, v214, v215
v_cvt_pk_bf16_f32 v134, v1, v2
v_cvt_pk_bf16_f32 v135, v3, v4
s_nop 1
v_mfma_f32_16x16x32_bf16 v[196:199], a[208:211], v[132:135], v[196:199]
buffer_store_dwordx4 v[132:135], v17, s[20:23], s46 offen offset:1024 sc1
v_accvgpr_read_b32 v232, a136
v_accvgpr_read_b32 v233, a137
v_accvgpr_read_b32 v234, a138
v_accvgpr_read_b32 v235, a139
v_accvgpr_read_b32 v236, a152
v_accvgpr_read_b32 v237, a153
v_accvgpr_read_b32 v238, a154
v_accvgpr_read_b32 v239, a155
v_mul_f32 v232, v210, v232
v_mul_f32 v233, v210, v233
v_mul_f32 v234, v210, v234
v_mul_f32 v235, v210, v235
v_mul_f32 v236, v210, v236
v_mul_f32 v237, v210, v237
v_mul_f32 v238, v210, v238
v_mul_f32 v239, v210, v239
v_cvt_pk_bf16_f32 v136, v232, v233
v_cvt_pk_bf16_f32 v137, v234, v235
v_cvt_pk_bf16_f32 v138, v236, v237
v_cvt_pk_bf16_f32 v139, v238, v239
s_nop 1
v_mfma_f32_16x16x32_bf16 v[200:203], a[208:211], v[136:139], v[200:203]
buffer_store_dwordx4 v[136:139], v17, s[20:23], s46 offen offset:2048 sc1
v_accvgpr_read_b32 v212, a140
v_accvgpr_read_b32 v213, a141
v_accvgpr_read_b32 v214, a142
v_accvgpr_read_b32 v215, a143
v_accvgpr_read_b32 v1, a156
v_accvgpr_read_b32 v2, a157
v_accvgpr_read_b32 v3, a158
v_accvgpr_read_b32 v4, a159
v_mul_f32 v212, v211, v212
v_mul_f32 v213, v211, v213
v_mul_f32 v214, v211, v214
v_mul_f32 v215, v211, v215
v_mul_f32 v1, v211, v1
v_mul_f32 v2, v211, v2
v_mul_f32 v3, v211, v3
v_mul_f32 v4, v211, v4
v_cvt_pk_bf16_f32 v140, v212, v213
v_cvt_pk_bf16_f32 v141, v214, v215
v_cvt_pk_bf16_f32 v142, v1, v2
v_cvt_pk_bf16_f32 v143, v3, v4
s_nop 1
v_mfma_f32_16x16x32_bf16 v[204:207], a[208:211], v[140:143], v[204:207]
ds_read_b64_tr_b16 a[208:209], v27 offset:12288
v_accvgpr_read_b32 v232, a160
v_mfma_f32_16x16x32_bf16 v[252:255], a[212:215], v[140:143], v[252:255]
ds_read_b64_tr_b16 a[210:211], v27 offset:18432
v_accvgpr_read_b32 v233, a161
buffer_store_dwordx4 v[140:143], v20, s[20:23], s46 offen offset:3072 sc1
v_mfma_f32_16x16x32_bf16 v[248:251], a[212:215], v[136:139], v[248:251]
v_accvgpr_read_b32 v234, a162
v_accvgpr_read_b32 v235, a163
v_mfma_f32_16x16x32_bf16 v[244:247], a[212:215], v[132:135], v[244:247]
v_accvgpr_read_b32 v236, a176
v_accvgpr_read_b32 v237, a177
v_mfma_f32_16x16x32_bf16 v[240:243], a[212:215], v[128:131], v[240:243]
ds_read_b64_tr_b16 a[212:213], v27 offset:12296
v_accvgpr_read_b32 v238, a178
v_mfma_f32_16x16x32_bf16 a[240:243], a[216:219], v[128:131], a[240:243]
ds_read_b64_tr_b16 a[214:215], v27 offset:18440
v_accvgpr_read_b32 v239, a179
v_mfma_f32_16x16x32_bf16 a[244:247], a[216:219], v[132:135], a[244:247]
v_mul_f32 v232, v208, v232
v_mul_f32 v233, v208, v233
v_mfma_f32_16x16x32_bf16 a[248:251], a[216:219], v[136:139], a[248:251]
v_mul_f32 v234, v208, v234
v_mul_f32 v235, v208, v235
v_mfma_f32_16x16x32_bf16 a[252:255], a[216:219], v[140:143], a[252:255]
ds_read_b64_tr_b16 a[216:217], v26 offset:12416
v_mul_f32 v236, v208, v236
v_mfma_f32_16x16x32_bf16 v[172:175], a[220:223], v[140:143], v[172:175]
ds_read_b64_tr_b16 a[218:219], v26 offset:18560
v_mul_f32 v237, v208, v237
v_mfma_f32_16x16x32_bf16 v[168:171], a[220:223], v[136:139], v[168:171]
v_mul_f32 v238, v208, v238
v_mul_f32 v239, v208, v239
v_mfma_f32_16x16x32_bf16 v[164:167], a[220:223], v[132:135], v[164:167]
v_cvt_pk_bf16_f32 v144, v232, v233
v_cvt_pk_bf16_f32 v145, v234, v235
v_mfma_f32_16x16x32_bf16 v[160:163], a[220:223], v[128:131], v[160:163]
ds_read_b64_tr_b16 a[220:221], v26 offset:12424
v_cvt_pk_bf16_f32 v146, v236, v237
v_mfma_f32_16x16x32_bf16 v[32:35], a[224:227], v[128:131], v[32:35]
ds_read_b64_tr_b16 a[222:223], v26 offset:18568
v_cvt_pk_bf16_f32 v147, v238, v239
v_mfma_f32_16x16x32_bf16 v[36:39], a[224:227], v[132:135], v[36:39]
buffer_store_dwordx4 v[144:147], v17, s[20:23], s47 offen offset:0 sc1
v_mfma_f32_16x16x32_bf16 v[40:43], a[224:227], v[136:139], v[40:43]
v_accvgpr_read_b32 v212, a164
v_accvgpr_read_b32 v213, a165
v_mfma_f32_16x16x32_bf16 v[44:47], a[224:227], v[140:143], v[44:47]
ds_read_b64_tr_b16 a[224:225], v27 offset:12416
v_accvgpr_read_b32 v214, a166
v_mfma_f32_16x16x32_bf16 v[60:63], a[228:231], v[140:143], v[60:63]
ds_read_b64_tr_b16 a[226:227], v27 offset:18560
v_accvgpr_read_b32 v215, a167
v_mfma_f32_16x16x32_bf16 v[56:59], a[228:231], v[136:139], v[56:59]
v_accvgpr_read_b32 v1, a180
v_accvgpr_read_b32 v2, a181
v_mfma_f32_16x16x32_bf16 v[52:55], a[228:231], v[132:135], v[52:55]
v_accvgpr_read_b32 v3, a182
v_accvgpr_read_b32 v4, a183
v_mfma_f32_16x16x32_bf16 v[48:51], a[228:231], v[128:131], v[48:51]
ds_read_b64_tr_b16 a[228:229], v27 offset:12424
v_mul_f32 v212, v209, v212
v_mfma_f32_16x16x32_bf16 v[176:179], a[232:235], v[128:131], v[176:179]
ds_read_b64_tr_b16 a[230:231], v27 offset:18568
v_mul_f32 v213, v209, v213
v_mfma_f32_16x16x32_bf16 v[180:183], a[232:235], v[132:135], v[180:183]
v_mul_f32 v214, v209, v214
v_mul_f32 v215, v209, v215
v_mfma_f32_16x16x32_bf16 v[184:187], a[232:235], v[136:139], v[184:187]
v_mul_f32 v1, v209, v1
v_mul_f32 v2, v209, v2
v_mfma_f32_16x16x32_bf16 v[188:191], a[232:235], v[140:143], v[188:191]
s_waitcnt vmcnt(8)
v_min3_u32 v8, v8, v9, v10
v_min_u32 v8, v8, v11
v_mfma_f32_16x16x32_bf16 a[12:15], a[236:239], v[140:143], a[12:15]
v_cmp_gt_u32 vcc, 1, v8
v_mul_f32 v3, v209, v3
v_mfma_f32_16x16x32_bf16 a[8:11], a[236:239], v[136:139], a[8:11]
s_nop 1
s_cbranch_vccnz L1_pspin1
L1_pback1:
v_mfma_f32_16x16x32_bf16 a[4:7], a[236:239], v[132:135], a[4:7]
s_add_u32 s89, s85, 0
buffer_load_dwordx4 a[32:35], v17, s[20:23], s89 offen offset:0 sc1
v_mfma_f32_16x16x32_bf16 a[0:3], a[236:239], v[128:131], a[0:3]
ds_read_b64_tr_b16 a[232:233], v26 offset:12544
v_mul_f32 v4, v209, v4
v_mfma_f32_16x16x32_bf16 a[16:19], a[192:195], v[128:131], a[16:19]
ds_read_b64_tr_b16 a[234:235], v26 offset:18688
v_cvt_pk_bf16_f32 v148, v212, v213
v_mfma_f32_16x16x32_bf16 a[20:23], a[192:195], v[132:135], a[20:23]
buffer_load_dwordx4 a[36:39], v17, s[20:23], s89 offen offset:1024 sc1
v_mfma_f32_16x16x32_bf16 a[24:27], a[192:195], v[136:139], a[24:27]
ds_read_b64_tr_b16 a[236:237], v26 offset:12552
v_cvt_pk_bf16_f32 v149, v214, v215
v_mfma_f32_16x16x32_bf16 a[28:31], a[192:195], v[140:143], a[28:31]
ds_read_b64_tr_b16 a[238:239], v26 offset:18696
v_cvt_pk_bf16_f32 v150, v1, v2
v_mfma_f32_16x16x32_bf16 v[228:231], a[196:199], v[140:143], v[228:231]
buffer_load_dwordx4 a[40:43], v17, s[20:23], s89 offen offset:2048 sc1
v_mfma_f32_16x16x32_bf16 v[224:227], a[196:199], v[136:139], v[224:227]
v_cvt_pk_bf16_f32 v151, v3, v4
v_accvgpr_read_b32 v232, a168
v_mfma_f32_16x16x32_bf16 v[220:223], a[196:199], v[132:135], v[220:223]
buffer_store_dwordx4 v[148:151], v17, s[20:23], s47 offen offset:1024 sc1
v_mfma_f32_16x16x32_bf16 v[216:219], a[196:199], v[128:131], v[216:219]
s_waitcnt lgkmcnt(2)
v_mov_b32 v12, 2
buffer_load_dwordx4 a[44:47], v20, s[20:23], s89 offen offset:3072 sc1
v_mfma_f32_16x16x32_bf16 v[192:195], a[200:203], v[144:147], v[192:195]
v_accvgpr_read_b32 v233, a169
v_accvgpr_read_b32 v234, a170
v_mfma_f32_16x16x32_bf16 v[196:199], a[200:203], v[148:151], v[196:199]
v_accvgpr_read_b32 v235, a171
v_accvgpr_read_b32 v236, a184
v_accvgpr_read_b32 v237, a185
v_accvgpr_read_b32 v238, a186
v_accvgpr_read_b32 v239, a187
v_mul_f32 v232, v210, v232
v_mul_f32 v233, v210, v233
v_mul_f32 v234, v210, v234
v_mul_f32 v235, v210, v235
v_mul_f32 v236, v210, v236
v_mul_f32 v237, v210, v237
v_mul_f32 v238, v210, v238
v_mul_f32 v239, v210, v239
v_cvt_pk_bf16_f32 v152, v232, v233
v_cvt_pk_bf16_f32 v153, v234, v235
v_cvt_pk_bf16_f32 v154, v236, v237
v_cvt_pk_bf16_f32 v155, v238, v239
s_nop 1
v_mfma_f32_16x16x32_bf16 v[200:203], a[200:203], v[152:155], v[200:203]
buffer_store_dwordx4 v[152:155], v17, s[20:23], s47 offen offset:2048 sc1
v_accvgpr_read_b32 v212, a172
v_accvgpr_read_b32 v213, a173
v_accvgpr_read_b32 v214, a174
v_accvgpr_read_b32 v215, a175
v_accvgpr_read_b32 v1, a188
v_accvgpr_read_b32 v2, a189
v_accvgpr_read_b32 v3, a190
v_accvgpr_read_b32 v4, a191
v_mul_f32 v212, v211, v212
v_mul_f32 v213, v211, v213
v_mul_f32 v214, v211, v214
v_mul_f32 v215, v211, v215
v_mul_f32 v1, v211, v1
v_mul_f32 v2, v211, v2
v_mul_f32 v3, v211, v3
v_mul_f32 v4, v211, v4
v_cvt_pk_bf16_f32 v156, v212, v213
v_cvt_pk_bf16_f32 v157, v214, v215
v_cvt_pk_bf16_f32 v158, v1, v2
v_cvt_pk_bf16_f32 v159, v3, v4
s_nop 1
v_mfma_f32_16x16x32_bf16 v[204:207], a[200:203], v[156:159], v[204:207]
s_waitcnt lgkmcnt(0)
buffer_store_dwordx4 v[156:159], v20, s[20:23], s47 offen offset:3072 sc1
v_mfma_f32_16x16x32_bf16 v[252:255], a[204:207], v[156:159], v[252:255]
s_barrier
v_mfma_f32_16x16x32_bf16 v[248:251], a[204:207], v[152:155], v[248:251]
buffer_store_dword v12, v30, s[72:75], 0 offen sc1
v_mfma_f32_16x16x32_bf16 v[244:247], a[204:207], v[148:151], v[244:247]
s_add_u32 s89, s86, 0
buffer_load_dwordx4 a[48:51], v17, s[20:23], s89 offen offset:0 sc1
v_mfma_f32_16x16x32_bf16 v[240:243], a[204:207], v[144:147], v[240:243]
s_add_u32 s88, s81, 163840
ds_read_b64_tr_b16 a[192:193], v15 offset:12288
v_mfma_f32_16x16x32_bf16 a[240:243], a[208:211], v[144:147], a[240:243]
s_add_u32 m0, s25, 0
ds_read_b64_tr_b16 a[194:195], v15 offset:18432
v_mfma_f32_16x16x32_bf16 a[244:247], a[208:211], v[148:151], a[244:247]
buffer_load_dwordx4 v23, s[64:67], s88 offen offset:0 lds
v_mfma_f32_16x16x32_bf16 a[248:251], a[208:211], v[152:155], a[248:251]
buffer_load_dwordx4 a[52:55], v17, s[20:23], s89 offen offset:1024 sc1
v_mfma_f32_16x16x32_bf16 a[252:255], a[208:211], v[156:159], a[252:255]
ds_read_b64_tr_b16 a[196:197], v15 offset:24576
v_mfma_f32_16x16x32_bf16 v[172:175], a[212:215], v[156:159], v[172:175]
ds_read_b64_tr_b16 a[198:199], v15 offset:30720
v_mfma_f32_16x16x32_bf16 v[168:171], a[212:215], v[152:155], v[168:171]
buffer_load_dwordx4 v24, s[64:67], s88 offen offset:1024 lds
v_mfma_f32_16x16x32_bf16 v[164:167], a[212:215], v[148:151], v[164:167]
buffer_load_dwordx4 a[56:59], v17, s[20:23], s89 offen offset:2048 sc1
v_mfma_f32_16x16x32_bf16 v[160:163], a[212:215], v[144:147], v[160:163]
ds_read_b64_tr_b16 a[200:201], v15 offset:12296
v_mfma_f32_16x16x32_bf16 v[32:35], a[216:219], v[144:147], v[32:35]
ds_read_b64_tr_b16 a[202:203], v15 offset:18440
v_mfma_f32_16x16x32_bf16 v[36:39], a[216:219], v[148:151], v[36:39]
buffer_load_dwordx4 v25, s[64:67], s88 offen offset:2048 lds
v_mfma_f32_16x16x32_bf16 v[40:43], a[216:219], v[152:155], v[40:43]
buffer_load_dwordx4 a[60:63], v20, s[20:23], s89 offen offset:3072 sc1
v_mfma_f32_16x16x32_bf16 v[44:47], a[216:219], v[156:159], v[44:47]
ds_read_b64_tr_b16 a[204:205], v15 offset:24584
v_mfma_f32_16x16x32_bf16 v[60:63], a[220:223], v[156:159], v[60:63]
ds_read_b64_tr_b16 a[206:207], v15 offset:30728
v_mfma_f32_16x16x32_bf16 v[56:59], a[220:223], v[152:155], v[56:59]
s_add_u32 s88, s81, 204800
s_add_u32 s89, s87, 0
buffer_load_dwordx4 a[64:67], v17, s[20:23], s89 offen offset:0 sc1
v_mfma_f32_16x16x32_bf16 v[52:55], a[220:223], v[148:151], v[52:55]
s_add_u32 m0, s25, 12288
ds_read_b64_tr_b16 a[208:209], v16 offset:12288
v_mfma_f32_16x16x32_bf16 v[48:51], a[220:223], v[144:147], v[48:51]
buffer_load_dwordx4 v23, s[64:67], s88 offen offset:0 lds
v_mfma_f32_16x16x32_bf16 v[176:179], a[224:227], v[144:147], v[176:179]
buffer_load_dwordx4 a[68:71], v17, s[20:23], s89 offen offset:1024 sc1
v_mfma_f32_16x16x32_bf16 v[180:183], a[224:227], v[148:151], v[180:183]
ds_read_b64_tr_b16 a[210:211], v16 offset:18432
v_mfma_f32_16x16x32_bf16 v[184:187], a[224:227], v[152:155], v[184:187]
ds_read_b64_tr_b16 a[212:213], v16 offset:24576
v_mfma_f32_16x16x32_bf16 v[188:191], a[224:227], v[156:159], v[188:191]
buffer_load_dwordx4 v24, s[64:67], s88 offen offset:1024 lds
v_mfma_f32_16x16x32_bf16 a[12:15], a[228:231], v[156:159], a[12:15]
buffer_load_dwordx4 a[72:75], v17, s[20:23], s89 offen offset:2048 sc1
v_mfma_f32_16x16x32_bf16 a[8:11], a[228:231], v[152:155], a[8:11]
ds_read_b64_tr_b16 a[214:215], v16 offset:30720
v_mfma_f32_16x16x32_bf16 a[4:7], a[228:231], v[148:151], a[4:7]
ds_read_b64_tr_b16 a[216:217], v16 offset:12296
v_mfma_f32_16x16x32_bf16 a[0:3], a[228:231], v[144:147], a[0:3]
buffer_load_dwordx4 v25, s[64:67], s88 offen offset:2048 lds
v_mfma_f32_16x16x32_bf16 a[16:19], a[232:235], v[144:147], a[16:19]
buffer_load_dwordx4 a[76:79], v20, s[20:23], s89 offen offset:3072 sc1
v_mfma_f32_16x16x32_bf16 a[20:23], a[232:235], v[148:151], a[20:23]
ds_read_b64_tr_b16 a[218:219], v16 offset:18440
v_mfma_f32_16x16x32_bf16 a[24:27], a[232:235], v[152:155], a[24:27]
ds_read_b64_tr_b16 a[220:221], v16 offset:24584
v_mfma_f32_16x16x32_bf16 a[28:31], a[232:235], v[156:159], a[28:31]
ds_read_b64_tr_b16 a[222:223], v16 offset:30728
v_mfma_f32_16x16x32_bf16 v[228:231], a[236:239], v[156:159], v[228:231]
ds_read_b64_tr_b16 a[224:225], v15 offset:12416
v_mfma_f32_16x16x32_bf16 v[224:227], a[236:239], v[152:155], v[224:227]
ds_read_b64_tr_b16 a[226:227], v15 offset:18560
v_mfma_f32_16x16x32_bf16 v[220:223], a[236:239], v[148:151], v[220:223]
ds_read_b64_tr_b16 a[228:229], v15 offset:24704
v_mfma_f32_16x16x32_bf16 v[216:219], a[236:239], v[144:147], v[216:219]
s_waitcnt vmcnt(21) lgkmcnt(5)
ds_read_b64_tr_b16 a[230:231], v15 offset:30848
v_mfma_f32_16x16x32_bf16 v[192:195], a[192:195], a[32:35], v[192:195]
s_waitcnt vmcnt(13)
ds_read_b64_tr_b16 a[232:233], v15 offset:12424
v_mfma_f32_16x16x32_bf16 v[192:195], a[196:199], a[48:51], v[192:195]
ds_read_b64_tr_b16 a[234:235], v15 offset:18568
v_mfma_f32_16x16x32_bf16 v[196:199], a[192:195], a[36:39], v[196:199]
s_waitcnt vmcnt(11)
ds_read_b64_tr_b16 a[236:237], v15 offset:24712
v_mfma_f32_16x16x32_bf16 v[196:199], a[196:199], a[52:55], v[196:199]
ds_read_b64_tr_b16 a[238:239], v15 offset:30856
v_mfma_f32_16x16x32_bf16 v[200:203], a[192:195], a[40:43], v[200:203]
s_waitcnt vmcnt(9)
v_mfma_f32_16x16x32_bf16 v[200:203], a[196:199], a[56:59], v[200:203]
v_mfma_f32_16x16x32_bf16 v[204:207], a[192:195], a[44:47], v[204:207]
s_waitcnt vmcnt(7)
ds_read_b64_tr_b16 a[192:193], v16 offset:12416
v_mfma_f32_16x16x32_bf16 v[204:207], a[196:199], a[60:63], v[204:207]
ds_read_b64_tr_b16 a[194:195], v16 offset:18560
v_mfma_f32_16x16x32_bf16 v[252:255], a[200:203], a[44:47], v[252:255]
ds_read_b64_tr_b16 a[196:197], v16 offset:24704
v_mfma_f32_16x16x32_bf16 v[252:255], a[204:207], a[60:63], v[252:255]
ds_read_b64_tr_b16 a[198:199], v16 offset:30848
v_mfma_f32_16x16x32_bf16 v[248:251], a[200:203], a[40:43], v[248:251]
v_mfma_f32_16x16x32_bf16 v[248:251], a[204:207], a[56:59], v[248:251]
v_mfma_f32_16x16x32_bf16 v[244:247], a[200:203], a[36:39], v[244:247]
buffer_load_dwordx4 v[8:11], off, s[72:75], 0 sc1
v_mfma_f32_16x16x32_bf16 v[244:247], a[204:207], a[52:55], v[244:247]
v_mfma_f32_16x16x32_bf16 v[240:243], a[200:203], a[32:35], v[240:243]
ds_read_b64_tr_b16 a[200:201], v16 offset:12424
v_mfma_f32_16x16x32_bf16 v[240:243], a[204:207], a[48:51], v[240:243]
ds_read_b64_tr_b16 a[202:203], v16 offset:18568
v_mfma_f32_16x16x32_bf16 a[240:243], a[208:211], a[32:35], a[240:243]
ds_read_b64_tr_b16 a[204:205], v16 offset:24712
v_mfma_f32_16x16x32_bf16 a[240:243], a[212:215], a[48:51], a[240:243]
ds_read_b64_tr_b16 a[206:207], v16 offset:30856
v_mfma_f32_16x16x32_bf16 a[244:247], a[208:211], a[36:39], a[244:247]
v_mfma_f32_16x16x32_bf16 a[244:247], a[212:215], a[52:55], a[244:247]
v_mfma_f32_16x16x32_bf16 a[248:251], a[208:211], a[40:43], a[248:251]
v_mfma_f32_16x16x32_bf16 a[248:251], a[212:215], a[56:59], a[248:251]
v_mfma_f32_16x16x32_bf16 a[252:255], a[208:211], a[44:47], a[252:255]
ds_read_b64_tr_b16 a[208:209], v15 offset:12544
v_mfma_f32_16x16x32_bf16 a[252:255], a[212:215], a[60:63], a[252:255]
ds_read_b64_tr_b16 a[210:211], v15 offset:18688
v_mfma_f32_16x16x32_bf16 v[172:175], a[216:219], a[44:47], v[172:175]
s_waitcnt lgkmcnt(2)
ds_read_b64_tr_b16 a[212:213], v15 offset:24832
v_mfma_f32_16x16x32_bf16 v[172:175], a[220:223], a[60:63], v[172:175]
ds_read_b64_tr_b16 a[214:215], v15 offset:30976
v_mfma_f32_16x16x32_bf16 v[168:171], a[216:219], a[40:43], v[168:171]
v_mfma_f32_16x16x32_bf16 v[168:171], a[220:223], a[56:59], v[168:171]
v_mfma_f32_16x16x32_bf16 v[164:167], a[216:219], a[36:39], v[164:167]
v_mfma_f32_16x16x32_bf16 v[164:167], a[220:223], a[52:55], v[164:167]
v_mfma_f32_16x16x32_bf16 v[160:163], a[216:219], a[32:35], v[160:163]
ds_read_b64_tr_b16 a[216:217], v15 offset:12552
v_mfma_f32_16x16x32_bf16 v[160:163], a[220:223], a[48:51], v[160:163]
ds_read_b64_tr_b16 a[218:219], v15 offset:18696
v_mfma_f32_16x16x32_bf16 v[32:35], a[224:227], a[32:35], v[32:35]
ds_read_b64_tr_b16 a[220:221], v15 offset:24840
v_mfma_f32_16x16x32_bf16 v[32:35], a[228:231], a[48:51], v[32:35]
ds_read_b64_tr_b16 a[222:223], v15 offset:30984
v_mfma_f32_16x16x32_bf16 v[36:39], a[224:227], a[36:39], v[36:39]
v_mfma_f32_16x16x32_bf16 v[36:39], a[228:231], a[52:55], v[36:39]
v_mfma_f32_16x16x32_bf16 v[40:43], a[224:227], a[40:43], v[40:43]
v_mfma_f32_16x16x32_bf16 v[40:43], a[228:231], a[56:59], v[40:43]
v_mfma_f32_16x16x32_bf16 v[44:47], a[224:227], a[44:47], v[44:47]
v_mfma_f32_16x16x32_bf16 v[44:47], a[228:231], a[60:63], v[44:47]
v_mfma_f32_16x16x32_bf16 v[60:63], a[232:235], a[44:47], v[60:63]
v_mfma_f32_16x16x32_bf16 v[60:63], a[236:239], a[60:63], v[60:63]
v_mfma_f32_16x16x32_bf16 v[56:59], a[232:235], a[40:43], v[56:59]
v_mfma_f32_16x16x32_bf16 v[56:59], a[236:239], a[56:59], v[56:59]
s_waitcnt lgkmcnt(0)
v_mfma_f32_16x16x32_bf16 v[52:55], a[232:235], a[36:39], v[52:55]
s_barrier
v_mfma_f32_16x16x32_bf16 v[52:55], a[236:239], a[52:55], v[52:55]
ds_read_b64_tr_b16 a[224:225], v13 offset:0
v_mfma_f32_16x16x32_bf16 v[48:51], a[232:235], a[32:35], v[48:51]
ds_read_b64_tr_b16 a[226:227], v13 offset:6144
v_mfma_f32_16x16x32_bf16 v[48:51], a[236:239], a[48:51], v[48:51]
ds_read_b64_tr_b16 a[228:229], v13 offset:12288
v_mfma_f32_16x16x32_bf16 v[176:179], a[192:195], a[32:35], v[176:179]
ds_read_b64_tr_b16 a[230:231], v13 offset:18432
v_mfma_f32_16x16x32_bf16 v[176:179], a[196:199], a[48:51], v[176:179]
s_add_u32 s88, s82, 122880
ds_read_b64_tr_b16 a[232:233], v13 offset:8
v_mfma_f32_16x16x32_bf16 v[180:183], a[192:195], a[36:39], v[180:183]
s_add_u32 m0, s26, 49152
ds_read_b64_tr_b16 a[234:235], v13 offset:6152
v_mfma_f32_16x16x32_bf16 v[180:183], a[196:199], a[52:55], v[180:183]
buffer_load_dwordx4 v23, s[64:67], s88 offen offset:0 lds
v_mfma_f32_16x16x32_bf16 v[184:187], a[192:195], a[40:43], v[184:187]
s_waitcnt vmcnt(1)
v_min3_u32 v8, v8, v9, v10
v_min_u32 v8, v8, v11
v_mfma_f32_16x16x32_bf16 v[184:187], a[196:199], a[56:59], v[184:187]
v_cmp_gt_u32 vcc, 2, v8
v_mfma_f32_16x16x32_bf16 v[188:191], a[192:195], a[44:47], v[188:191]
s_nop 1
s_cbranch_vccnz L1_pspin2
L1_pback2:
v_mfma_f32_16x16x32_bf16 v[188:191], a[196:199], a[60:63], v[188:191]
buffer_load_dwordx4 v24, s[64:67], s88 offen offset:1024 lds
v_mfma_f32_16x16x32_bf16 a[12:15], a[200:203], a[44:47], a[12:15]
s_add_u32 s89, s85, 15360
buffer_load_dwordx4 a[80:83], v17, s[20:23], s89 offen offset:0 sc1
v_mfma_f32_16x16x32_bf16 a[12:15], a[204:207], a[60:63], a[12:15]
ds_read_b64_tr_b16 a[236:237], v13 offset:12296
v_mfma_f32_16x16x32_bf16 a[8:11], a[200:203], a[40:43], a[8:11]
ds_read_b64_tr_b16 a[238:239], v13 offset:18440
v_mfma_f32_16x16x32_bf16 a[8:11], a[204:207], a[56:59], a[8:11]
buffer_load_dwordx4 v25, s[64:67], s88 offen offset:2048 lds
v_mfma_f32_16x16x32_bf16 a[4:7], a[200:203], a[36:39], a[4:7]
buffer_load_dwordx4 a[84:87], v17, s[20:23], s89 offen offset:1024 sc1
v_mfma_f32_16x16x32_bf16 a[4:7], a[204:207], a[52:55], a[4:7]
ds_read_b64_tr_b16 a[192:193], v14 offset:0
v_mfma_f32_16x16x32_bf16 a[0:3], a[200:203], a[32:35], a[0:3]
ds_read_b64_tr_b16 a[194:195], v14 offset:6144
v_mfma_f32_16x16x32_bf16 a[0:3], a[204:207], a[48:51], a[0:3]
s_add_u32 s88, s82, 163840
buffer_load_dwordx4 a[88:91], v17, s[20:23], s89 offen offset:2048 sc1
v_mfma_f32_16x16x32_bf16 a[16:19], a[208:211], a[32:35], a[16:19]
s_add_u32 m0, s26, 61440
ds_read_b64_tr_b16 a[196:197], v14 offset:12288
v_mfma_f32_16x16x32_bf16 a[16:19], a[212:215], a[48:51], a[16:19]
buffer_load_dwordx4 v23, s[64:67], s88 offen offset:0 lds
v_mfma_f32_16x16x32_bf16 a[20:23], a[208:211], a[36:39], a[20:23]
buffer_load_dwordx4 a[92:95], v20, s[20:23], s89 offen offset:3072 sc1
v_mfma_f32_16x16x32_bf16 a[20:23], a[212:215], a[52:55], a[20:23]
ds_read_b64_tr_b16 a[198:199], v14 offset:18432
v_mfma_f32_16x16x32_bf16 a[24:27], a[208:211], a[40:43], a[24:27]
ds_read_b64_tr_b16 a[200:201], v14 offset:8
v_mfma_f32_16x16x32_bf16 a[24:27], a[212:215], a[56:59], a[24:27]
buffer_load_dwordx4 v24, s[64:67], s88 offen offset:1024 lds
v_mfma_f32_16x16x32_bf16 a[28:31], a[208:211], a[44:47], a[28:31]
s_add_u32 s89, s85, 30720
buffer_load_dwordx4 a[96:99], v17, s[20:23], s89 offen offset:0 sc1
v_mfma_f32_16x16x32_bf16 a[28:31], a[212:215], a[60:63], a[28:31]
ds_read_b64_tr_b16 a[202:203], v14 offset:6152
v_mfma_f32_16x16x32_bf16 v[228:231], a[216:219], a[44:47], v[228:231]
ds_read_b64_tr_b16 a[204:205], v14 offset:12296
v_mfma_f32_16x16x32_bf16 v[228:231], a[220:223], a[60:63], v[228:231]
buffer_load_dwordx4 v25, s[64:67], s88 offen offset:2048 lds
v_mfma_f32_16x16x32_bf16 v[224:227], a[216:219], a[40:43], v[224:227]
buffer_load_dwordx4 a[100:103], v17, s[20:23], s89 offen offset:1024 sc1
v_mfma_f32_16x16x32_bf16 v[224:227], a[220:223], a[56:59], v[224:227]
ds_read_b64_tr_b16 a[206:207], v14 offset:18440
v_mfma_f32_16x16x32_bf16 v[220:223], a[216:219], a[36:39], v[220:223]
ds_read_b64_tr_b16 a[208:209], v13 offset:128
v_mfma_f32_16x16x32_bf16 v[220:223], a[220:223], a[52:55], v[220:223]
buffer_load_dwordx4 a[104:107], v17, s[20:23], s89 offen offset:2048 sc1
v_mfma_f32_16x16x32_bf16 v[216:219], a[216:219], a[32:35], v[216:219]
ds_read_b64_tr_b16 a[210:211], v13 offset:6272
v_mfma_f32_16x16x32_bf16 v[216:219], a[220:223], a[48:51], v[216:219]
s_waitcnt lgkmcnt(3)
ds_read_b64_tr_b16 a[212:213], v13 offset:12416
v_mfma_f32_16x16x32_bf16 v[192:195], a[224:227], a[64:67], v[192:195]
s_waitcnt vmcnt(10)
buffer_load_dwordx4 a[108:111], v20, s[20:23], s89 offen offset:3072 sc1
v_mfma_f32_16x16x32_bf16 v[192:195], a[228:231], a[80:83], v[192:195]
ds_read_b64_tr_b16 a[214:215], v13 offset:18560
v_mfma_f32_16x16x32_bf16 v[196:199], a[224:227], a[68:71], v[196:199]
s_waitcnt vmcnt(9)
ds_read_b64_tr_b16 a[216:217], v13 offset:136
v_mfma_f32_16x16x32_bf16 v[196:199], a[228:231], a[84:87], v[196:199]
s_add_u32 s89, s86, 15360
buffer_load_dwordx4 a[112:115], v17, s[20:23], s89 offen offset:0 sc1
v_mfma_f32_16x16x32_bf16 v[200:203], a[224:227], a[72:75], v[200:203]
s_waitcnt vmcnt(9)
ds_read_b64_tr_b16 a[218:219], v13 offset:6280
v_mfma_f32_16x16x32_bf16 v[200:203], a[228:231], a[88:91], v[200:203]
ds_read_b64_tr_b16 a[220:221], v13 offset:12424
v_mfma_f32_16x16x32_bf16 v[204:207], a[224:227], a[76:79], v[204:207]
s_waitcnt vmcnt(7)
buffer_load_dwordx4 a[116:119], v17, s[20:23], s89 offen offset:1024 sc1
v_mfma_f32_16x16x32_bf16 v[204:207], a[228:231], a[92:95], v[204:207]
ds_read_b64_tr_b16 a[222:223], v13 offset:18568
v_mfma_f32_16x16x32_bf16 v[252:255], a[232:235], a[76:79], v[252:255]
ds_read_b64_tr_b16 a[224:225], v14 offset:128
v_mfma_f32_16x16x32_bf16 v[252:255], a[236:239], a[92:95], v[252:255]
buffer_load_dwordx4 a[120:123], v17, s[20:23], s89 offen offset:2048 sc1
v_mfma_f32_16x16x32_bf16 v[248:251], a[232:235], a[72:75], v[248:251]
ds_read_b64_tr_b16 a[226:227], v14 offset:6272
v_mfma_f32_16x16x32_bf16 v[248:251], a[236:239], a[88:91], v[248:251]
ds_read_b64_tr_b16 a[228:229], v14 offset:12416
v_mfma_f32_16x16x32_bf16 v[244:247], a[232:235], a[68:71], v[244:247]
buffer_load_dwordx4 a[124:127], v20, s[20:23], s89 offen offset:3072 sc1
v_mfma_f32_16x16x32_bf16 v[244:247], a[236:239], a[84:87], v[244:247]
ds_read_b64_tr_b16 a[230:231], v14 offset:18560
v_mfma_f32_16x16x32_bf16 v[240:243], a[232:235], a[64:67], v[240:243]
ds_read_b64_tr_b16 a[232:233], v14 offset:136
v_mfma_f32_16x16x32_bf16 v[240:243], a[236:239], a[80:83], v[240:243]
s_add_u32 s89, s86, 30720
buffer_load_dwordx4 a[128:131], v17, s[20:23], s89 offen offset:0 sc1
v_mfma_f32_16x16x32_bf16 a[240:243], a[192:195], a[64:67], a[240:243]
ds_read_b64_tr_b16 a[234:235], v14 offset:6280
v_mfma_f32_16x16x32_bf16 a[240:243], a[196:199], a[80:83], a[240:243]
ds_read_b64_tr_b16 a[236:237], v14 offset:12424
v_mfma_f32_16x16x32_bf16 a[244:247], a[192:195], a[68:71], a[244:247]
buffer_load_dwordx4 a[132:135], v17, s[20:23], s89 offen offset:1024 sc1
v_mfma_f32_16x16x32_bf16 a[244:247], a[196:199], a[84:87], a[244:247]
ds_read_b64_tr_b16 a[238:239], v14 offset:18568
v_mfma_f32_16x16x32_bf16 a[248:251], a[192:195], a[72:75], a[248:251]
v_mfma_f32_16x16x32_bf16 a[248:251], a[196:199], a[88:91], a[248:251]
buffer_load_dwordx4 a[136:139], v17, s[20:23], s89 offen offset:2048 sc1
v_mfma_f32_16x16x32_bf16 a[252:255], a[192:195], a[76:79], a[252:255]
ds_read_b64_tr_b16 a[192:193], v13 offset:256
v_mfma_f32_16x16x32_bf16 a[252:255], a[196:199], a[92:95], a[252:255]
ds_read_b64_tr_b16 a[194:195], v13 offset:6400
v_mfma_f32_16x16x32_bf16 v[172:175], a[200:203], a[76:79], v[172:175]
s_waitcnt lgkmcnt(3)
buffer_load_dwordx4 a[140:143], v20, s[20:23], s89 offen offset:3072 sc1
v_mfma_f32_16x16x32_bf16 v[172:175], a[204:207], a[92:95], v[172:175]
ds_read_b64_tr_b16 a[196:197], v13 offset:12544
v_mfma_f32_16x16x32_bf16 v[168:171], a[200:203], a[72:75], v[168:171]
ds_read_b64_tr_b16 a[198:199], v13 offset:18688
v_mfma_f32_16x16x32_bf16 v[168:171], a[204:207], a[88:91], v[168:171]
s_add_u32 s89, s87, 15360
buffer_load_dwordx4 a[144:147], v17, s[20:23], s89 offen offset:0 sc1
v_mfma_f32_16x16x32_bf16 v[164:167], a[200:203], a[68:71], v[164:167]
v_mfma_f32_16x16x32_bf16 v[164:167], a[204:207], a[84:87], v[164:167]
v_mfma_f32_16x16x32_bf16 v[160:163], a[200:203], a[64:67], v[160:163]
buffer_load_dwordx4 a[148:151], v17, s[20:23], s89 offen offset:1024 sc1
v_mfma_f32_16x16x32_bf16 v[160:163], a[204:207], a[80:83], v[160:163]
ds_read_b64_tr_b16 a[200:201], v13 offset:264
v_mfma_f32_16x16x32_bf16 v[32:35], a[208:211], a[64:67], v[32:35]
ds_read_b64_tr_b16 a[202:203], v13 offset:6408
v_mfma_f32_16x16x32_bf16 v[32:35], a[212:215], a[80:83], v[32:35]
buffer_load_dwordx4 a[152:155], v17, s[20:23], s89 offen offset:2048 sc1
v_mfma_f32_16x16x32_bf16 v[36:39], a[208:211], a[68:71], v[36:39]
ds_read_b64_tr_b16 a[204:205], v13 offset:12552
v_mfma_f32_16x16x32_bf16 v[36:39], a[212:215], a[84:87], v[36:39]
ds_read_b64_tr_b16 a[206:207], v13 offset:18696
v_mfma_f32_16x16x32_bf16 v[40:43], a[208:211], a[72:75], v[40:43]
buffer_load_dwordx4 a[156:159], v20, s[20:23], s89 offen offset:3072 sc1
v_mfma_f32_16x16x32_bf16 v[40:43], a[212:215], a[88:91], v[40:43]
v_mfma_f32_16x16x32_bf16 v[44:47], a[208:211], a[76:79], v[44:47]
v_mfma_f32_16x16x32_bf16 v[44:47], a[212:215], a[92:95], v[44:47]
v_mov_b32 v12, 3
s_add_u32 s89, s87, 30720
buffer_load_dwordx4 a[160:163], v17, s[20:23], s89 offen offset:0 sc1
v_mfma_f32_16x16x32_bf16 v[60:63], a[216:219], a[76:79], v[60:63]
v_mfma_f32_16x16x32_bf16 v[60:63], a[220:223], a[92:95], v[60:63]
v_mfma_f32_16x16x32_bf16 v[56:59], a[216:219], a[72:75], v[56:59]
v_mfma_f32_16x16x32_bf16 v[56:59], a[220:223], a[88:91], v[56:59]
s_waitcnt lgkmcnt(0)
v_mfma_f32_16x16x32_bf16 v[52:55], a[216:219], a[68:71], v[52:55]
s_barrier
v_mfma_f32_16x16x32_bf16 v[52:55], a[220:223], a[84:87], v[52:55]
buffer_store_dword v12, v30, s[72:75], 0 offen sc1
v_mfma_f32_16x16x32_bf16 v[48:51], a[216:219], a[64:67], v[48:51]
buffer_load_dwordx4 a[164:167], v17, s[20:23], s89 offen offset:1024 sc1
v_mfma_f32_16x16x32_bf16 v[48:51], a[220:223], a[80:83], v[48:51]
s_add_u32 s88, s82, 204800
ds_read_b64_tr_b16 a[208:209], v13 offset:24576
v_mfma_f32_16x16x32_bf16 v[176:179], a[224:227], a[64:67], v[176:179]
s_add_u32 m0, s26, 0
ds_read_b64_tr_b16 a[210:211], v13 offset:30720
v_mfma_f32_16x16x32_bf16 v[176:179], a[228:231], a[80:83], v[176:179]
buffer_load_dwordx4 v23, s[64:67], s88 offen offset:0 lds
v_mfma_f32_16x16x32_bf16 v[180:183], a[224:227], a[68:71], v[180:183]
buffer_load_dwordx4 a[168:171], v17, s[20:23], s89 offen offset:2048 sc1
v_mfma_f32_16x16x32_bf16 v[180:183], a[228:231], a[84:87], v[180:183]
ds_read_b64_tr_b16 a[212:213], v15 offset:0
v_mfma_f32_16x16x32_bf16 v[184:187], a[224:227], a[72:75], v[184:187]
ds_read_b64_tr_b16 a[214:215], v15 offset:6144
v_mfma_f32_16x16x32_bf16 v[184:187], a[228:231], a[88:91], v[184:187]
buffer_load_dwordx4 v24, s[64:67], s88 offen offset:1024 lds
v_mfma_f32_16x16x32_bf16 v[188:191], a[224:227], a[76:79], v[188:191]
buffer_load_dwordx4 a[172:175], v20, s[20:23], s89 offen offset:3072 sc1
v_mfma_f32_16x16x32_bf16 v[188:191], a[228:231], a[92:95], v[188:191]
ds_read_b64_tr_b16 a[216:217], v13 offset:24584
v_mfma_f32_16x16x32_bf16 a[12:15], a[232:235], a[76:79], a[12:15]
ds_read_b64_tr_b16 a[218:219], v13 offset:30728
v_mfma_f32_16x16x32_bf16 a[12:15], a[236:239], a[92:95], a[12:15]
buffer_load_dwordx4 v25, s[64:67], s88 offen offset:2048 lds
v_mfma_f32_16x16x32_bf16 a[8:11], a[232:235], a[72:75], a[8:11]
ds_read_b64_tr_b16 a[220:221], v15 offset:8
v_mfma_f32_16x16x32_bf16 a[8:11], a[236:239], a[88:91], a[8:11]
ds_read_b64_tr_b16 a[222:223], v15 offset:6152
v_mfma_f32_16x16x32_bf16 a[4:7], a[232:235], a[68:71], a[4:7]
ds_read_b64_tr_b16 a[224:225], v14 offset:24576
v_mfma_f32_16x16x32_bf16 a[4:7], a[236:239], a[84:87], a[4:7]
s_add_u32 s88, s83, 122880
ds_read_b64_tr_b16 a[226:227], v14 offset:30720
v_mfma_f32_16x16x32_bf16 a[0:3], a[232:235], a[64:67], a[0:3]
s_add_u32 m0, s26, 12288
ds_read_b64_tr_b16 a[228:229], v16 offset:0
v_mfma_f32_16x16x32_bf16 a[0:3], a[236:239], a[80:83], a[0:3]
buffer_load_dwordx4 v23, s[64:67], s88 offen offset:0 lds
v_mfma_f32_16x16x32_bf16 a[16:19], a[192:195], a[64:67], a[16:19]
ds_read_b64_tr_b16 a[230:231], v16 offset:6144
v_mfma_f32_16x16x32_bf16 a[16:19], a[196:199], a[80:83], a[16:19]
ds_read_b64_tr_b16 a[232:233], v14 offset:24584
v_mfma_f32_16x16x32_bf16 a[20:23], a[192:195], a[68:71], a[20:23]
ds_read_b64_tr_b16 a[234:235], v14 offset:30728
v_mfma_f32_16x16x32_bf16 a[20:23], a[196:199], a[84:87], a[20:23]
buffer_load_dwordx4 v24, s[64:67], s88 offen offset:1024 lds
v_mfma_f32_16x16x32_bf16 a[24:27], a[192:195], a[72:75], a[24:27]
ds_read_b64_tr_b16 a[236:237], v16 offset:8
v_mfma_f32_16x16x32_bf16 a[24:27], a[196:199], a[88:91], a[24:27]
ds_read_b64_tr_b16 a[238:239], v16 offset:6152
v_mfma_f32_16x16x32_bf16 a[28:31], a[192:195], a[76:79], a[28:31]
ds_read_b64_tr_b16 a[192:193], v13 offset:24704
v_mfma_f32_16x16x32_bf16 a[28:31], a[196:199], a[92:95], a[28:31]
buffer_load_dwordx4 v25, s[64:67], s88 offen offset:2048 lds
v_mfma_f32_16x16x32_bf16 v[228:231], a[200:203], a[76:79], v[228:231]
ds_read_b64_tr_b16 a[194:195], v13 offset:30848
v_mfma_f32_16x16x32_bf16 v[228:231], a[204:207], a[92:95], v[228:231]
ds_read_b64_tr_b16 a[196:197], v15 offset:128
v_mfma_f32_16x16x32_bf16 v[224:227], a[200:203], a[72:75], v[224:227]
ds_read_b64_tr_b16 a[198:199], v15 offset:6272
v_mfma_f32_16x16x32_bf16 v[224:227], a[204:207], a[88:91], v[224:227]
v_mfma_f32_16x16x32_bf16 v[220:223], a[200:203], a[68:71], v[220:223]
v_mfma_f32_16x16x32_bf16 v[220:223], a[204:207], a[84:87], v[220:223]
v_mfma_f32_16x16x32_bf16 v[216:219], a[200:203], a[64:67], v[216:219]
ds_read_b64_tr_b16 a[200:201], v13 offset:24712
v_mfma_f32_16x16x32_bf16 v[216:219], a[204:207], a[80:83], v[216:219]
s_waitcnt vmcnt(27) lgkmcnt(2)
ds_read_b64_tr_b16 a[202:203], v13 offset:30856
v_mfma_f32_16x16x32_bf16 v[192:195], a[208:211], a[96:99], v[192:195]
s_waitcnt vmcnt(22)
ds_read_b64_tr_b16 a[204:205], v15 offset:136
v_mfma_f32_16x16x32_bf16 v[192:195], a[212:215], a[112:115], v[192:195]
ds_read_b64_tr_b16 a[206:207], v15 offset:6280
v_mfma_f32_16x16x32_bf16 v[196:199], a[208:211], a[100:103], v[196:199]
s_waitcnt vmcnt(21)
v_mfma_f32_16x16x32_bf16 v[196:199], a[212:215], a[116:119], v[196:199]
v_mfma_f32_16x16x32_bf16 v[200:203], a[208:211], a[104:107], v[200:203]
s_waitcnt vmcnt(20)
v_mfma_f32_16x16x32_bf16 v[200:203], a[212:215], a[120:123], v[200:203]
v_mfma_f32_16x16x32_bf16 v[204:207], a[208:211], a[108:111], v[204:207]
s_waitcnt vmcnt(19)
ds_read_b64_tr_b16 a[208:209], v14 offset:24704
v_mfma_f32_16x16x32_bf16 v[204:207], a[212:215], a[124:127], v[204:207]
ds_read_b64_tr_b16 a[210:211], v14 offset:30848
v_mfma_f32_16x16x32_bf16 v[252:255], a[216:219], a[108:111], v[252:255]
ds_read_b64_tr_b16 a[212:213], v16 offset:128
v_mfma_f32_16x16x32_bf16 v[252:255], a[220:223], a[124:127], v[252:255]
ds_read_b64_tr_b16 a[214:215], v16 offset:6272
v_mfma_f32_16x16x32_bf16 v[248:251], a[216:219], a[104:107], v[248:251]
v_mfma_f32_16x16x32_bf16 v[248:251], a[220:223], a[120:123], v[248:251]
v_mfma_f32_16x16x32_bf16 v[244:247], a[216:219], a[100:103], v[244:247]
buffer_load_dwordx4 v[8:11], off, s[72:75], 0 sc1
v_mfma_f32_16x16x32_bf16 v[244:247], a[220:223], a[116:119], v[244:247]
v_mfma_f32_16x16x32_bf16 v[240:243], a[216:219], a[96:99], v[240:243]
ds_read_b64_tr_b16 a[216:217], v14 offset:24712
v_mfma_f32_16x16x32_bf16 v[240:243], a[220:223], a[112:115], v[240:243]
ds_read_b64_tr_b16 a[218:219], v14 offset:30856
v_mfma_f32_16x16x32_bf16 a[240:243], a[224:227], a[96:99], a[240:243]
ds_read_b64_tr_b16 a[220:221], v16 offset:136
v_mfma_f32_16x16x32_bf16 a[240:243], a[228:231], a[112:115], a[240:243]
ds_read_b64_tr_b16 a[222:223], v16 offset:6280
v_mfma_f32_16x16x32_bf16 a[244:247], a[224:227], a[100:103], a[244:247]
v_mfma_f32_16x16x32_bf16 a[244:247], a[228:231], a[116:119], a[244:247]
v_mfma_f32_16x16x32_bf16 a[248:251], a[224:227], a[104:107], a[248:251]
v_mfma_f32_16x16x32_bf16 a[248:251], a[228:231], a[120:123], a[248:251]
v_mfma_f32_16x16x32_bf16 a[252:255], a[224:227], a[108:111], a[252:255]
ds_read_b64_tr_b16 a[224:225], v13 offset:24832
v_mfma_f32_16x16x32_bf16 a[252:255], a[228:231], a[124:127], a[252:255]
ds_read_b64_tr_b16 a[226:227], v13 offset:30976
v_mfma_f32_16x16x32_bf16 v[172:175], a[232:235], a[108:111], v[172:175]
ds_read_b64_tr_b16 a[228:229], v15 offset:256
v_mfma_f32_16x16x32_bf16 v[172:175], a[236:239], a[124:127], v[172:175]
ds_read_b64_tr_b16 a[230:231], v15 offset:6400
v_mfma_f32_16x16x32_bf16 v[168:171], a[232:235], a[104:107], v[168:171]
v_mfma_f32_16x16x32_bf16 v[168:171], a[236:239], a[120:123], v[168:171]
v_mfma_f32_16x16x32_bf16 v[164:167], a[232:235], a[100:103], v[164:167]
v_mfma_f32_16x16x32_bf16 v[164:167], a[236:239], a[116:119], v[164:167]
v_mfma_f32_16x16x32_bf16 v[160:163], a[232:235], a[96:99], v[160:163]
ds_read_b64_tr_b16 a[232:233], v13 offset:24840
v_mfma_f32_16x16x32_bf16 v[160:163], a[236:239], a[112:115], v[160:163]
ds_read_b64_tr_b16 a[234:235], v13 offset:30984
v_mfma_f32_16x16x32_bf16 v[32:35], a[192:195], a[96:99], v[32:35]
s_waitcnt lgkmcnt(2)
ds_read_b64_tr_b16 a[236:237], v15 offset:264
v_mfma_f32_16x16x32_bf16 v[32:35], a[196:199], a[112:115], v[32:35]
ds_read_b64_tr_b16 a[238:239], v15 offset:6408
v_mfma_f32_16x16x32_bf16 v[36:39], a[192:195], a[100:103], v[36:39]
v_mfma_f32_16x16x32_bf16 v[36:39], a[196:199], a[116:119], v[36:39]
v_mfma_f32_16x16x32_bf16 v[40:43], a[192:195], a[104:107], v[40:43]
v_mfma_f32_16x16x32_bf16 v[40:43], a[196:199], a[120:123], v[40:43]
v_mfma_f32_16x16x32_bf16 v[44:47], a[192:195], a[108:111], v[44:47]
v_mfma_f32_16x16x32_bf16 v[44:47], a[196:199], a[124:127], v[44:47]
v_mfma_f32_16x16x32_bf16 v[60:63], a[200:203], a[108:111], v[60:63]
v_mfma_f32_16x16x32_bf16 v[60:63], a[204:207], a[124:127], v[60:63]
v_mfma_f32_16x16x32_bf16 v[56:59], a[200:203], a[104:107], v[56:59]
v_mfma_f32_16x16x32_bf16 v[56:59], a[204:207], a[120:123], v[56:59]
s_waitcnt lgkmcnt(0)
v_mfma_f32_16x16x32_bf16 v[52:55], a[200:203], a[100:103], v[52:55]
s_barrier
v_mfma_f32_16x16x32_bf16 v[52:55], a[204:207], a[116:119], v[52:55]
ds_read_b64_tr_b16 a[192:193], v26 offset:24576
v_mfma_f32_16x16x32_bf16 v[48:51], a[200:203], a[96:99], v[48:51]
ds_read_b64_tr_b16 a[194:195], v26 offset:30720
v_mfma_f32_16x16x32_bf16 v[48:51], a[204:207], a[112:115], v[48:51]
ds_read_b64_tr_b16 a[196:197], v28 offset:0
v_mfma_f32_16x16x32_bf16 v[176:179], a[208:211], a[96:99], v[176:179]
ds_read_b64_tr_b16 a[198:199], v28 offset:6144
v_mfma_f32_16x16x32_bf16 v[176:179], a[212:215], a[112:115], v[176:179]
s_add_u32 s88, s83, 163840
ds_read_b64_tr_b16 a[200:201], v26 offset:24584
v_mfma_f32_16x16x32_bf16 v[180:183], a[208:211], a[100:103], v[180:183]
s_add_u32 m0, s26, 24576
ds_read_b64_tr_b16 a[202:203], v26 offset:30728
v_mfma_f32_16x16x32_bf16 v[180:183], a[212:215], a[116:119], v[180:183]
buffer_load_dwordx4 v23, s[64:67], s88 offen offset:0 lds
v_mfma_f32_16x16x32_bf16 v[184:187], a[208:211], a[104:107], v[184:187]
s_waitcnt vmcnt(1)
v_min3_u32 v8, v8, v9, v10
v_min_u32 v8, v8, v11
v_mfma_f32_16x16x32_bf16 v[184:187], a[212:215], a[120:123], v[184:187]
v_cmp_gt_u32 vcc, 3, v8
v_mfma_f32_16x16x32_bf16 v[188:191], a[208:211], a[108:111], v[188:191]
s_nop 1
s_cbranch_vccnz L1_pspin3
L1_pback3:
v_mfma_f32_16x16x32_bf16 v[188:191], a[212:215], a[124:127], v[188:191]
buffer_load_dwordx4 v24, s[64:67], s88 offen offset:1024 lds
v_mfma_f32_16x16x32_bf16 a[12:15], a[216:219], a[108:111], a[12:15]
s_add_u32 s89, s85, 46080
buffer_load_dwordx4 a[176:179], v17, s[20:23], s89 offen offset:0 sc1
v_mfma_f32_16x16x32_bf16 a[12:15], a[220:223], a[124:127], a[12:15]
ds_read_b64_tr_b16 a[204:205], v28 offset:8
v_mfma_f32_16x16x32_bf16 a[8:11], a[216:219], a[104:107], a[8:11]
ds_read_b64_tr_b16 a[206:207], v28 offset:6152
v_mfma_f32_16x16x32_bf16 a[8:11], a[220:223], a[120:123], a[8:11]
buffer_load_dwordx4 v25, s[64:67], s88 offen offset:2048 lds
v_mfma_f32_16x16x32_bf16 a[4:7], a[216:219], a[100:103], a[4:7]
buffer_load_dwordx4 a[180:183], v17, s[20:23], s89 offen offset:1024 sc1
v_mfma_f32_16x16x32_bf16 a[4:7], a[220:223], a[116:119], a[4:7]
ds_read_b64_tr_b16 a[208:209], v27 offset:24576
v_mfma_f32_16x16x32_bf16 a[0:3], a[216:219], a[96:99], a[0:3]
ds_read_b64_tr_b16 a[210:211], v27 offset:30720
v_mfma_f32_16x16x32_bf16 a[0:3], a[220:223], a[112:115], a[0:3]
s_add_u32 s88, s83, 204800
buffer_load_dwordx4 a[184:187], v17, s[20:23], s89 offen offset:2048 sc1
v_mfma_f32_16x16x32_bf16 a[16:19], a[224:227], a[96:99], a[16:19]
s_add_u32 m0, s26, 36864
ds_read_b64_tr_b16 a[212:213], v29 offset:0
v_mfma_f32_16x16x32_bf16 a[16:19], a[228:231], a[112:115], a[16:19]
buffer_load_dwordx4 v23, s[64:67], s88 offen offset:0 lds
v_mfma_f32_16x16x32_bf16 a[20:23], a[224:227], a[100:103], a[20:23]
buffer_load_dwordx4 a[188:191], v20, s[20:23], s89 offen offset:3072 sc1
v_mfma_f32_16x16x32_bf16 a[20:23], a[228:231], a[116:119], a[20:23]
ds_read_b64_tr_b16 a[214:215], v29 offset:6144
v_mfma_f32_16x16x32_bf16 a[24:27], a[224:227], a[104:107], a[24:27]
ds_read_b64_tr_b16 a[216:217], v27 offset:24584
v_mfma_f32_16x16x32_bf16 a[24:27], a[228:231], a[120:123], a[24:27]
buffer_load_dwordx4 v24, s[64:67], s88 offen offset:1024 lds
v_mfma_f32_16x16x32_bf16 a[28:31], a[224:227], a[108:111], a[28:31]
s_add_u32 s89, s85, 61440
buffer_load_dwordx4 a[32:35], v17, s[20:23], s89 offen offset:0 sc1
v_mfma_f32_16x16x32_bf16 a[28:31], a[228:231], a[124:127], a[28:31]
ds_read_b64_tr_b16 a[218:219], v27 offset:30728
v_mfma_f32_16x16x32_bf16 v[228:231], a[232:235], a[108:111], v[228:231]
ds_read_b64_tr_b16 a[220:221], v29 offset:8
v_mfma_f32_16x16x32_bf16 v[228:231], a[236:239], a[124:127], v[228:231]
buffer_load_dwordx4 v25, s[64:67], s88 offen offset:2048 lds
v_mfma_f32_16x16x32_bf16 v[224:227], a[232:235], a[104:107], v[224:227]
buffer_load_dwordx4 a[36:39], v17, s[20:23], s89 offen offset:1024 sc1
v_mfma_f32_16x16x32_bf16 v[224:227], a[236:239], a[120:123], v[224:227]
ds_read_b64_tr_b16 a[222:223], v29 offset:6152
v_mfma_f32_16x16x32_bf16 v[220:223], a[232:235], a[100:103], v[220:223]
ds_read_b64_tr_b16 a[224:225], v26 offset:24704
v_mfma_f32_16x16x32_bf16 v[220:223], a[236:239], a[116:119], v[220:223]
buffer_load_dwordx4 a[40:43], v17, s[20:23], s89 offen offset:2048 sc1
v_mfma_f32_16x16x32_bf16 v[216:219], a[232:235], a[96:99], v[216:219]
ds_read_b64_tr_b16 a[226:227], v26 offset:30848
v_mfma_f32_16x16x32_bf16 v[216:219], a[236:239], a[112:115], v[216:219]
s_waitcnt lgkmcnt(3)
ds_read_b64_tr_b16 a[228:229], v28 offset:128
v_mfma_f32_16x16x32_bf16 v[192:195], a[192:195], a[128:131], v[192:195]
buffer_load_dwordx4 a[44:47], v20, s[20:23], s89 offen offset:3072 sc1
v_mfma_f32_16x16x32_bf16 v[192:195], a[196:199], a[144:147], v[192:195]
ds_read_b64_tr_b16 a[230:231], v28 offset:6272
v_mfma_f32_16x16x32_bf16 v[196:199], a[192:195], a[132:135], v[196:199]
ds_read_b64_tr_b16 a[232:233], v26 offset:24712
v_mfma_f32_16x16x32_bf16 v[196:199], a[196:199], a[148:151], v[196:199]
s_add_u32 s89, s85, 76800
buffer_load_dwordx4 a[48:51], v17, s[20:23], s89 offen offset:0 sc1
v_mfma_f32_16x16x32_bf16 v[200:203], a[192:195], a[136:139], v[200:203]
ds_read_b64_tr_b16 a[234:235], v26 offset:30856
v_mfma_f32_16x16x32_bf16 v[200:203], a[196:199], a[152:155], v[200:203]
ds_read_b64_tr_b16 a[236:237], v28 offset:136
v_mfma_f32_16x16x32_bf16 v[204:207], a[192:195], a[140:143], v[204:207]
buffer_load_dwordx4 a[52:55], v17, s[20:23], s89 offen offset:1024 sc1
v_mfma_f32_16x16x32_bf16 v[204:207], a[196:199], a[156:159], v[204:207]
ds_read_b64_tr_b16 a[238:239], v28 offset:6280
v_mfma_f32_16x16x32_bf16 v[252:255], a[200:203], a[140:143], v[252:255]
ds_read_b64_tr_b16 a[192:193], v27 offset:24704
v_mfma_f32_16x16x32_bf16 v[252:255], a[204:207], a[156:159], v[252:255]
buffer_load_dwordx4 a[56:59], v17, s[20:23], s89 offen offset:2048 sc1
v_mfma_f32_16x16x32_bf16 v[248:251], a[200:203], a[136:139], v[248:251]
ds_read_b64_tr_b16 a[194:195], v27 offset:30848
v_mfma_f32_16x16x32_bf16 v[248:251], a[204:207], a[152:155], v[248:251]
ds_read_b64_tr_b16 a[196:197], v29 offset:128
v_mfma_f32_16x16x32_bf16 v[244:247], a[200:203], a[132:135], v[244:247]
buffer_load_dwordx4 a[60:63], v20, s[20:23], s89 offen offset:3072 sc1
v_mfma_f32_16x16x32_bf16 v[244:247], a[204:207], a[148:151], v[244:247]
ds_read_b64_tr_b16 a[198:199], v29 offset:6272
v_mfma_f32_16x16x32_bf16 v[240:243], a[200:203], a[128:131], v[240:243]
ds_read_b64_tr_b16 a[200:201], v27 offset:24712
v_mfma_f32_16x16x32_bf16 v[240:243], a[204:207], a[144:147], v[240:243]
s_add_u32 s89, s86, 46080
buffer_load_dwordx4 a[64:67], v17, s[20:23], s89 offen offset:0 sc1
v_mfma_f32_16x16x32_bf16 a[240:243], a[208:211], a[128:131], a[240:243]
ds_read_b64_tr_b16 a[202:203], v27 offset:30856
v_mfma_f32_16x16x32_bf16 a[240:243], a[212:215], a[144:147], a[240:243]
ds_read_b64_tr_b16 a[204:205], v29 offset:136
v_mfma_f32_16x16x32_bf16 a[244:247], a[208:211], a[132:135], a[244:247]
buffer_load_dwordx4 a[68:71], v17, s[20:23], s89 offen offset:1024 sc1
v_mfma_f32_16x16x32_bf16 a[244:247], a[212:215], a[148:151], a[244:247]
ds_read_b64_tr_b16 a[206:207], v29 offset:6280
v_mfma_f32_16x16x32_bf16 a[248:251], a[208:211], a[136:139], a[248:251]
v_mfma_f32_16x16x32_bf16 a[248:251], a[212:215], a[152:155], a[248:251]
buffer_load_dwordx4 a[72:75], v17, s[20:23], s89 offen offset:2048 sc1
v_mfma_f32_16x16x32_bf16 a[252:255], a[208:211], a[140:143], a[252:255]
ds_read_b64_tr_b16 a[208:209], v26 offset:24832
v_mfma_f32_16x16x32_bf16 a[252:255], a[212:215], a[156:159], a[252:255]
ds_read_b64_tr_b16 a[210:211], v26 offset:30976
v_mfma_f32_16x16x32_bf16 v[172:175], a[216:219], a[140:143], v[172:175]
s_waitcnt lgkmcnt(3)
buffer_load_dwordx4 a[76:79], v20, s[20:23], s89 offen offset:3072 sc1
v_mfma_f32_16x16x32_bf16 v[172:175], a[220:223], a[156:159], v[172:175]
ds_read_b64_tr_b16 a[212:213], v28 offset:256
v_mfma_f32_16x16x32_bf16 v[168:171], a[216:219], a[136:139], v[168:171]
ds_read_b64_tr_b16 a[214:215], v28 offset:6400
v_mfma_f32_16x16x32_bf16 v[168:171], a[220:223], a[152:155], v[168:171]
s_add_u32 s89, s86, 61440
buffer_load_dwordx4 a[80:83], v17, s[20:23], s89 offen offset:0 sc1
v_mfma_f32_16x16x32_bf16 v[164:167], a[216:219], a[132:135], v[164:167]
v_mfma_f32_16x16x32_bf16 v[164:167], a[220:223], a[148:151], v[164:167]
v_mfma_f32_16x16x32_bf16 v[160:163], a[216:219], a[128:131], v[160:163]
buffer_load_dwordx4 a[84:87], v17, s[20:23], s89 offen offset:1024 sc1
v_mfma_f32_16x16x32_bf16 v[160:163], a[220:223], a[144:147], v[160:163]
ds_read_b64_tr_b16 a[216:217], v26 offset:24840
v_mfma_f32_16x16x32_bf16 v[32:35], a[224:227], a[128:131], v[32:35]
ds_read_b64_tr_b16 a[218:219], v26 offset:30984
v_mfma_f32_16x16x32_bf16 v[32:35], a[228:231], a[144:147], v[32:35]
buffer_load_dwordx4 a[88:91], v17, s[20:23], s89 offen offset:2048 sc1
v_mfma_f32_16x16x32_bf16 v[36:39], a[224:227], a[132:135], v[36:39]
ds_read_b64_tr_b16 a[220:221], v28 offset:264
v_mfma_f32_16x16x32_bf16 v[36:39], a[228:231], a[148:151], v[36:39]
ds_read_b64_tr_b16 a[222:223], v28 offset:6408
v_mfma_f32_16x16x32_bf16 v[40:43], a[224:227], a[136:139], v[40:43]
buffer_load_dwordx4 a[92:95], v20, s[20:23], s89 offen offset:3072 sc1
v_mfma_f32_16x16x32_bf16 v[40:43], a[228:231], a[152:155], v[40:43]
v_mfma_f32_16x16x32_bf16 v[44:47], a[224:227], a[140:143], v[44:47]
v_mfma_f32_16x16x32_bf16 v[44:47], a[228:231], a[156:159], v[44:47]
s_add_u32 s89, s86, 76800
buffer_load_dwordx4 a[96:99], v17, s[20:23], s89 offen offset:0 sc1
v_mfma_f32_16x16x32_bf16 v[60:63], a[232:235], a[140:143], v[60:63]
v_mfma_f32_16x16x32_bf16 v[60:63], a[236:239], a[156:159], v[60:63]
v_mfma_f32_16x16x32_bf16 v[56:59], a[232:235], a[136:139], v[56:59]
v_mfma_f32_16x16x32_bf16 v[56:59], a[236:239], a[152:155], v[56:59]
s_waitcnt lgkmcnt(0)
v_mfma_f32_16x16x32_bf16 v[52:55], a[232:235], a[132:135], v[52:55]
s_barrier
v_mfma_f32_16x16x32_bf16 v[52:55], a[236:239], a[148:151], v[52:55]
buffer_load_dwordx4 a[100:103], v17, s[20:23], s89 offen offset:1024 sc1
v_mfma_f32_16x16x32_bf16 v[48:51], a[232:235], a[128:131], v[48:51]
ds_read_b64_tr_b16 a[224:225], v28 offset:12288
v_mfma_f32_16x16x32_bf16 v[48:51], a[236:239], a[144:147], v[48:51]
ds_read_b64_tr_b16 a[226:227], v28 offset:18432
v_mfma_f32_16x16x32_bf16 v[176:179], a[192:195], a[128:131], v[176:179]
buffer_load_dwordx4 a[104:107], v17, s[20:23], s89 offen offset:2048 sc1
v_mfma_f32_16x16x32_bf16 v[176:179], a[196:199], a[144:147], v[176:179]
ds_read_b64_tr_b16 a[228:229], v28 offset:24576
v_mfma_f32_16x16x32_bf16 v[180:183], a[192:195], a[132:135], v[180:183]
ds_read_b64_tr_b16 a[230:231], v28 offset:30720
v_mfma_f32_16x16x32_bf16 v[180:183], a[196:199], a[148:151], v[180:183]
buffer_load_dwordx4 a[108:111], v20, s[20:23], s89 offen offset:3072 sc1
v_mfma_f32_16x16x32_bf16 v[184:187], a[192:195], a[136:139], v[184:187]
ds_read_b64_tr_b16 a[232:233], v28 offset:12296
v_mfma_f32_16x16x32_bf16 v[184:187], a[196:199], a[152:155], v[184:187]
ds_read_b64_tr_b16 a[234:235], v28 offset:18440
v_mfma_f32_16x16x32_bf16 v[188:191], a[192:195], a[140:143], v[188:191]
s_add_u32 s89, s87, 46080
buffer_load_dwordx4 a[112:115], v17, s[20:23], s89 offen offset:0 sc1
v_mfma_f32_16x16x32_bf16 v[188:191], a[196:199], a[156:159], v[188:191]
ds_read_b64_tr_b16 a[236:237], v28 offset:24584
v_mfma_f32_16x16x32_bf16 a[12:15], a[200:203], a[140:143], a[12:15]
ds_read_b64_tr_b16 a[238:239], v28 offset:30728
v_mfma_f32_16x16x32_bf16 a[12:15], a[204:207], a[156:159], a[12:15]
buffer_load_dwordx4 a[116:119], v17, s[20:23], s89 offen offset:1024 sc1
v_mfma_f32_16x16x32_bf16 a[8:11], a[200:203], a[136:139], a[8:11]
ds_read_b64_tr_b16 a[192:193], v29 offset:12288
v_mfma_f32_16x16x32_bf16 a[8:11], a[204:207], a[152:155], a[8:11]
ds_read_b64_tr_b16 a[194:195], v29 offset:18432
v_mfma_f32_16x16x32_bf16 a[4:7], a[200:203], a[132:135], a[4:7]
buffer_load_dwordx4 a[120:123], v17, s[20:23], s89 offen offset:2048 sc1
v_mfma_f32_16x16x32_bf16 a[4:7], a[204:207], a[148:151], a[4:7]
ds_read_b64_tr_b16 a[196:197], v29 offset:24576
v_mfma_f32_16x16x32_bf16 a[0:3], a[200:203], a[128:131], a[0:3]
ds_read_b64_tr_b16 a[198:199], v29 offset:30720
v_mfma_f32_16x16x32_bf16 a[0:3], a[204:207], a[144:147], a[0:3]
buffer_load_dwordx4 a[124:127], v20, s[20:23], s89 offen offset:3072 sc1
v_mfma_f32_16x16x32_bf16 a[16:19], a[208:211], a[128:131], a[16:19]
ds_read_b64_tr_b16 a[200:201], v29 offset:12296
v_mfma_f32_16x16x32_bf16 a[16:19], a[212:215], a[144:147], a[16:19]
ds_read_b64_tr_b16 a[202:203], v29 offset:18440
v_mfma_f32_16x16x32_bf16 a[20:23], a[208:211], a[132:135], a[20:23]
ds_read_b64_tr_b16 a[204:205], v29 offset:24584
v_mfma_f32_16x16x32_bf16 a[20:23], a[212:215], a[148:151], a[20:23]
ds_read_b64_tr_b16 a[206:207], v29 offset:30728
v_mfma_f32_16x16x32_bf16 a[24:27], a[208:211], a[136:139], a[24:27]
v_mfma_f32_16x16x32_bf16 a[24:27], a[212:215], a[152:155], a[24:27]
v_mfma_f32_16x16x32_bf16 a[28:31], a[208:211], a[140:143], a[28:31]
ds_read_b64_tr_b16 a[208:209], v28 offset:12416
v_mfma_f32_16x16x32_bf16 a[28:31], a[212:215], a[156:159], a[28:31]
ds_read_b64_tr_b16 a[210:211], v28 offset:18560
v_mfma_f32_16x16x32_bf16 v[228:231], a[216:219], a[140:143], v[228:231]
ds_read_b64_tr_b16 a[212:213], v28 offset:24704
v_mfma_f32_16x16x32_bf16 v[228:231], a[220:223], a[156:159], v[228:231]
ds_read_b64_tr_b16 a[214:215], v28 offset:30848
v_mfma_f32_16x16x32_bf16 v[224:227], a[216:219], a[136:139], v[224:227]
v_mfma_f32_16x16x32_bf16 v[224:227], a[220:223], a[152:155], v[224:227]
v_mfma_f32_16x16x32_bf16 v[220:223], a[216:219], a[132:135], v[220:223]
v_mfma_f32_16x16x32_bf16 v[220:223], a[220:223], a[148:151], v[220:223]
v_mfma_f32_16x16x32_bf16 v[216:219], a[216:219], a[128:131], v[216:219]
ds_read_b64_tr_b16 a[216:217], v28 offset:12424
v_mfma_f32_16x16x32_bf16 v[216:219], a[220:223], a[144:147], v[216:219]
s_waitcnt lgkmcnt(1)
s_add_u32 s89, s87, 61440
buffer_load_dwordx4 a[128:131], v17, s[20:23], s89 offen offset:0 sc1
v_mfma_f32_16x16x32_bf16 v[192:195], a[224:227], a[160:163], v[192:195]
s_waitcnt vmcnt(32)
ds_read_b64_tr_b16 a[218:219], v28 offset:18568
v_mfma_f32_16x16x32_bf16 v[192:195], a[228:231], a[176:179], v[192:195]
ds_read_b64_tr_b16 a[220:221], v28 offset:24712
v_mfma_f32_16x16x32_bf16 v[196:199], a[224:227], a[164:167], v[196:199]
s_waitcnt vmcnt(30)
buffer_load_dwordx4 a[132:135], v17, s[20:23], s89 offen offset:1024 sc1
v_mfma_f32_16x16x32_bf16 v[196:199], a[228:231], a[180:183], v[196:199]
ds_read_b64_tr_b16 a[222:223], v28 offset:30856
v_mfma_f32_16x16x32_bf16 v[200:203], a[224:227], a[168:171], v[200:203]
s_waitcnt vmcnt(30)
v_mfma_f32_16x16x32_bf16 v[200:203], a[228:231], a[184:187], v[200:203]
buffer_load_dwordx4 a[136:139], v17, s[20:23], s89 offen offset:2048 sc1
v_mfma_f32_16x16x32_bf16 v[204:207], a[224:227], a[172:175], v[204:207]
s_waitcnt vmcnt(29)
ds_read_b64_tr_b16 a[224:225], v29 offset:12416
v_mfma_f32_16x16x32_bf16 v[204:207], a[228:231], a[188:191], v[204:207]
ds_read_b64_tr_b16 a[226:227], v29 offset:18560
v_mfma_f32_16x16x32_bf16 v[252:255], a[232:235], a[172:175], v[252:255]
buffer_load_dwordx4 a[140:143], v20, s[20:23], s89 offen offset:3072 sc1
v_mfma_f32_16x16x32_bf16 v[252:255], a[236:239], a[188:191], v[252:255]
ds_read_b64_tr_b16 a[228:229], v29 offset:24704
v_mfma_f32_16x16x32_bf16 v[248:251], a[232:235], a[168:171], v[248:251]
ds_read_b64_tr_b16 a[230:231], v29 offset:30848
v_mfma_f32_16x16x32_bf16 v[248:251], a[236:239], a[184:187], v[248:251]
s_add_u32 s89, s87, 76800
buffer_load_dwordx4 a[144:147], v17, s[20:23], s89 offen offset:0 sc1
v_mfma_f32_16x16x32_bf16 v[244:247], a[232:235], a[164:167], v[244:247]
v_mfma_f32_16x16x32_bf16 v[244:247], a[236:239], a[180:183], v[244:247]
v_mfma_f32_16x16x32_bf16 v[240:243], a[232:235], a[160:163], v[240:243]
buffer_load_dwordx4 a[148:151], v17, s[20:23], s89 offen offset:1024 sc1
v_mfma_f32_16x16x32_bf16 v[240:243], a[236:239], a[176:179], v[240:243]
ds_read_b64_tr_b16 a[232:233], v29 offset:12424
v_mfma_f32_16x16x32_bf16 a[240:243], a[192:195], a[160:163], a[240:243]
ds_read_b64_tr_b16 a[234:235], v29 offset:18568
v_mfma_f32_16x16x32_bf16 a[240:243], a[196:199], a[176:179], a[240:243]
buffer_load_dwordx4 a[152:155], v17, s[20:23], s89 offen offset:2048 sc1
v_mfma_f32_16x16x32_bf16 a[244:247], a[192:195], a[164:167], a[244:247]
ds_read_b64_tr_b16 a[236:237], v29 offset:24712
v_mfma_f32_16x16x32_bf16 a[244:247], a[196:199], a[180:183], a[244:247]
ds_read_b64_tr_b16 a[238:239], v29 offset:30856
v_mfma_f32_16x16x32_bf16 a[248:251], a[192:195], a[168:171], a[248:251]
buffer_load_dwordx4 a[156:159], v20, s[20:23], s89 offen offset:3072 sc1
v_mfma_f32_16x16x32_bf16 a[248:251], a[196:199], a[184:187], a[248:251]
v_mfma_f32_16x16x32_bf16 a[252:255], a[192:195], a[172:175], a[252:255]
ds_read_b64_tr_b16 a[192:193], v28 offset:12544
v_mfma_f32_16x16x32_bf16 a[252:255], a[196:199], a[188:191], a[252:255]
ds_read_b64_tr_b16 a[194:195], v28 offset:18688
v_mfma_f32_16x16x32_bf16 v[172:175], a[200:203], a[172:175], v[172:175]
ds_read_b64_tr_b16 a[196:197], v28 offset:24832
v_mfma_f32_16x16x32_bf16 v[172:175], a[204:207], a[188:191], v[172:175]
ds_read_b64_tr_b16 a[198:199], v28 offset:30976
v_mfma_f32_16x16x32_bf16 v[168:171], a[200:203], a[168:171], v[168:171]
v_mfma_f32_16x16x32_bf16 v[168:171], a[204:207], a[184:187], v[168:171]
v_mfma_f32_16x16x32_bf16 v[164:167], a[200:203], a[164:167], v[164:167]
v_mfma_f32_16x16x32_bf16 v[164:167], a[204:207], a[180:183], v[164:167]
v_mfma_f32_16x16x32_bf16 v[160:163], a[200:203], a[160:163], v[160:163]
ds_read_b64_tr_b16 a[200:201], v28 offset:12552
v_mfma_f32_16x16x32_bf16 v[160:163], a[204:207], a[176:179], v[160:163]
ds_read_b64_tr_b16 a[202:203], v28 offset:18696
v_mfma_f32_16x16x32_bf16 v[32:35], a[208:211], a[160:163], v[32:35]
ds_read_b64_tr_b16 a[204:205], v28 offset:24840
v_mfma_f32_16x16x32_bf16 v[32:35], a[212:215], a[176:179], v[32:35]
ds_read_b64_tr_b16 a[206:207], v28 offset:30984
v_mfma_f32_16x16x32_bf16 v[36:39], a[208:211], a[164:167], v[36:39]
v_mfma_f32_16x16x32_bf16 v[36:39], a[212:215], a[180:183], v[36:39]
v_mfma_f32_16x16x32_bf16 v[40:43], a[208:211], a[168:171], v[40:43]
v_mfma_f32_16x16x32_bf16 v[40:43], a[212:215], a[184:187], v[40:43]
v_mfma_f32_16x16x32_bf16 v[44:47], a[208:211], a[172:175], v[44:47]
v_mfma_f32_16x16x32_bf16 v[44:47], a[212:215], a[188:191], v[44:47]
s_waitcnt lgkmcnt(0)
v_mfma_f32_16x16x32_bf16 v[60:63], a[216:219], a[172:175], v[60:63]
v_mfma_f32_16x16x32_bf16 v[60:63], a[220:223], a[188:191], v[60:63]
v_mfma_f32_16x16x32_bf16 v[56:59], a[216:219], a[168:171], v[56:59]
v_mfma_f32_16x16x32_bf16 v[56:59], a[220:223], a[184:187], v[56:59]
s_waitcnt vmcnt(31)
v_mfma_f32_16x16x32_bf16 v[52:55], a[216:219], a[164:167], v[52:55]
s_barrier
v_mfma_f32_16x16x32_bf16 v[52:55], a[220:223], a[180:183], v[52:55]
ds_read_b64_tr_b16 a[208:209], v26 offset:0
v_mfma_f32_16x16x32_bf16 v[48:51], a[216:219], a[160:163], v[48:51]
ds_read_b64_tr_b16 a[210:211], v26 offset:6144
v_mfma_f32_16x16x32_bf16 v[48:51], a[220:223], a[176:179], v[48:51]
ds_read_b64_tr_b16 a[212:213], v26 offset:12288
v_mfma_f32_16x16x32_bf16 v[176:179], a[224:227], a[160:163], v[176:179]
ds_read_b64_tr_b16 a[214:215], v26 offset:18432
v_mfma_f32_16x16x32_bf16 v[176:179], a[228:231], a[176:179], v[176:179]
ds_read_b64_tr_b16 a[216:217], v15 offset:12288
v_mfma_f32_16x16x32_bf16 v[180:183], a[224:227], a[164:167], v[180:183]
ds_read_b64_tr_b16 a[218:219], v15 offset:18432
v_mfma_f32_16x16x32_bf16 v[180:183], a[228:231], a[180:183], v[180:183]
ds_read_b64_tr_b16 a[220:221], v15 offset:24576
v_mfma_f32_16x16x32_bf16 v[184:187], a[224:227], a[168:171], v[184:187]
ds_read_b64_tr_b16 a[222:223], v15 offset:30720
v_mfma_f32_16x16x32_bf16 v[184:187], a[228:231], a[184:187], v[184:187]
v_mfma_f32_16x16x32_bf16 v[188:191], a[224:227], a[172:175], v[188:191]
ds_read_b64_tr_b16 a[224:225], v26 offset:8
v_mfma_f32_16x16x32_bf16 v[188:191], a[228:231], a[188:191], v[188:191]
ds_read_b64_tr_b16 a[226:227], v26 offset:6152
v_mfma_f32_16x16x32_bf16 a[12:15], a[232:235], a[172:175], a[12:15]
ds_read_b64_tr_b16 a[228:229], v26 offset:12296
v_mfma_f32_16x16x32_bf16 a[12:15], a[236:239], a[188:191], a[12:15]
ds_read_b64_tr_b16 a[230:231], v26 offset:18440
v_mfma_f32_16x16x32_bf16 a[8:11], a[232:235], a[168:171], a[8:11]
v_mfma_f32_16x16x32_bf16 a[8:11], a[236:239], a[184:187], a[8:11]
v_mfma_f32_16x16x32_bf16 a[4:7], a[232:235], a[164:167], a[4:7]
v_mfma_f32_16x16x32_bf16 a[4:7], a[236:239], a[180:183], a[4:7]
v_mfma_f32_16x16x32_bf16 a[0:3], a[232:235], a[160:163], a[0:3]
ds_read_b64_tr_b16 a[232:233], v15 offset:12296
v_mfma_f32_16x16x32_bf16 a[0:3], a[236:239], a[176:179], a[0:3]
ds_read_b64_tr_b16 a[234:235], v15 offset:18440
v_mfma_f32_16x16x32_bf16 a[16:19], a[192:195], a[160:163], a[16:19]
ds_read_b64_tr_b16 a[236:237], v15 offset:24584
v_mfma_f32_16x16x32_bf16 a[16:19], a[196:199], a[176:179], a[16:19]
ds_read_b64_tr_b16 a[238:239], v15 offset:30728
v_mfma_f32_16x16x32_bf16 a[20:23], a[192:195], a[164:167], a[20:23]
v_mfma_f32_16x16x32_bf16 a[20:23], a[196:199], a[180:183], a[20:23]
v_mfma_f32_16x16x32_bf16 a[24:27], a[192:195], a[168:171], a[24:27]
v_mfma_f32_16x16x32_bf16 a[24:27], a[196:199], a[184:187], a[24:27]
v_mfma_f32_16x16x32_bf16 a[28:31], a[192:195], a[172:175], a[28:31]
ds_read_b64_tr_b16 a[192:193], v13 offset:0
v_mfma_f32_16x16x32_bf16 a[28:31], a[196:199], a[188:191], a[28:31]
ds_read_b64_tr_b16 a[194:195], v13 offset:6144
v_mfma_f32_16x16x32_bf16 v[228:231], a[200:203], a[172:175], v[228:231]
ds_read_b64_tr_b16 a[196:197], v13 offset:12288
v_mfma_f32_16x16x32_bf16 v[228:231], a[204:207], a[188:191], v[228:231]
ds_read_b64_tr_b16 a[198:199], v13 offset:18432
v_mfma_f32_16x16x32_bf16 v[224:227], a[200:203], a[168:171], v[224:227]
v_mfma_f32_16x16x32_bf16 v[224:227], a[204:207], a[184:187], v[224:227]
v_mfma_f32_16x16x32_bf16 v[220:223], a[200:203], a[164:167], v[220:223]
v_mfma_f32_16x16x32_bf16 v[220:223], a[204:207], a[180:183], v[220:223]
v_mfma_f32_16x16x32_bf16 v[216:219], a[200:203], a[160:163], v[216:219]
ds_read_b64_tr_b16 a[200:201], v13 offset:24576
v_mfma_f32_16x16x32_bf16 v[216:219], a[204:207], a[176:179], v[216:219]
s_waitcnt lgkmcnt(1)
ds_read_b64_tr_b16 a[202:203], v13 offset:30720
v_mfma_f32_16x16x32_bf16 v[192:195], a[208:211], a[32:35], v[192:195]
s_waitcnt vmcnt(27)
ds_read_b64_tr_b16 a[204:205], v15 offset:0
v_mfma_f32_16x16x32_bf16 v[192:195], a[212:215], a[48:51], v[192:195]
s_waitcnt vmcnt(23)
ds_read_b64_tr_b16 a[206:207], v15 offset:6144
v_mfma_f32_16x16x32_bf16 v[192:195], a[216:219], a[64:67], v[192:195]
s_waitcnt vmcnt(19)
v_mfma_f32_16x16x32_bf16 v[192:195], a[220:223], a[80:83], v[192:195]
v_mfma_f32_16x16x32_bf16 v[196:199], a[208:211], a[36:39], v[196:199]
v_mfma_f32_16x16x32_bf16 v[196:199], a[212:215], a[52:55], v[196:199]
v_mfma_f32_16x16x32_bf16 v[196:199], a[216:219], a[68:71], v[196:199]
s_waitcnt vmcnt(18)
v_mfma_f32_16x16x32_bf16 v[196:199], a[220:223], a[84:87], v[196:199]
v_mfma_f32_16x16x32_bf16 v[200:203], a[208:211], a[40:43], v[200:203]
v_mfma_f32_16x16x32_bf16 v[200:203], a[212:215], a[56:59], v[200:203]
v_mfma_f32_16x16x32_bf16 v[200:203], a[216:219], a[72:75], v[200:203]
s_waitcnt vmcnt(17)
v_mfma_f32_16x16x32_bf16 v[200:203], a[220:223], a[88:91], v[200:203]
v_mfma_f32_16x16x32_bf16 v[204:207], a[208:211], a[44:47], v[204:207]
ds_read_b64_tr_b16 a[208:209], v13 offset:8
v_mfma_f32_16x16x32_bf16 v[204:207], a[212:215], a[60:63], v[204:207]
ds_read_b64_tr_b16 a[210:211], v13 offset:6152
v_mfma_f32_16x16x32_bf16 v[204:207], a[216:219], a[76:79], v[204:207]
s_waitcnt vmcnt(16)
ds_read_b64_tr_b16 a[212:213], v13 offset:12296
v_mfma_f32_16x16x32_bf16 v[204:207], a[220:223], a[92:95], v[204:207]
ds_read_b64_tr_b16 a[214:215], v13 offset:18440
v_mfma_f32_16x16x32_bf16 v[240:243], a[224:227], a[32:35], v[240:243]
ds_read_b64_tr_b16 a[216:217], v13 offset:24584
v_mfma_f32_16x16x32_bf16 v[240:243], a[228:231], a[48:51], v[240:243]
ds_read_b64_tr_b16 a[218:219], v13 offset:30728
v_mfma_f32_16x16x32_bf16 v[240:243], a[232:235], a[64:67], v[240:243]
ds_read_b64_tr_b16 a[220:221], v15 offset:8
v_mfma_f32_16x16x32_bf16 v[240:243], a[236:239], a[80:83], v[240:243]
ds_read_b64_tr_b16 a[222:223], v15 offset:6152
v_mfma_f32_16x16x32_bf16 v[244:247], a[224:227], a[36:39], v[244:247]
v_mfma_f32_16x16x32_bf16 v[244:247], a[228:231], a[52:55], v[244:247]
v_mfma_f32_16x16x32_bf16 v[244:247], a[232:235], a[68:71], v[244:247]
v_mfma_f32_16x16x32_bf16 v[244:247], a[236:239], a[84:87], v[244:247]
v_mfma_f32_16x16x32_bf16 v[248:251], a[224:227], a[40:43], v[248:251]
v_mfma_f32_16x16x32_bf16 v[248:251], a[228:231], a[56:59], v[248:251]
v_mfma_f32_16x16x32_bf16 v[248:251], a[232:235], a[72:75], v[248:251]
v_mfma_f32_16x16x32_bf16 v[248:251], a[236:239], a[88:91], v[248:251]
v_mfma_f32_16x16x32_bf16 v[252:255], a[224:227], a[44:47], v[252:255]
ds_read_b64_tr_b16 a[224:225], v27 offset:0
v_mfma_f32_16x16x32_bf16 v[252:255], a[228:231], a[60:63], v[252:255]
ds_read_b64_tr_b16 a[226:227], v27 offset:6144
v_mfma_f32_16x16x32_bf16 v[252:255], a[232:235], a[76:79], v[252:255]
ds_read_b64_tr_b16 a[228:229], v27 offset:12288
v_mfma_f32_16x16x32_bf16 v[252:255], a[236:239], a[92:95], v[252:255]
s_waitcnt vmcnt(15)
ds_read_b64_tr_b16 a[230:231], v27 offset:18432
v_mfma_f32_16x16x32_bf16 v[192:195], a[192:195], a[96:99], v[192:195]
s_waitcnt vmcnt(11)
ds_read_b64_tr_b16 a[232:233], v16 offset:12288
v_mfma_f32_16x16x32_bf16 v[192:195], a[196:199], a[112:115], v[192:195]
s_waitcnt vmcnt(7) lgkmcnt(5)
ds_read_b64_tr_b16 a[234:235], v16 offset:18432
v_mfma_f32_16x16x32_bf16 v[192:195], a[200:203], a[128:131], v[192:195]
s_waitcnt vmcnt(3)
ds_read_b64_tr_b16 a[236:237], v16 offset:24576
v_mfma_f32_16x16x32_bf16 v[192:195], a[204:207], a[144:147], v[192:195]
ds_read_b64_tr_b16 a[238:239], v16 offset:30720
v_mfma_f32_16x16x32_bf16 v[196:199], a[192:195], a[100:103], v[196:199]
v_mfma_f32_16x16x32_bf16 v[196:199], a[196:199], a[116:119], v[196:199]
v_mfma_f32_16x16x32_bf16 v[196:199], a[200:203], a[132:135], v[196:199]
s_waitcnt vmcnt(2)
v_mfma_f32_16x16x32_bf16 v[196:199], a[204:207], a[148:151], v[196:199]
v_mfma_f32_16x16x32_bf16 v[200:203], a[192:195], a[104:107], v[200:203]
v_mfma_f32_16x16x32_bf16 v[200:203], a[196:199], a[120:123], v[200:203]
v_mfma_f32_16x16x32_bf16 v[200:203], a[200:203], a[136:139], v[200:203]
s_waitcnt vmcnt(1)
v_mfma_f32_16x16x32_bf16 v[200:203], a[204:207], a[152:155], v[200:203]
v_mfma_f32_16x16x32_bf16 v[204:207], a[192:195], a[108:111], v[204:207]
ds_read_b64_tr_b16 a[192:193], v27 offset:8
v_mfma_f32_16x16x32_bf16 v[204:207], a[196:199], a[124:127], v[204:207]
ds_read_b64_tr_b16 a[194:195], v27 offset:6152
v_mfma_f32_16x16x32_bf16 v[204:207], a[200:203], a[140:143], v[204:207]
s_waitcnt vmcnt(0)
ds_read_b64_tr_b16 a[196:197], v27 offset:12296
v_mfma_f32_16x16x32_bf16 v[204:207], a[204:207], a[156:159], v[204:207]
ds_read_b64_tr_b16 a[198:199], v27 offset:18440
v_mfma_f32_16x16x32_bf16 v[240:243], a[208:211], a[96:99], v[240:243]
ds_read_b64_tr_b16 a[200:201], v16 offset:12296
v_mfma_f32_16x16x32_bf16 v[240:243], a[212:215], a[112:115], v[240:243]
ds_read_b64_tr_b16 a[202:203], v16 offset:18440
v_mfma_f32_16x16x32_bf16 v[240:243], a[216:219], a[128:131], v[240:243]
ds_read_b64_tr_b16 a[204:205], v16 offset:24584
v_mfma_f32_16x16x32_bf16 v[240:243], a[220:223], a[144:147], v[240:243]
ds_read_b64_tr_b16 a[206:207], v16 offset:30728
v_cvt_pk_bf16_f32 v64, v192, v193
v_mfma_f32_16x16x32_bf16 v[244:247], a[208:211], a[100:103], v[244:247]
v_cvt_pk_bf16_f32 v65, v194, v195
v_mfma_f32_16x16x32_bf16 v[244:247], a[212:215], a[116:119], v[244:247]
v_mfma_f32_16x16x32_bf16 v[244:247], a[216:219], a[132:135], v[244:247]
v_mfma_f32_16x16x32_bf16 v[244:247], a[220:223], a[148:151], v[244:247]
v_cvt_pk_bf16_f32 v68, v196, v197
v_cvt_pk_bf16_f32 v66, v240, v241
v_mfma_f32_16x16x32_bf16 v[248:251], a[208:211], a[104:107], v[248:251]
v_cvt_pk_bf16_f32 v67, v242, v243
v_cvt_pk_bf16_f32 v69, v198, v199
v_mfma_f32_16x16x32_bf16 v[248:251], a[212:215], a[120:123], v[248:251]
buffer_store_dwordx4 v[64:67], v18, s[68:71], s30 offen offset:0 sc1
v_mfma_f32_16x16x32_bf16 v[248:251], a[216:219], a[136:139], v[248:251]
v_cvt_pk_bf16_f32 v70, v244, v245
v_cvt_pk_bf16_f32 v71, v246, v247
v_mfma_f32_16x16x32_bf16 v[248:251], a[220:223], a[152:155], v[248:251]
buffer_store_dwordx4 v[68:71], v18, s[68:71], s31 offen offset:0 sc1
v_mfma_f32_16x16x32_bf16 v[252:255], a[208:211], a[108:111], v[252:255]
ds_read_b64_tr_b16 a[208:209], v14 offset:0
v_cvt_pk_bf16_f32 v72, v200, v201
v_mfma_f32_16x16x32_bf16 v[252:255], a[212:215], a[124:127], v[252:255]
ds_read_b64_tr_b16 a[210:211], v14 offset:6144
v_cvt_pk_bf16_f32 v73, v202, v203
v_mfma_f32_16x16x32_bf16 v[252:255], a[216:219], a[140:143], v[252:255]
ds_read_b64_tr_b16 a[212:213], v14 offset:12288
v_cvt_pk_bf16_f32 v74, v248, v249
v_mfma_f32_16x16x32_bf16 v[252:255], a[220:223], a[156:159], v[252:255]
s_waitcnt lgkmcnt(3)
ds_read_b64_tr_b16 a[214:215], v14 offset:18432
v_cvt_pk_bf16_f32 v75, v250, v251
v_mfma_f32_16x16x32_bf16 a[240:243], a[224:227], a[32:35], a[240:243]
ds_read_b64_tr_b16 a[216:217], v14 offset:24576
v_cvt_pk_bf16_f32 v76, v204, v205
v_mfma_f32_16x16x32_bf16 a[240:243], a[228:231], a[48:51], a[240:243]
ds_read_b64_tr_b16 a[218:219], v14 offset:30720
v_cvt_pk_bf16_f32 v77, v206, v207
v_mfma_f32_16x16x32_bf16 a[240:243], a[232:235], a[64:67], a[240:243]
ds_read_b64_tr_b16 a[220:221], v16 offset:0
v_cvt_pk_bf16_f32 v78, v252, v253
v_mfma_f32_16x16x32_bf16 a[240:243], a[236:239], a[80:83], a[240:243]
ds_read_b64_tr_b16 a[222:223], v16 offset:6144
v_cvt_pk_bf16_f32 v79, v254, v255
v_mfma_f32_16x16x32_bf16 a[244:247], a[224:227], a[36:39], a[244:247]
buffer_store_dwordx4 v[72:75], v18, s[68:71], s32 offen offset:0 sc1
v_mfma_f32_16x16x32_bf16 a[244:247], a[228:231], a[52:55], a[244:247]
buffer_store_dwordx4 v[76:79], v18, s[68:71], s33 offen offset:0 sc1
v_mfma_f32_16x16x32_bf16 a[244:247], a[232:235], a[68:71], a[244:247]
v_mfma_f32_16x16x32_bf16 a[244:247], a[236:239], a[84:87], a[244:247]
v_mfma_f32_16x16x32_bf16 a[248:251], a[224:227], a[40:43], a[248:251]
v_mfma_f32_16x16x32_bf16 a[248:251], a[228:231], a[56:59], a[248:251]
v_mfma_f32_16x16x32_bf16 a[248:251], a[232:235], a[72:75], a[248:251]
v_mfma_f32_16x16x32_bf16 a[248:251], a[236:239], a[88:91], a[248:251]
v_mfma_f32_16x16x32_bf16 a[252:255], a[224:227], a[44:47], a[252:255]
ds_read_b64_tr_b16 a[224:225], v14 offset:8
v_mfma_f32_16x16x32_bf16 a[252:255], a[228:231], a[60:63], a[252:255]
ds_read_b64_tr_b16 a[226:227], v14 offset:6152
v_mfma_f32_16x16x32_bf16 a[252:255], a[232:235], a[76:79], a[252:255]
ds_read_b64_tr_b16 a[228:229], v14 offset:12296
v_mfma_f32_16x16x32_bf16 a[252:255], a[236:239], a[92:95], a[252:255]
ds_read_b64_tr_b16 a[230:231], v14 offset:18440
v_mfma_f32_16x16x32_bf16 v[160:163], a[192:195], a[32:35], v[160:163]
ds_read_b64_tr_b16 a[232:233], v14 offset:24584
v_mfma_f32_16x16x32_bf16 v[160:163], a[196:199], a[48:51], v[160:163]
ds_read_b64_tr_b16 a[234:235], v14 offset:30728
v_mfma_f32_16x16x32_bf16 v[160:163], a[200:203], a[64:67], v[160:163]
ds_read_b64_tr_b16 a[236:237], v16 offset:8
v_mfma_f32_16x16x32_bf16 v[160:163], a[204:207], a[80:83], v[160:163]
ds_read_b64_tr_b16 a[238:239], v16 offset:6152
v_mfma_f32_16x16x32_bf16 v[164:167], a[192:195], a[36:39], v[164:167]
v_mfma_f32_16x16x32_bf16 v[164:167], a[196:199], a[52:55], v[164:167]
v_mfma_f32_16x16x32_bf16 v[164:167], a[200:203], a[68:71], v[164:167]
v_mfma_f32_16x16x32_bf16 v[164:167], a[204:207], a[84:87], v[164:167]
v_mfma_f32_16x16x32_bf16 v[168:171], a[192:195], a[40:43], v[168:171]
v_mfma_f32_16x16x32_bf16 v[168:171], a[196:199], a[56:59], v[168:171]
v_mfma_f32_16x16x32_bf16 v[168:171], a[200:203], a[72:75], v[168:171]
v_mfma_f32_16x16x32_bf16 v[168:171], a[204:207], a[88:91], v[168:171]
v_mfma_f32_16x16x32_bf16 v[172:175], a[192:195], a[44:47], v[172:175]
ds_read_b64_tr_b16 a[192:193], v26 offset:128
v_mfma_f32_16x16x32_bf16 v[172:175], a[196:199], a[60:63], v[172:175]
ds_read_b64_tr_b16 a[194:195], v26 offset:6272
v_mfma_f32_16x16x32_bf16 v[172:175], a[200:203], a[76:79], v[172:175]
ds_read_b64_tr_b16 a[196:197], v26 offset:12416
v_mfma_f32_16x16x32_bf16 v[172:175], a[204:207], a[92:95], v[172:175]
s_waitcnt lgkmcnt(3)
ds_read_b64_tr_b16 a[198:199], v26 offset:18560
v_mfma_f32_16x16x32_bf16 a[240:243], a[208:211], a[96:99], a[240:243]
ds_read_b64_tr_b16 a[200:201], v15 offset:12416
v_mfma_f32_16x16x32_bf16 a[240:243], a[212:215], a[112:115], a[240:243]
ds_read_b64_tr_b16 a[202:203], v15 offset:18560
v_mfma_f32_16x16x32_bf16 a[240:243], a[216:219], a[128:131], a[240:243]
ds_read_b64_tr_b16 a[204:205], v15 offset:24704
v_mfma_f32_16x16x32_bf16 a[240:243], a[220:223], a[144:147], a[240:243]
ds_read_b64_tr_b16 a[206:207], v15 offset:30848
v_mfma_f32_16x16x32_bf16 a[244:247], a[208:211], a[100:103], a[244:247]
v_mfma_f32_16x16x32_bf16 a[244:247], a[212:215], a[116:119], a[244:247]
v_mfma_f32_16x16x32_bf16 a[244:247], a[216:219], a[132:135], a[244:247]
v_mfma_f32_16x16x32_bf16 a[244:247], a[220:223], a[148:151], a[244:247]
v_mfma_f32_16x16x32_bf16 a[248:251], a[208:211], a[104:107], a[248:251]
v_mfma_f32_16x16x32_bf16 a[248:251], a[212:215], a[120:123], a[248:251]
v_mfma_f32_16x16x32_bf16 a[248:251], a[216:219], a[136:139], a[248:251]
v_mfma_f32_16x16x32_bf16 a[248:251], a[220:223], a[152:155], a[248:251]
v_mfma_f32_16x16x32_bf16 a[252:255], a[208:211], a[108:111], a[252:255]
ds_read_b64_tr_b16 a[208:209], v26 offset:136
v_mfma_f32_16x16x32_bf16 a[252:255], a[212:215], a[124:127], a[252:255]
ds_read_b64_tr_b16 a[210:211], v26 offset:6280
v_mfma_f32_16x16x32_bf16 a[252:255], a[216:219], a[140:143], a[252:255]
ds_read_b64_tr_b16 a[212:213], v26 offset:12424
v_mfma_f32_16x16x32_bf16 a[252:255], a[220:223], a[156:159], a[252:255]
ds_read_b64_tr_b16 a[214:215], v26 offset:18568
v_mfma_f32_16x16x32_bf16 v[160:163], a[224:227], a[96:99], v[160:163]
ds_read_b64_tr_b16 a[216:217], v15 offset:12424
v_mfma_f32_16x16x32_bf16 v[160:163], a[228:231], a[112:115], v[160:163]
ds_read_b64_tr_b16 a[218:219], v15 offset:18568
v_mfma_f32_16x16x32_bf16 v[160:163], a[232:235], a[128:131], v[160:163]
ds_read_b64_tr_b16 a[220:221], v15 offset:24712
v_mfma_f32_16x16x32_bf16 v[160:163], a[236:239], a[144:147], v[160:163]
ds_read_b64_tr_b16 a[222:223], v15 offset:30856
v_accvgpr_read_b32 v112, a240
v_mfma_f32_16x16x32_bf16 v[164:167], a[224:227], a[100:103], v[164:167]
v_accvgpr_read_b32 v113, a241
v_accvgpr_read_b32 v114, a242
v_mfma_f32_16x16x32_bf16 v[164:167], a[228:231], a[116:119], v[164:167]
v_accvgpr_read_b32 v115, a243
v_cvt_pk_bf16_f32 v80, v112, v113
v_mfma_f32_16x16x32_bf16 v[164:167], a[232:235], a[132:135], v[164:167]
v_cvt_pk_bf16_f32 v81, v114, v115
v_cvt_pk_bf16_f32 v82, v160, v161
v_mfma_f32_16x16x32_bf16 v[164:167], a[236:239], a[148:151], v[164:167]
v_cvt_pk_bf16_f32 v83, v162, v163
v_accvgpr_read_b32 v116, a244
v_mfma_f32_16x16x32_bf16 v[168:171], a[224:227], a[104:107], v[168:171]
buffer_store_dwordx4 v[80:83], v18, s[68:71], s30 offen offset:1024 sc1
v_mfma_f32_16x16x32_bf16 v[168:171], a[228:231], a[120:123], v[168:171]
v_accvgpr_read_b32 v117, a245
v_accvgpr_read_b32 v118, a246
v_mfma_f32_16x16x32_bf16 v[168:171], a[232:235], a[136:139], v[168:171]
v_accvgpr_read_b32 v119, a247
v_cvt_pk_bf16_f32 v84, v116, v117
v_mfma_f32_16x16x32_bf16 v[168:171], a[236:239], a[152:155], v[168:171]
v_cvt_pk_bf16_f32 v85, v118, v119
v_cvt_pk_bf16_f32 v86, v164, v165
v_mfma_f32_16x16x32_bf16 v[172:175], a[224:227], a[108:111], v[172:175]
ds_read_b64_tr_b16 a[224:225], v13 offset:128
v_cvt_pk_bf16_f32 v87, v166, v167
v_mfma_f32_16x16x32_bf16 v[172:175], a[228:231], a[124:127], v[172:175]
ds_read_b64_tr_b16 a[226:227], v13 offset:6272
v_accvgpr_read_b32 v120, a248
v_mfma_f32_16x16x32_bf16 v[172:175], a[232:235], a[140:143], v[172:175]
ds_read_b64_tr_b16 a[228:229], v13 offset:12416
v_accvgpr_read_b32 v121, a249
v_mfma_f32_16x16x32_bf16 v[172:175], a[236:239], a[156:159], v[172:175]
s_waitcnt lgkmcnt(3)
ds_read_b64_tr_b16 a[230:231], v13 offset:18560
v_accvgpr_read_b32 v122, a250
v_mfma_f32_16x16x32_bf16 v[32:35], a[192:195], a[32:35], v[32:35]
ds_read_b64_tr_b16 a[232:233], v13 offset:24704
v_accvgpr_read_b32 v123, a251
v_mfma_f32_16x16x32_bf16 v[32:35], a[196:199], a[48:51], v[32:35]
ds_read_b64_tr_b16 a[234:235], v13 offset:30848
v_cvt_pk_bf16_f32 v88, v120, v121
v_mfma_f32_16x16x32_bf16 v[32:35], a[200:203], a[64:67], v[32:35]
ds_read_b64_tr_b16 a[236:237], v15 offset:128
v_cvt_pk_bf16_f32 v89, v122, v123
v_mfma_f32_16x16x32_bf16 v[32:35], a[204:207], a[80:83], v[32:35]
ds_read_b64_tr_b16 a[238:239], v15 offset:6272
v_cvt_pk_bf16_f32 v90, v168, v169
v_mfma_f32_16x16x32_bf16 v[36:39], a[192:195], a[36:39], v[36:39]
buffer_store_dwordx4 v[84:87], v18, s[68:71], s31 offen offset:1024 sc1
v_mfma_f32_16x16x32_bf16 v[36:39], a[196:199], a[52:55], v[36:39]
v_cvt_pk_bf16_f32 v91, v170, v171
v_accvgpr_read_b32 v124, a252
v_mfma_f32_16x16x32_bf16 v[36:39], a[200:203], a[68:71], v[36:39]
buffer_store_dwordx4 v[88:91], v18, s[68:71], s32 offen offset:1024 sc1
v_mfma_f32_16x16x32_bf16 v[36:39], a[204:207], a[84:87], v[36:39]
v_accvgpr_read_b32 v125, a253
v_accvgpr_read_b32 v126, a254
v_mfma_f32_16x16x32_bf16 v[40:43], a[192:195], a[40:43], v[40:43]
v_accvgpr_read_b32 v127, a255
v_cvt_pk_bf16_f32 v92, v124, v125
v_mfma_f32_16x16x32_bf16 v[40:43], a[196:199], a[56:59], v[40:43]
v_cvt_pk_bf16_f32 v93, v126, v127
v_cvt_pk_bf16_f32 v94, v172, v173
v_mfma_f32_16x16x32_bf16 v[40:43], a[200:203], a[72:75], v[40:43]
v_cvt_pk_bf16_f32 v95, v174, v175
v_mfma_f32_16x16x32_bf16 v[40:43], a[204:207], a[88:91], v[40:43]
buffer_store_dwordx4 v[92:95], v18, s[68:71], s33 offen offset:1024 sc1
v_mfma_f32_16x16x32_bf16 v[44:47], a[192:195], a[44:47], v[44:47]
ds_read_b64_tr_b16 a[192:193], v13 offset:136
v_mfma_f32_16x16x32_bf16 v[44:47], a[196:199], a[60:63], v[44:47]
ds_read_b64_tr_b16 a[194:195], v13 offset:6280
v_mfma_f32_16x16x32_bf16 v[44:47], a[200:203], a[76:79], v[44:47]
ds_read_b64_tr_b16 a[196:197], v13 offset:12424
v_mfma_f32_16x16x32_bf16 v[44:47], a[204:207], a[92:95], v[44:47]
ds_read_b64_tr_b16 a[198:199], v13 offset:18568
v_mfma_f32_16x16x32_bf16 v[48:51], a[208:211], a[32:35], v[48:51]
ds_read_b64_tr_b16 a[200:201], v13 offset:24712
v_mfma_f32_16x16x32_bf16 v[48:51], a[212:215], a[48:51], v[48:51]
ds_read_b64_tr_b16 a[202:203], v13 offset:30856
v_mfma_f32_16x16x32_bf16 v[48:51], a[216:219], a[64:67], v[48:51]
ds_read_b64_tr_b16 a[204:205], v15 offset:136
v_mfma_f32_16x16x32_bf16 v[48:51], a[220:223], a[80:83], v[48:51]
ds_read_b64_tr_b16 a[206:207], v15 offset:6280
v_mfma_f32_16x16x32_bf16 v[52:55], a[208:211], a[36:39], v[52:55]
v_mfma_f32_16x16x32_bf16 v[52:55], a[212:215], a[52:55], v[52:55]
v_mfma_f32_16x16x32_bf16 v[52:55], a[216:219], a[68:71], v[52:55]
v_mfma_f32_16x16x32_bf16 v[52:55], a[220:223], a[84:87], v[52:55]
v_mfma_f32_16x16x32_bf16 v[56:59], a[208:211], a[40:43], v[56:59]
v_mfma_f32_16x16x32_bf16 v[56:59], a[212:215], a[56:59], v[56:59]
v_mfma_f32_16x16x32_bf16 v[56:59], a[216:219], a[72:75], v[56:59]
v_mfma_f32_16x16x32_bf16 v[56:59], a[220:223], a[88:91], v[56:59]
v_mfma_f32_16x16x32_bf16 v[60:63], a[208:211], a[44:47], v[60:63]
ds_read_b64_tr_b16 a[208:209], v27 offset:128
v_mfma_f32_16x16x32_bf16 v[60:63], a[212:215], a[60:63], v[60:63]
ds_read_b64_tr_b16 a[210:211], v27 offset:6272
v_mfma_f32_16x16x32_bf16 v[60:63], a[216:219], a[76:79], v[60:63]
ds_read_b64_tr_b16 a[212:213], v27 offset:12416
v_mfma_f32_16x16x32_bf16 v[60:63], a[220:223], a[92:95], v[60:63]
s_waitcnt lgkmcnt(3)
ds_read_b64_tr_b16 a[214:215], v27 offset:18560
v_mfma_f32_16x16x32_bf16 v[32:35], a[224:227], a[96:99], v[32:35]
ds_read_b64_tr_b16 a[216:217], v16 offset:12416
v_mfma_f32_16x16x32_bf16 v[32:35], a[228:231], a[112:115], v[32:35]
ds_read_b64_tr_b16 a[218:219], v16 offset:18560
v_mfma_f32_16x16x32_bf16 v[32:35], a[232:235], a[128:131], v[32:35]
ds_read_b64_tr_b16 a[220:221], v16 offset:24704
v_mfma_f32_16x16x32_bf16 v[32:35], a[236:239], a[144:147], v[32:35]
ds_read_b64_tr_b16 a[222:223], v16 offset:30848
v_mfma_f32_16x16x32_bf16 v[36:39], a[224:227], a[100:103], v[36:39]
v_mfma_f32_16x16x32_bf16 v[36:39], a[228:231], a[116:119], v[36:39]
v_mfma_f32_16x16x32_bf16 v[36:39], a[232:235], a[132:135], v[36:39]
v_mfma_f32_16x16x32_bf16 v[36:39], a[236:239], a[148:151], v[36:39]
v_mfma_f32_16x16x32_bf16 v[40:43], a[224:227], a[104:107], v[40:43]
v_mfma_f32_16x16x32_bf16 v[40:43], a[228:231], a[120:123], v[40:43]
v_mfma_f32_16x16x32_bf16 v[40:43], a[232:235], a[136:139], v[40:43]
v_mfma_f32_16x16x32_bf16 v[40:43], a[236:239], a[152:155], v[40:43]
v_mfma_f32_16x16x32_bf16 v[44:47], a[224:227], a[108:111], v[44:47]
ds_read_b64_tr_b16 a[224:225], v27 offset:136
v_mfma_f32_16x16x32_bf16 v[44:47], a[228:231], a[124:127], v[44:47]
ds_read_b64_tr_b16 a[226:227], v27 offset:6280
v_mfma_f32_16x16x32_bf16 v[44:47], a[232:235], a[140:143], v[44:47]
ds_read_b64_tr_b16 a[228:229], v27 offset:12424
v_mfma_f32_16x16x32_bf16 v[44:47], a[236:239], a[156:159], v[44:47]
ds_read_b64_tr_b16 a[230:231], v27 offset:18568
v_mfma_f32_16x16x32_bf16 v[48:51], a[192:195], a[96:99], v[48:51]
ds_read_b64_tr_b16 a[232:233], v16 offset:12424
v_mfma_f32_16x16x32_bf16 v[48:51], a[196:199], a[112:115], v[48:51]
ds_read_b64_tr_b16 a[234:235], v16 offset:18568
v_mfma_f32_16x16x32_bf16 v[48:51], a[200:203], a[128:131], v[48:51]
ds_read_b64_tr_b16 a[236:237], v16 offset:24712
v_mfma_f32_16x16x32_bf16 v[48:51], a[204:207], a[144:147], v[48:51]
ds_read_b64_tr_b16 a[238:239], v16 offset:30856
v_cvt_pk_bf16_f32 v64, v32, v33
v_mfma_f32_16x16x32_bf16 v[52:55], a[192:195], a[100:103], v[52:55]
v_cvt_pk_bf16_f32 v65, v34, v35
v_mfma_f32_16x16x32_bf16 v[52:55], a[196:199], a[116:119], v[52:55]
v_mfma_f32_16x16x32_bf16 v[52:55], a[200:203], a[132:135], v[52:55]
v_mfma_f32_16x16x32_bf16 v[52:55], a[204:207], a[148:151], v[52:55]
v_cvt_pk_bf16_f32 v68, v36, v37
v_cvt_pk_bf16_f32 v66, v48, v49
v_mfma_f32_16x16x32_bf16 v[56:59], a[192:195], a[104:107], v[56:59]
v_cvt_pk_bf16_f32 v67, v50, v51
v_cvt_pk_bf16_f32 v69, v38, v39
v_mfma_f32_16x16x32_bf16 v[56:59], a[196:199], a[120:123], v[56:59]
buffer_store_dwordx4 v[64:67], v18, s[68:71], s30 offen offset:2048 sc1
v_mfma_f32_16x16x32_bf16 v[56:59], a[200:203], a[136:139], v[56:59]
v_cvt_pk_bf16_f32 v70, v52, v53
v_cvt_pk_bf16_f32 v71, v54, v55
v_mfma_f32_16x16x32_bf16 v[56:59], a[204:207], a[152:155], v[56:59]
buffer_store_dwordx4 v[68:71], v18, s[68:71], s31 offen offset:2048 sc1
v_mfma_f32_16x16x32_bf16 v[60:63], a[192:195], a[108:111], v[60:63]
ds_read_b64_tr_b16 a[192:193], v14 offset:128
v_cvt_pk_bf16_f32 v72, v40, v41
v_mfma_f32_16x16x32_bf16 v[60:63], a[196:199], a[124:127], v[60:63]
ds_read_b64_tr_b16 a[194:195], v14 offset:6272
v_cvt_pk_bf16_f32 v73, v42, v43
v_mfma_f32_16x16x32_bf16 v[60:63], a[200:203], a[140:143], v[60:63]
ds_read_b64_tr_b16 a[196:197], v14 offset:12416
v_cvt_pk_bf16_f32 v74, v56, v57
v_mfma_f32_16x16x32_bf16 v[60:63], a[204:207], a[156:159], v[60:63]
s_waitcnt lgkmcnt(3)
ds_read_b64_tr_b16 a[198:199], v14 offset:18560
v_cvt_pk_bf16_f32 v75, v58, v59
v_mfma_f32_16x16x32_bf16 v[176:179], a[208:211], a[32:35], v[176:179]
ds_read_b64_tr_b16 a[200:201], v14 offset:24704
v_cvt_pk_bf16_f32 v76, v44, v45
v_mfma_f32_16x16x32_bf16 v[176:179], a[212:215], a[48:51], v[176:179]
ds_read_b64_tr_b16 a[202:203], v14 offset:30848
v_cvt_pk_bf16_f32 v77, v46, v47
v_mfma_f32_16x16x32_bf16 v[176:179], a[216:219], a[64:67], v[176:179]
ds_read_b64_tr_b16 a[204:205], v16 offset:128
v_cvt_pk_bf16_f32 v78, v60, v61
v_mfma_f32_16x16x32_bf16 v[176:179], a[220:223], a[80:83], v[176:179]
ds_read_b64_tr_b16 a[206:207], v16 offset:6272
v_cvt_pk_bf16_f32 v79, v62, v63
v_mfma_f32_16x16x32_bf16 v[180:183], a[208:211], a[36:39], v[180:183]
buffer_store_dwordx4 v[72:75], v18, s[68:71], s32 offen offset:2048 sc1
v_mfma_f32_16x16x32_bf16 v[180:183], a[212:215], a[52:55], v[180:183]
buffer_store_dwordx4 v[76:79], v18, s[68:71], s33 offen offset:2048 sc1
v_mfma_f32_16x16x32_bf16 v[180:183], a[216:219], a[68:71], v[180:183]
v_mfma_f32_16x16x32_bf16 v[180:183], a[220:223], a[84:87], v[180:183]
v_mfma_f32_16x16x32_bf16 v[184:187], a[208:211], a[40:43], v[184:187]
v_mfma_f32_16x16x32_bf16 v[184:187], a[212:215], a[56:59], v[184:187]
v_mfma_f32_16x16x32_bf16 v[184:187], a[216:219], a[72:75], v[184:187]
v_mfma_f32_16x16x32_bf16 v[184:187], a[220:223], a[88:91], v[184:187]
v_mfma_f32_16x16x32_bf16 v[188:191], a[208:211], a[44:47], v[188:191]
ds_read_b64_tr_b16 a[208:209], v14 offset:136
v_mfma_f32_16x16x32_bf16 v[188:191], a[212:215], a[60:63], v[188:191]
ds_read_b64_tr_b16 a[210:211], v14 offset:6280
v_mfma_f32_16x16x32_bf16 v[188:191], a[216:219], a[76:79], v[188:191]
ds_read_b64_tr_b16 a[212:213], v14 offset:12424
v_mfma_f32_16x16x32_bf16 v[188:191], a[220:223], a[92:95], v[188:191]
ds_read_b64_tr_b16 a[214:215], v14 offset:18568
v_mfma_f32_16x16x32_bf16 a[0:3], a[224:227], a[32:35], a[0:3]
ds_read_b64_tr_b16 a[216:217], v14 offset:24712
v_mfma_f32_16x16x32_bf16 a[0:3], a[228:231], a[48:51], a[0:3]
ds_read_b64_tr_b16 a[218:219], v14 offset:30856
v_mfma_f32_16x16x32_bf16 a[0:3], a[232:235], a[64:67], a[0:3]
ds_read_b64_tr_b16 a[220:221], v16 offset:136
v_mfma_f32_16x16x32_bf16 a[0:3], a[236:239], a[80:83], a[0:3]
ds_read_b64_tr_b16 a[222:223], v16 offset:6280
v_mfma_f32_16x16x32_bf16 a[4:7], a[224:227], a[36:39], a[4:7]
v_mfma_f32_16x16x32_bf16 a[4:7], a[228:231], a[52:55], a[4:7]
v_mfma_f32_16x16x32_bf16 a[4:7], a[232:235], a[68:71], a[4:7]
v_mfma_f32_16x16x32_bf16 a[4:7], a[236:239], a[84:87], a[4:7]
v_mfma_f32_16x16x32_bf16 a[8:11], a[224:227], a[40:43], a[8:11]
v_mfma_f32_16x16x32_bf16 a[8:11], a[228:231], a[56:59], a[8:11]
v_mfma_f32_16x16x32_bf16 a[8:11], a[232:235], a[72:75], a[8:11]
v_mfma_f32_16x16x32_bf16 a[8:11], a[236:239], a[88:91], a[8:11]
v_mfma_f32_16x16x32_bf16 a[12:15], a[224:227], a[44:47], a[12:15]
ds_read_b64_tr_b16 a[224:225], v26 offset:256
v_mfma_f32_16x16x32_bf16 a[12:15], a[228:231], a[60:63], a[12:15]
ds_read_b64_tr_b16 a[226:227], v26 offset:6400
v_mfma_f32_16x16x32_bf16 a[12:15], a[232:235], a[76:79], a[12:15]
ds_read_b64_tr_b16 a[228:229], v26 offset:12544
v_mfma_f32_16x16x32_bf16 a[12:15], a[236:239], a[92:95], a[12:15]
s_waitcnt lgkmcnt(3)
ds_read_b64_tr_b16 a[230:231], v26 offset:18688
v_mfma_f32_16x16x32_bf16 v[176:179], a[192:195], a[96:99], v[176:179]
ds_read_b64_tr_b16 a[232:233], v15 offset:12544
v_mfma_f32_16x16x32_bf16 v[176:179], a[196:199], a[112:115], v[176:179]
ds_read_b64_tr_b16 a[234:235], v15 offset:18688
v_mfma_f32_16x16x32_bf16 v[176:179], a[200:203], a[128:131], v[176:179]
ds_read_b64_tr_b16 a[236:237], v15 offset:24832
v_mfma_f32_16x16x32_bf16 v[176:179], a[204:207], a[144:147], v[176:179]
ds_read_b64_tr_b16 a[238:239], v15 offset:30976
v_mfma_f32_16x16x32_bf16 v[180:183], a[192:195], a[100:103], v[180:183]
v_mfma_f32_16x16x32_bf16 v[180:183], a[196:199], a[116:119], v[180:183]
v_mfma_f32_16x16x32_bf16 v[180:183], a[200:203], a[132:135], v[180:183]
v_mfma_f32_16x16x32_bf16 v[180:183], a[204:207], a[148:151], v[180:183]
v_mfma_f32_16x16x32_bf16 v[184:187], a[192:195], a[104:107], v[184:187]
v_mfma_f32_16x16x32_bf16 v[184:187], a[196:199], a[120:123], v[184:187]
v_mfma_f32_16x16x32_bf16 v[184:187], a[200:203], a[136:139], v[184:187]
v_mfma_f32_16x16x32_bf16 v[184:187], a[204:207], a[152:155], v[184:187]
v_mfma_f32_16x16x32_bf16 v[188:191], a[192:195], a[108:111], v[188:191]
ds_read_b64_tr_b16 a[192:193], v26 offset:264
v_mfma_f32_16x16x32_bf16 v[188:191], a[196:199], a[124:127], v[188:191]
ds_read_b64_tr_b16 a[194:195], v26 offset:6408
v_mfma_f32_16x16x32_bf16 v[188:191], a[200:203], a[140:143], v[188:191]
ds_read_b64_tr_b16 a[196:197], v26 offset:12552
v_mfma_f32_16x16x32_bf16 v[188:191], a[204:207], a[156:159], v[188:191]
ds_read_b64_tr_b16 a[198:199], v26 offset:18696
v_mfma_f32_16x16x32_bf16 a[0:3], a[208:211], a[96:99], a[0:3]
ds_read_b64_tr_b16 a[200:201], v15 offset:12552
v_mfma_f32_16x16x32_bf16 a[0:3], a[212:215], a[112:115], a[0:3]
ds_read_b64_tr_b16 a[202:203], v15 offset:18696
v_mfma_f32_16x16x32_bf16 a[0:3], a[216:219], a[128:131], a[0:3]
ds_read_b64_tr_b16 a[204:205], v15 offset:24840
v_mfma_f32_16x16x32_bf16 a[0:3], a[220:223], a[144:147], a[0:3]
ds_read_b64_tr_b16 a[206:207], v15 offset:30984
v_cvt_pk_bf16_f32 v80, v176, v177
v_mfma_f32_16x16x32_bf16 a[4:7], a[208:211], a[100:103], a[4:7]
v_cvt_pk_bf16_f32 v81, v178, v179
v_mfma_f32_16x16x32_bf16 a[4:7], a[212:215], a[116:119], a[4:7]
v_mfma_f32_16x16x32_bf16 a[4:7], a[216:219], a[132:135], a[4:7]
v_mfma_f32_16x16x32_bf16 a[4:7], a[220:223], a[148:151], a[4:7]
v_cvt_pk_bf16_f32 v84, v180, v181
v_accvgpr_read_b32 v112, a0
v_mfma_f32_16x16x32_bf16 a[8:11], a[208:211], a[104:107], a[8:11]
v_accvgpr_read_b32 v113, a1
v_accvgpr_read_b32 v114, a2
v_mfma_f32_16x16x32_bf16 a[8:11], a[212:215], a[120:123], a[8:11]
v_accvgpr_read_b32 v115, a3
v_cvt_pk_bf16_f32 v82, v112, v113
v_mfma_f32_16x16x32_bf16 a[8:11], a[216:219], a[136:139], a[8:11]
v_cvt_pk_bf16_f32 v83, v114, v115
v_accvgpr_read_b32 v116, a4
v_mfma_f32_16x16x32_bf16 a[8:11], a[220:223], a[152:155], a[8:11]
buffer_store_dwordx4 v[80:83], v18, s[68:71], s30 offen offset:3072 sc1
v_mfma_f32_16x16x32_bf16 a[12:15], a[208:211], a[108:111], a[12:15]
ds_read_b64_tr_b16 a[208:209], v13 offset:256
v_accvgpr_read_b32 v117, a5
v_mfma_f32_16x16x32_bf16 a[12:15], a[212:215], a[124:127], a[12:15]
ds_read_b64_tr_b16 a[210:211], v13 offset:6400
v_accvgpr_read_b32 v118, a6
v_mfma_f32_16x16x32_bf16 a[12:15], a[216:219], a[140:143], a[12:15]
ds_read_b64_tr_b16 a[212:213], v13 offset:12544
v_accvgpr_read_b32 v119, a7
v_mfma_f32_16x16x32_bf16 a[12:15], a[220:223], a[156:159], a[12:15]
s_waitcnt lgkmcnt(3)
ds_read_b64_tr_b16 a[214:215], v13 offset:18688
v_cvt_pk_bf16_f32 v85, v182, v183
v_mfma_f32_16x16x32_bf16 a[16:19], a[224:227], a[32:35], a[16:19]
ds_read_b64_tr_b16 a[216:217], v13 offset:24832
v_cvt_pk_bf16_f32 v86, v116, v117
v_mfma_f32_16x16x32_bf16 a[16:19], a[228:231], a[48:51], a[16:19]
ds_read_b64_tr_b16 a[218:219], v13 offset:30976
v_cvt_pk_bf16_f32 v87, v118, v119
v_mfma_f32_16x16x32_bf16 a[16:19], a[232:235], a[64:67], a[16:19]
ds_read_b64_tr_b16 a[220:221], v15 offset:256
v_accvgpr_read_b32 v120, a8
v_mfma_f32_16x16x32_bf16 a[16:19], a[236:239], a[80:83], a[16:19]
ds_read_b64_tr_b16 a[222:223], v15 offset:6400
v_accvgpr_read_b32 v121, a9
v_mfma_f32_16x16x32_bf16 a[20:23], a[224:227], a[36:39], a[20:23]
buffer_store_dwordx4 v[84:87], v18, s[68:71], s31 offen offset:3072 sc1
v_mfma_f32_16x16x32_bf16 a[20:23], a[228:231], a[52:55], a[20:23]
v_accvgpr_read_b32 v122, a10
v_accvgpr_read_b32 v123, a11
v_mfma_f32_16x16x32_bf16 a[20:23], a[232:235], a[68:71], a[20:23]
v_cvt_pk_bf16_f32 v88, v184, v185
v_cvt_pk_bf16_f32 v89, v186, v187
v_mfma_f32_16x16x32_bf16 a[20:23], a[236:239], a[84:87], a[20:23]
v_cvt_pk_bf16_f32 v90, v120, v121
v_cvt_pk_bf16_f32 v91, v122, v123
v_mfma_f32_16x16x32_bf16 a[24:27], a[224:227], a[40:43], a[24:27]
buffer_store_dwordx4 v[88:91], v18, s[68:71], s32 offen offset:3072 sc1
v_mfma_f32_16x16x32_bf16 a[24:27], a[228:231], a[56:59], a[24:27]
v_accvgpr_read_b32 v124, a12
v_accvgpr_read_b32 v125, a13
v_mfma_f32_16x16x32_bf16 a[24:27], a[232:235], a[72:75], a[24:27]
v_accvgpr_read_b32 v126, a14
v_accvgpr_read_b32 v127, a15
v_mfma_f32_16x16x32_bf16 a[24:27], a[236:239], a[88:91], a[24:27]
v_cvt_pk_bf16_f32 v92, v188, v189
v_cvt_pk_bf16_f32 v93, v190, v191
v_mfma_f32_16x16x32_bf16 a[28:31], a[224:227], a[44:47], a[28:31]
ds_read_b64_tr_b16 a[224:225], v13 offset:264
v_cvt_pk_bf16_f32 v94, v124, v125
v_mfma_f32_16x16x32_bf16 a[28:31], a[228:231], a[60:63], a[28:31]
ds_read_b64_tr_b16 a[226:227], v13 offset:6408
v_cvt_pk_bf16_f32 v95, v126, v127
v_mfma_f32_16x16x32_bf16 a[28:31], a[232:235], a[76:79], a[28:31]
ds_read_b64_tr_b16 a[228:229], v13 offset:12552
v_mfma_f32_16x16x32_bf16 a[28:31], a[236:239], a[92:95], a[28:31]
ds_read_b64_tr_b16 a[230:231], v13 offset:18696
v_mfma_f32_16x16x32_bf16 v[216:219], a[192:195], a[32:35], v[216:219]
ds_read_b64_tr_b16 a[232:233], v13 offset:24840
v_mfma_f32_16x16x32_bf16 v[216:219], a[196:199], a[48:51], v[216:219]
ds_read_b64_tr_b16 a[234:235], v13 offset:30984
v_mfma_f32_16x16x32_bf16 v[216:219], a[200:203], a[64:67], v[216:219]
ds_read_b64_tr_b16 a[236:237], v15 offset:264
v_mfma_f32_16x16x32_bf16 v[216:219], a[204:207], a[80:83], v[216:219]
ds_read_b64_tr_b16 a[238:239], v15 offset:6408
v_mfma_f32_16x16x32_bf16 v[220:223], a[192:195], a[36:39], v[220:223]
buffer_store_dwordx4 v[92:95], v18, s[68:71], s33 offen offset:3072 sc1
v_mfma_f32_16x16x32_bf16 v[220:223], a[196:199], a[52:55], v[220:223]
v_mfma_f32_16x16x32_bf16 v[220:223], a[200:203], a[68:71], v[220:223]
v_mfma_f32_16x16x32_bf16 v[220:223], a[204:207], a[84:87], v[220:223]
v_mfma_f32_16x16x32_bf16 v[224:227], a[192:195], a[40:43], v[224:227]
v_mfma_f32_16x16x32_bf16 v[224:227], a[196:199], a[56:59], v[224:227]
v_mfma_f32_16x16x32_bf16 v[224:227], a[200:203], a[72:75], v[224:227]
v_mfma_f32_16x16x32_bf16 v[224:227], a[204:207], a[88:91], v[224:227]
v_mfma_f32_16x16x32_bf16 v[228:231], a[192:195], a[44:47], v[228:231]
v_mfma_f32_16x16x32_bf16 v[228:231], a[196:199], a[60:63], v[228:231]
v_mfma_f32_16x16x32_bf16 v[228:231], a[200:203], a[76:79], v[228:231]
v_mfma_f32_16x16x32_bf16 v[228:231], a[204:207], a[92:95], v[228:231]
s_waitcnt lgkmcnt(0)
v_mfma_f32_16x16x32_bf16 a[16:19], a[208:211], a[96:99], a[16:19]
v_mfma_f32_16x16x32_bf16 a[16:19], a[212:215], a[112:115], a[16:19]
v_mfma_f32_16x16x32_bf16 a[16:19], a[216:219], a[128:131], a[16:19]
v_mfma_f32_16x16x32_bf16 a[16:19], a[220:223], a[144:147], a[16:19]
v_mfma_f32_16x16x32_bf16 a[20:23], a[208:211], a[100:103], a[20:23]
v_mfma_f32_16x16x32_bf16 a[20:23], a[212:215], a[116:119], a[20:23]
v_mfma_f32_16x16x32_bf16 a[20:23], a[216:219], a[132:135], a[20:23]
v_mfma_f32_16x16x32_bf16 a[20:23], a[220:223], a[148:151], a[20:23]
v_mfma_f32_16x16x32_bf16 a[24:27], a[208:211], a[104:107], a[24:27]
v_mfma_f32_16x16x32_bf16 a[24:27], a[212:215], a[120:123], a[24:27]
v_mfma_f32_16x16x32_bf16 a[24:27], a[216:219], a[136:139], a[24:27]
v_mfma_f32_16x16x32_bf16 a[24:27], a[220:223], a[152:155], a[24:27]
v_mfma_f32_16x16x32_bf16 a[28:31], a[208:211], a[108:111], a[28:31]
v_mfma_f32_16x16x32_bf16 a[28:31], a[212:215], a[124:127], a[28:31]
v_mfma_f32_16x16x32_bf16 a[28:31], a[216:219], a[140:143], a[28:31]
v_mfma_f32_16x16x32_bf16 a[28:31], a[220:223], a[156:159], a[28:31]
v_mfma_f32_16x16x32_bf16 v[216:219], a[224:227], a[96:99], v[216:219]
v_mfma_f32_16x16x32_bf16 v[216:219], a[228:231], a[112:115], v[216:219]
v_mfma_f32_16x16x32_bf16 v[216:219], a[232:235], a[128:131], v[216:219]
v_mfma_f32_16x16x32_bf16 v[216:219], a[236:239], a[144:147], v[216:219]
v_accvgpr_read_b32 v96, a16
v_accvgpr_read_b32 v97, a17
v_mfma_f32_16x16x32_bf16 v[220:223], a[224:227], a[100:103], v[220:223]
v_accvgpr_read_b32 v98, a18
v_accvgpr_read_b32 v99, a19
v_mfma_f32_16x16x32_bf16 v[220:223], a[228:231], a[116:119], v[220:223]
v_cvt_pk_bf16_f32 v64, v96, v97
v_cvt_pk_bf16_f32 v65, v98, v99
v_mfma_f32_16x16x32_bf16 v[220:223], a[232:235], a[132:135], v[220:223]
v_cvt_pk_bf16_f32 v66, v216, v217
v_cvt_pk_bf16_f32 v67, v218, v219
v_mfma_f32_16x16x32_bf16 v[220:223], a[236:239], a[148:151], v[220:223]
buffer_store_dwordx4 v[64:67], v19, s[68:71], s30 offen offset:0 sc1
v_mfma_f32_16x16x32_bf16 v[224:227], a[224:227], a[104:107], v[224:227]
v_accvgpr_read_b32 v100, a20
v_accvgpr_read_b32 v101, a21
v_mfma_f32_16x16x32_bf16 v[224:227], a[228:231], a[120:123], v[224:227]
v_accvgpr_read_b32 v102, a22
v_accvgpr_read_b32 v103, a23
v_mfma_f32_16x16x32_bf16 v[224:227], a[232:235], a[136:139], v[224:227]
v_cvt_pk_bf16_f32 v68, v100, v101
v_cvt_pk_bf16_f32 v69, v102, v103
v_mfma_f32_16x16x32_bf16 v[224:227], a[236:239], a[152:155], v[224:227]
v_cvt_pk_bf16_f32 v70, v220, v221
v_cvt_pk_bf16_f32 v71, v222, v223
v_mfma_f32_16x16x32_bf16 v[228:231], a[224:227], a[108:111], v[228:231]
buffer_store_dwordx4 v[68:71], v19, s[68:71], s31 offen offset:0 sc1
v_mfma_f32_16x16x32_bf16 v[228:231], a[228:231], a[124:127], v[228:231]
v_accvgpr_read_b32 v104, a24
v_accvgpr_read_b32 v105, a25
v_mfma_f32_16x16x32_bf16 v[228:231], a[232:235], a[140:143], v[228:231]
v_accvgpr_read_b32 v106, a26
v_accvgpr_read_b32 v107, a27
v_mfma_f32_16x16x32_bf16 v[228:231], a[236:239], a[156:159], v[228:231]
v_cvt_pk_bf16_f32 v72, v104, v105
v_cvt_pk_bf16_f32 v73, v106, v107
v_cvt_pk_bf16_f32 v74, v224, v225
v_cvt_pk_bf16_f32 v75, v226, v227
buffer_store_dwordx4 v[72:75], v19, s[68:71], s32 offen offset:0 sc1
v_accvgpr_read_b32 v108, a28
v_accvgpr_read_b32 v109, a29
v_accvgpr_read_b32 v110, a30
v_accvgpr_read_b32 v111, a31
v_cvt_pk_bf16_f32 v76, v108, v109
v_cvt_pk_bf16_f32 v77, v110, v111
v_cvt_pk_bf16_f32 v78, v228, v229
v_cvt_pk_bf16_f32 v79, v230, v231
buffer_store_dwordx4 v[76:79], v19, s[68:71], s33 offen offset:0 sc1
L1_end:
s_endpgm
L1_dspin:
s_mov_b32 s90, 0x40000
L1_dspin_l:
s_sub_u32 s90, s90, 1
s_cbranch_scc1 L1_dback
buffer_load_dword v250, off, s[76:79], 0 sc1
s_waitcnt vmcnt(0)
v_readfirstlane_b32 s91, v250
s_nop 1
s_cmp_lg_u32 s91, 4
s_cbranch_scc1 L1_dspin_l
s_branch L1_dback
L1_pspin1:
s_mov_b32 s90, 0x40000
L1_pspin1_l:
s_sub_u32 s90, s90, 1
s_cbranch_scc1 L1_pback1
buffer_load_dwordx4 v[8:11], off, s[72:75], 0 sc1
s_waitcnt vmcnt(0)
v_min3_u32 v8, v8, v9, v10
v_min_u32 v8, v8, v11
v_cmp_gt_u32 vcc, 1, v8
s_nop 1
s_cbranch_vccnz L1_pspin1_l
s_branch L1_pback1
L1_pspin2:
s_mov_b32 s90, 0x40000
L1_pspin2_l:
s_sub_u32 s90, s90, 1
s_cbranch_scc1 L1_pback2
buffer_load_dwordx4 v[8:11], off, s[72:75], 0 sc1
s_waitcnt vmcnt(0)
v_min3_u32 v8, v8, v9, v10
v_min_u32 v8, v8, v11
v_cmp_gt_u32 vcc, 2, v8
s_nop 1
s_cbranch_vccnz L1_pspin2_l
s_branch L1_pback2
L1_pspin3:
s_mov_b32 s90, 0x40000
L1_pspin3_l:
s_sub_u32 s90, s90, 1
s_cbranch_scc1 L1_pback3
buffer_load_dwordx4 v[8:11], off, s[72:75], 0 sc1
s_waitcnt vmcnt(0)
v_min3_u32 v8, v8, v9, v10
v_min_u32 v8, v8, v11
v_cmp_gt_u32 vcc, 3, v8
s_nop 1
s_cbranch_vccnz L1_pspin3_l
s_branch L1_pback3
L1_rare:
s_nop 7
s_nop 7
v_max3_f32 v232, v32, v33, v34
v_max3_f32 v232, v232, v35, v48
v_max3_f32 v232, v232, v49, v50
v_max_f32 v232, v232, v51
v_mov_b32 v233, v232
s_nop 1
v_permlane32_swap_b32 v232, v233
v_max_f32 v232, v232, v233
v_mov_b32 v233, v232
s_nop 1
v_permlane16_swap_b32 v232, v233
v_max_f32 v232, v232, v233
v_max_f32 v232, s35, v232
v_max_f32 v233, 0, v232
v_exp_f32 v233, -v233
v_sub_f32 v192, v192, v232
v_sub_f32 v32, v32, v232
v_sub_f32 v48, v48, v232
v_sub_f32 v193, v193, v232
v_sub_f32 v33, v33, v232
v_sub_f32 v49, v49, v232
v_sub_f32 v194, v194, v232
v_sub_f32 v34, v34, v232
v_sub_f32 v50, v50, v232
v_sub_f32 v195, v195, v232
v_sub_f32 v35, v35, v232
v_sub_f32 v51, v51, v232
v_mul_f32 v208, v208, v233
v_accvgpr_read_b32 v234, a0
v_accvgpr_read_b32 v235, a1
v_accvgpr_read_b32 v236, a2
v_accvgpr_read_b32 v237, a3
v_mul_f32 v234, v234, v233
v_mul_f32 v235, v235, v233
v_mul_f32 v236, v236, v233
v_mul_f32 v237, v237, v233
v_accvgpr_write_b32 a0, v234
v_accvgpr_write_b32 a1, v235
v_accvgpr_write_b32 a2, v236
v_accvgpr_write_b32 a3, v237
v_accvgpr_read_b32 v234, a16
v_accvgpr_read_b32 v235, a17
v_accvgpr_read_b32 v236, a18
v_accvgpr_read_b32 v237, a19
v_mul_f32 v234, v234, v233
v_mul_f32 v235, v235, v233
v_mul_f32 v236, v236, v233
v_mul_f32 v237, v237, v233
v_accvgpr_write_b32 a16, v234
v_accvgpr_write_b32 a17, v235
v_accvgpr_write_b32 a18, v236
v_accvgpr_write_b32 a19, v237
v_accvgpr_read_b32 v234, a32
v_accvgpr_read_b32 v235, a33
v_accvgpr_read_b32 v236, a34
v_accvgpr_read_b32 v237, a35
v_mul_f32 v234, v234, v233
v_mul_f32 v235, v235, v233
v_mul_f32 v236, v236, v233
v_mul_f32 v237, v237, v233
v_accvgpr_write_b32 a32, v234
v_accvgpr_write_b32 a33, v235
v_accvgpr_write_b32 a34, v236
v_accvgpr_write_b32 a35, v237
v_accvgpr_read_b32 v234, a48
v_accvgpr_read_b32 v235, a49
v_accvgpr_read_b32 v236, a50
v_accvgpr_read_b32 v237, a51
v_mul_f32 v234, v234, v233
v_mul_f32 v235, v235, v233
v_mul_f32 v236, v236, v233
v_mul_f32 v237, v237, v233
v_accvgpr_write_b32 a48, v234
v_accvgpr_write_b32 a49, v235
v_accvgpr_write_b32 a50, v236
v_accvgpr_write_b32 a51, v237
v_accvgpr_read_b32 v234, a64
v_accvgpr_read_b32 v235, a65
v_accvgpr_read_b32 v236, a66
v_accvgpr_read_b32 v237, a67
v_mul_f32 v234, v234, v233
v_mul_f32 v235, v235, v233
v_mul_f32 v236, v236, v233
v_mul_f32 v237, v237, v233
v_accvgpr_write_b32 a64, v234
v_accvgpr_write_b32 a65, v235
v_accvgpr_write_b32 a66, v236
v_accvgpr_write_b32 a67, v237
v_accvgpr_read_b32 v234, a80
v_accvgpr_read_b32 v235, a81
v_accvgpr_read_b32 v236, a82
v_accvgpr_read_b32 v237, a83
v_mul_f32 v234, v234, v233
v_mul_f32 v235, v235, v233
v_mul_f32 v236, v236, v233
v_mul_f32 v237, v237, v233
v_accvgpr_write_b32 a80, v234
v_accvgpr_write_b32 a81, v235
v_accvgpr_write_b32 a82, v236
v_accvgpr_write_b32 a83, v237
v_accvgpr_read_b32 v234, a96
v_accvgpr_read_b32 v235, a97
v_accvgpr_read_b32 v236, a98
v_accvgpr_read_b32 v237, a99
v_mul_f32 v234, v234, v233
v_mul_f32 v235, v235, v233
v_mul_f32 v236, v236, v233
v_mul_f32 v237, v237, v233
v_accvgpr_write_b32 a96, v234
v_accvgpr_write_b32 a97, v235
v_accvgpr_write_b32 a98, v236
v_accvgpr_write_b32 a99, v237
v_accvgpr_read_b32 v234, a112
v_accvgpr_read_b32 v235, a113
v_accvgpr_read_b32 v236, a114
v_accvgpr_read_b32 v237, a115
v_mul_f32 v234, v234, v233
v_mul_f32 v235, v235, v233
v_mul_f32 v236, v236, v233
v_mul_f32 v237, v237, v233
v_accvgpr_write_b32 a112, v234
v_accvgpr_write_b32 a113, v235
v_accvgpr_write_b32 a114, v236
v_accvgpr_write_b32 a115, v237
v_accvgpr_read_b32 v234, a128
v_accvgpr_read_b32 v235, a129
v_accvgpr_read_b32 v236, a130
v_accvgpr_read_b32 v237, a131
v_mul_f32 v234, v234, v233
v_mul_f32 v235, v235, v233
v_mul_f32 v236, v236, v233
v_mul_f32 v237, v237, v233
v_accvgpr_write_b32 a128, v234
v_accvgpr_write_b32 a129, v235
v_accvgpr_write_b32 a130, v236
v_accvgpr_write_b32 a131, v237
v_accvgpr_read_b32 v234, a144
v_accvgpr_read_b32 v235, a145
v_accvgpr_read_b32 v236, a146
v_accvgpr_read_b32 v237, a147
v_mul_f32 v234, v234, v233
v_mul_f32 v235, v235, v233
v_mul_f32 v236, v236, v233
v_mul_f32 v237, v237, v233
v_accvgpr_write_b32 a144, v234
v_accvgpr_write_b32 a145, v235
v_accvgpr_write_b32 a146, v236
v_accvgpr_write_b32 a147, v237
v_accvgpr_read_b32 v234, a160
v_accvgpr_read_b32 v235, a161
v_accvgpr_read_b32 v236, a162
v_accvgpr_read_b32 v237, a163
v_mul_f32 v234, v234, v233
v_mul_f32 v235, v235, v233
v_mul_f32 v236, v236, v233
v_mul_f32 v237, v237, v233
v_accvgpr_write_b32 a160, v234
v_accvgpr_write_b32 a161, v235
v_accvgpr_write_b32 a162, v236
v_accvgpr_write_b32 a163, v237
v_accvgpr_read_b32 v234, a176
v_accvgpr_read_b32 v235, a177
v_accvgpr_read_b32 v236, a178
v_accvgpr_read_b32 v237, a179
v_mul_f32 v234, v234, v233
v_mul_f32 v235, v235, v233
v_mul_f32 v236, v236, v233
v_mul_f32 v237, v237, v233
v_accvgpr_write_b32 a176, v234
v_accvgpr_write_b32 a177, v235
v_accvgpr_write_b32 a178, v236
v_accvgpr_write_b32 a179, v237
v_max3_f32 v232, v36, v37, v38
v_max3_f32 v232, v232, v39, v52
v_max3_f32 v232, v232, v53, v54
v_max_f32 v232, v232, v55
v_mov_b32 v233, v232
s_nop 1
v_permlane32_swap_b32 v232, v233
v_max_f32 v232, v232, v233
v_mov_b32 v233, v232
s_nop 1
v_permlane16_swap_b32 v232, v233
v_max_f32 v232, v232, v233
v_max_f32 v232, s35, v232
v_max_f32 v233, 0, v232
v_exp_f32 v233, -v233
v_sub_f32 v196, v196, v232
v_sub_f32 v36, v36, v232
v_sub_f32 v52, v52, v232
v_sub_f32 v197, v197, v232
v_sub_f32 v37, v37, v232
v_sub_f32 v53, v53, v232
v_sub_f32 v198, v198, v232
v_sub_f32 v38, v38, v232
v_sub_f32 v54, v54, v232
v_sub_f32 v199, v199, v232
v_sub_f32 v39, v39, v232
v_sub_f32 v55, v55, v232
v_mul_f32 v209, v209, v233
v_accvgpr_read_b32 v234, a4
v_accvgpr_read_b32 v235, a5
v_accvgpr_read_b32 v236, a6
v_accvgpr_read_b32 v237, a7
v_mul_f32 v234, v234, v233
v_mul_f32 v235, v235, v233
v_mul_f32 v236, v236, v233
v_mul_f32 v237, v237, v233
v_accvgpr_write_b32 a4, v234
v_accvgpr_write_b32 a5, v235
v_accvgpr_write_b32 a6, v236
v_accvgpr_write_b32 a7, v237
v_accvgpr_read_b32 v234, a20
v_accvgpr_read_b32 v235, a21
v_accvgpr_read_b32 v236, a22
v_accvgpr_read_b32 v237, a23
v_mul_f32 v234, v234, v233
v_mul_f32 v235, v235, v233
v_mul_f32 v236, v236, v233
v_mul_f32 v237, v237, v233
v_accvgpr_write_b32 a20, v234
v_accvgpr_write_b32 a21, v235
v_accvgpr_write_b32 a22, v236
v_accvgpr_write_b32 a23, v237
v_accvgpr_read_b32 v234, a36
v_accvgpr_read_b32 v235, a37
v_accvgpr_read_b32 v236, a38
v_accvgpr_read_b32 v237, a39
v_mul_f32 v234, v234, v233
v_mul_f32 v235, v235, v233
v_mul_f32 v236, v236, v233
v_mul_f32 v237, v237, v233
v_accvgpr_write_b32 a36, v234
v_accvgpr_write_b32 a37, v235
v_accvgpr_write_b32 a38, v236
v_accvgpr_write_b32 a39, v237
v_accvgpr_read_b32 v234, a52
v_accvgpr_read_b32 v235, a53
v_accvgpr_read_b32 v236, a54
v_accvgpr_read_b32 v237, a55
v_mul_f32 v234, v234, v233
v_mul_f32 v235, v235, v233
v_mul_f32 v236, v236, v233
v_mul_f32 v237, v237, v233
v_accvgpr_write_b32 a52, v234
v_accvgpr_write_b32 a53, v235
v_accvgpr_write_b32 a54, v236
v_accvgpr_write_b32 a55, v237
v_accvgpr_read_b32 v234, a68
v_accvgpr_read_b32 v235, a69
v_accvgpr_read_b32 v236, a70
v_accvgpr_read_b32 v237, a71
v_mul_f32 v234, v234, v233
v_mul_f32 v235, v235, v233
v_mul_f32 v236, v236, v233
v_mul_f32 v237, v237, v233
v_accvgpr_write_b32 a68, v234
v_accvgpr_write_b32 a69, v235
v_accvgpr_write_b32 a70, v236
v_accvgpr_write_b32 a71, v237
v_accvgpr_read_b32 v234, a84
v_accvgpr_read_b32 v235, a85
v_accvgpr_read_b32 v236, a86
v_accvgpr_read_b32 v237, a87
v_mul_f32 v234, v234, v233
v_mul_f32 v235, v235, v233
v_mul_f32 v236, v236, v233
v_mul_f32 v237, v237, v233
v_accvgpr_write_b32 a84, v234
v_accvgpr_write_b32 a85, v235
v_accvgpr_write_b32 a86, v236
v_accvgpr_write_b32 a87, v237
v_accvgpr_read_b32 v234, a100
v_accvgpr_read_b32 v235, a101
v_accvgpr_read_b32 v236, a102
v_accvgpr_read_b32 v237, a103
v_mul_f32 v234, v234, v233
v_mul_f32 v235, v235, v233
v_mul_f32 v236, v236, v233
v_mul_f32 v237, v237, v233
v_accvgpr_write_b32 a100, v234
v_accvgpr_write_b32 a101, v235
v_accvgpr_write_b32 a102, v236
v_accvgpr_write_b32 a103, v237
v_accvgpr_read_b32 v234, a116
v_accvgpr_read_b32 v235, a117
v_accvgpr_read_b32 v236, a118
v_accvgpr_read_b32 v237, a119
v_mul_f32 v234, v234, v233
v_mul_f32 v235, v235, v233
v_mul_f32 v236, v236, v233
v_mul_f32 v237, v237, v233
v_accvgpr_write_b32 a116, v234
v_accvgpr_write_b32 a117, v235
v_accvgpr_write_b32 a118, v236
v_accvgpr_write_b32 a119, v237
v_accvgpr_read_b32 v234, a132
v_accvgpr_read_b32 v235, a133
v_accvgpr_read_b32 v236, a134
v_accvgpr_read_b32 v237, a135
v_mul_f32 v234, v234, v233
v_mul_f32 v235, v235, v233
v_mul_f32 v236, v236, v233
v_mul_f32 v237, v237, v233
v_accvgpr_write_b32 a132, v234
v_accvgpr_write_b32 a133, v235
v_accvgpr_write_b32 a134, v236
v_accvgpr_write_b32 a135, v237
v_accvgpr_read_b32 v234, a148
v_accvgpr_read_b32 v235, a149
v_accvgpr_read_b32 v236, a150
v_accvgpr_read_b32 v237, a151
v_mul_f32 v234, v234, v233
v_mul_f32 v235, v235, v233
v_mul_f32 v236, v236, v233
v_mul_f32 v237, v237, v233
v_accvgpr_write_b32 a148, v234
v_accvgpr_write_b32 a149, v235
v_accvgpr_write_b32 a150, v236
v_accvgpr_write_b32 a151, v237
v_accvgpr_read_b32 v234, a164
v_accvgpr_read_b32 v235, a165
v_accvgpr_read_b32 v236, a166
v_accvgpr_read_b32 v237, a167
v_mul_f32 v234, v234, v233
v_mul_f32 v235, v235, v233
v_mul_f32 v236, v236, v233
v_mul_f32 v237, v237, v233
v_accvgpr_write_b32 a164, v234
v_accvgpr_write_b32 a165, v235
v_accvgpr_write_b32 a166, v236
v_accvgpr_write_b32 a167, v237
v_accvgpr_read_b32 v234, a180
v_accvgpr_read_b32 v235, a181
v_accvgpr_read_b32 v236, a182
v_accvgpr_read_b32 v237, a183
v_mul_f32 v234, v234, v233
v_mul_f32 v235, v235, v233
v_mul_f32 v236, v236, v233
v_mul_f32 v237, v237, v233
v_accvgpr_write_b32 a180, v234
v_accvgpr_write_b32 a181, v235
v_accvgpr_write_b32 a182, v236
v_accvgpr_write_b32 a183, v237
v_max3_f32 v232, v40, v41, v42
v_max3_f32 v232, v232, v43, v56
v_max3_f32 v232, v232, v57, v58
v_max_f32 v232, v232, v59
v_mov_b32 v233, v232
s_nop 1
v_permlane32_swap_b32 v232, v233
v_max_f32 v232, v232, v233
v_mov_b32 v233, v232
s_nop 1
v_permlane16_swap_b32 v232, v233
v_max_f32 v232, v232, v233
v_max_f32 v232, s35, v232
v_max_f32 v233, 0, v232
v_exp_f32 v233, -v233
v_sub_f32 v200, v200, v232
v_sub_f32 v40, v40, v232
v_sub_f32 v56, v56, v232
v_sub_f32 v201, v201, v232
v_sub_f32 v41, v41, v232
v_sub_f32 v57, v57, v232
v_sub_f32 v202, v202, v232
v_sub_f32 v42, v42, v232
v_sub_f32 v58, v58, v232
v_sub_f32 v203, v203, v232
v_sub_f32 v43, v43, v232
v_sub_f32 v59, v59, v232
v_mul_f32 v210, v210, v233
v_accvgpr_read_b32 v234, a8
v_accvgpr_read_b32 v235, a9
v_accvgpr_read_b32 v236, a10
v_accvgpr_read_b32 v237, a11
v_mul_f32 v234, v234, v233
v_mul_f32 v235, v235, v233
v_mul_f32 v236, v236, v233
v_mul_f32 v237, v237, v233
v_accvgpr_write_b32 a8, v234
v_accvgpr_write_b32 a9, v235
v_accvgpr_write_b32 a10, v236
v_accvgpr_write_b32 a11, v237
v_accvgpr_read_b32 v234, a24
v_accvgpr_read_b32 v235, a25
v_accvgpr_read_b32 v236, a26
v_accvgpr_read_b32 v237, a27
v_mul_f32 v234, v234, v233
v_mul_f32 v235, v235, v233
v_mul_f32 v236, v236, v233
v_mul_f32 v237, v237, v233
v_accvgpr_write_b32 a24, v234
v_accvgpr_write_b32 a25, v235
v_accvgpr_write_b32 a26, v236
v_accvgpr_write_b32 a27, v237
v_accvgpr_read_b32 v234, a40
v_accvgpr_read_b32 v235, a41
v_accvgpr_read_b32 v236, a42
v_accvgpr_read_b32 v237, a43
v_mul_f32 v234, v234, v233
v_mul_f32 v235, v235, v233
v_mul_f32 v236, v236, v233
v_mul_f32 v237, v237, v233
v_accvgpr_write_b32 a40, v234
v_accvgpr_write_b32 a41, v235
v_accvgpr_write_b32 a42, v236
v_accvgpr_write_b32 a43, v237
v_accvgpr_read_b32 v234, a56
v_accvgpr_read_b32 v235, a57
v_accvgpr_read_b32 v236, a58
v_accvgpr_read_b32 v237, a59
v_mul_f32 v234, v234, v233
v_mul_f32 v235, v235, v233
v_mul_f32 v236, v236, v233
v_mul_f32 v237, v237, v233
v_accvgpr_write_b32 a56, v234
v_accvgpr_write_b32 a57, v235
v_accvgpr_write_b32 a58, v236
v_accvgpr_write_b32 a59, v237
v_accvgpr_read_b32 v234, a72
v_accvgpr_read_b32 v235, a73
v_accvgpr_read_b32 v236, a74
v_accvgpr_read_b32 v237, a75
v_mul_f32 v234, v234, v233
v_mul_f32 v235, v235, v233
v_mul_f32 v236, v236, v233
v_mul_f32 v237, v237, v233
v_accvgpr_write_b32 a72, v234
v_accvgpr_write_b32 a73, v235
v_accvgpr_write_b32 a74, v236
v_accvgpr_write_b32 a75, v237
v_accvgpr_read_b32 v234, a88
v_accvgpr_read_b32 v235, a89
v_accvgpr_read_b32 v236, a90
v_accvgpr_read_b32 v237, a91
v_mul_f32 v234, v234, v233
v_mul_f32 v235, v235, v233
v_mul_f32 v236, v236, v233
v_mul_f32 v237, v237, v233
v_accvgpr_write_b32 a88, v234
v_accvgpr_write_b32 a89, v235
v_accvgpr_write_b32 a90, v236
v_accvgpr_write_b32 a91, v237
v_accvgpr_read_b32 v234, a104
v_accvgpr_read_b32 v235, a105
v_accvgpr_read_b32 v236, a106
v_accvgpr_read_b32 v237, a107
v_mul_f32 v234, v234, v233
v_mul_f32 v235, v235, v233
v_mul_f32 v236, v236, v233
v_mul_f32 v237, v237, v233
v_accvgpr_write_b32 a104, v234
v_accvgpr_write_b32 a105, v235
v_accvgpr_write_b32 a106, v236
v_accvgpr_write_b32 a107, v237
v_accvgpr_read_b32 v234, a120
v_accvgpr_read_b32 v235, a121
v_accvgpr_read_b32 v236, a122
v_accvgpr_read_b32 v237, a123
v_mul_f32 v234, v234, v233
v_mul_f32 v235, v235, v233
v_mul_f32 v236, v236, v233
v_mul_f32 v237, v237, v233
v_accvgpr_write_b32 a120, v234
v_accvgpr_write_b32 a121, v235
v_accvgpr_write_b32 a122, v236
v_accvgpr_write_b32 a123, v237
v_accvgpr_read_b32 v234, a136
v_accvgpr_read_b32 v235, a137
v_accvgpr_read_b32 v236, a138
v_accvgpr_read_b32 v237, a139
v_mul_f32 v234, v234, v233
v_mul_f32 v235, v235, v233
v_mul_f32 v236, v236, v233
v_mul_f32 v237, v237, v233
v_accvgpr_write_b32 a136, v234
v_accvgpr_write_b32 a137, v235
v_accvgpr_write_b32 a138, v236
v_accvgpr_write_b32 a139, v237
v_accvgpr_read_b32 v234, a152
v_accvgpr_read_b32 v235, a153
v_accvgpr_read_b32 v236, a154
v_accvgpr_read_b32 v237, a155
v_mul_f32 v234, v234, v233
v_mul_f32 v235, v235, v233
v_mul_f32 v236, v236, v233
v_mul_f32 v237, v237, v233
v_accvgpr_write_b32 a152, v234
v_accvgpr_write_b32 a153, v235
v_accvgpr_write_b32 a154, v236
v_accvgpr_write_b32 a155, v237
v_accvgpr_read_b32 v234, a168
v_accvgpr_read_b32 v235, a169
v_accvgpr_read_b32 v236, a170
v_accvgpr_read_b32 v237, a171
v_mul_f32 v234, v234, v233
v_mul_f32 v235, v235, v233
v_mul_f32 v236, v236, v233
v_mul_f32 v237, v237, v233
v_accvgpr_write_b32 a168, v234
v_accvgpr_write_b32 a169, v235
v_accvgpr_write_b32 a170, v236
v_accvgpr_write_b32 a171, v237
v_accvgpr_read_b32 v234, a184
v_accvgpr_read_b32 v235, a185
v_accvgpr_read_b32 v236, a186
v_accvgpr_read_b32 v237, a187
v_mul_f32 v234, v234, v233
v_mul_f32 v235, v235, v233
v_mul_f32 v236, v236, v233
v_mul_f32 v237, v237, v233
v_accvgpr_write_b32 a184, v234
v_accvgpr_write_b32 a185, v235
v_accvgpr_write_b32 a186, v236
v_accvgpr_write_b32 a187, v237
v_max3_f32 v232, v44, v45, v46
v_max3_f32 v232, v232, v47, v60
v_max3_f32 v232, v232, v61, v62
v_max_f32 v232, v232, v63
v_mov_b32 v233, v232
s_nop 1
v_permlane32_swap_b32 v232, v233
v_max_f32 v232, v232, v233
v_mov_b32 v233, v232
s_nop 1
v_permlane16_swap_b32 v232, v233
v_max_f32 v232, v232, v233
v_max_f32 v232, s35, v232
v_max_f32 v233, 0, v232
v_exp_f32 v233, -v233
v_sub_f32 v204, v204, v232
v_sub_f32 v44, v44, v232
v_sub_f32 v60, v60, v232
v_sub_f32 v205, v205, v232
v_sub_f32 v45, v45, v232
v_sub_f32 v61, v61, v232
v_sub_f32 v206, v206, v232
v_sub_f32 v46, v46, v232
v_sub_f32 v62, v62, v232
v_sub_f32 v207, v207, v232
v_sub_f32 v47, v47, v232
v_sub_f32 v63, v63, v232
v_mul_f32 v211, v211, v233
v_accvgpr_read_b32 v234, a12
v_accvgpr_read_b32 v235, a13
v_accvgpr_read_b32 v236, a14
v_accvgpr_read_b32 v237, a15
v_mul_f32 v234, v234, v233
v_mul_f32 v235, v235, v233
v_mul_f32 v236, v236, v233
v_mul_f32 v237, v237, v233
v_accvgpr_write_b32 a12, v234
v_accvgpr_write_b32 a13, v235
v_accvgpr_write_b32 a14, v236
v_accvgpr_write_b32 a15, v237
v_accvgpr_read_b32 v234, a28
v_accvgpr_read_b32 v235, a29
v_accvgpr_read_b32 v236, a30
v_accvgpr_read_b32 v237, a31
v_mul_f32 v234, v234, v233
v_mul_f32 v235, v235, v233
v_mul_f32 v236, v236, v233
v_mul_f32 v237, v237, v233
v_accvgpr_write_b32 a28, v234
v_accvgpr_write_b32 a29, v235
v_accvgpr_write_b32 a30, v236
v_accvgpr_write_b32 a31, v237
v_accvgpr_read_b32 v234, a44
v_accvgpr_read_b32 v235, a45
v_accvgpr_read_b32 v236, a46
v_accvgpr_read_b32 v237, a47
v_mul_f32 v234, v234, v233
v_mul_f32 v235, v235, v233
v_mul_f32 v236, v236, v233
v_mul_f32 v237, v237, v233
v_accvgpr_write_b32 a44, v234
v_accvgpr_write_b32 a45, v235
v_accvgpr_write_b32 a46, v236
v_accvgpr_write_b32 a47, v237
v_accvgpr_read_b32 v234, a60
v_accvgpr_read_b32 v235, a61
v_accvgpr_read_b32 v236, a62
v_accvgpr_read_b32 v237, a63
v_mul_f32 v234, v234, v233
v_mul_f32 v235, v235, v233
v_mul_f32 v236, v236, v233
v_mul_f32 v237, v237, v233
v_accvgpr_write_b32 a60, v234
v_accvgpr_write_b32 a61, v235
v_accvgpr_write_b32 a62, v236
v_accvgpr_write_b32 a63, v237
v_accvgpr_read_b32 v234, a76
v_accvgpr_read_b32 v235, a77
v_accvgpr_read_b32 v236, a78
v_accvgpr_read_b32 v237, a79
v_mul_f32 v234, v234, v233
v_mul_f32 v235, v235, v233
v_mul_f32 v236, v236, v233
v_mul_f32 v237, v237, v233
v_accvgpr_write_b32 a76, v234
v_accvgpr_write_b32 a77, v235
v_accvgpr_write_b32 a78, v236
v_accvgpr_write_b32 a79, v237
v_accvgpr_read_b32 v234, a92
v_accvgpr_read_b32 v235, a93
v_accvgpr_read_b32 v236, a94
v_accvgpr_read_b32 v237, a95
v_mul_f32 v234, v234, v233
v_mul_f32 v235, v235, v233
v_mul_f32 v236, v236, v233
v_mul_f32 v237, v237, v233
v_accvgpr_write_b32 a92, v234
v_accvgpr_write_b32 a93, v235
v_accvgpr_write_b32 a94, v236
v_accvgpr_write_b32 a95, v237
v_accvgpr_read_b32 v234, a108
v_accvgpr_read_b32 v235, a109
v_accvgpr_read_b32 v236, a110
v_accvgpr_read_b32 v237, a111
v_mul_f32 v234, v234, v233
v_mul_f32 v235, v235, v233
v_mul_f32 v236, v236, v233
v_mul_f32 v237, v237, v233
v_accvgpr_write_b32 a108, v234
v_accvgpr_write_b32 a109, v235
v_accvgpr_write_b32 a110, v236
v_accvgpr_write_b32 a111, v237
v_accvgpr_read_b32 v234, a124
v_accvgpr_read_b32 v235, a125
v_accvgpr_read_b32 v236, a126
v_accvgpr_read_b32 v237, a127
v_mul_f32 v234, v234, v233
v_mul_f32 v235, v235, v233
v_mul_f32 v236, v236, v233
v_mul_f32 v237, v237, v233
v_accvgpr_write_b32 a124, v234
v_accvgpr_write_b32 a125, v235
v_accvgpr_write_b32 a126, v236
v_accvgpr_write_b32 a127, v237
v_accvgpr_read_b32 v234, a140
v_accvgpr_read_b32 v235, a141
v_accvgpr_read_b32 v236, a142
v_accvgpr_read_b32 v237, a143
v_mul_f32 v234, v234, v233
v_mul_f32 v235, v235, v233
v_mul_f32 v236, v236, v233
v_mul_f32 v237, v237, v233
v_accvgpr_write_b32 a140, v234
v_accvgpr_write_b32 a141, v235
v_accvgpr_write_b32 a142, v236
v_accvgpr_write_b32 a143, v237
v_accvgpr_read_b32 v234, a156
v_accvgpr_read_b32 v235, a157
v_accvgpr_read_b32 v236, a158
v_accvgpr_read_b32 v237, a159
v_mul_f32 v234, v234, v233
v_mul_f32 v235, v235, v233
v_mul_f32 v236, v236, v233
v_mul_f32 v237, v237, v233
v_accvgpr_write_b32 a156, v234
v_accvgpr_write_b32 a157, v235
v_accvgpr_write_b32 a158, v236
v_accvgpr_write_b32 a159, v237
v_accvgpr_read_b32 v234, a172
v_accvgpr_read_b32 v235, a173
v_accvgpr_read_b32 v236, a174
v_accvgpr_read_b32 v237, a175
v_mul_f32 v234, v234, v233
v_mul_f32 v235, v235, v233
v_mul_f32 v236, v236, v233
v_mul_f32 v237, v237, v233
v_accvgpr_write_b32 a172, v234
v_accvgpr_write_b32 a173, v235
v_accvgpr_write_b32 a174, v236
v_accvgpr_write_b32 a175, v237
v_accvgpr_read_b32 v234, a188
v_accvgpr_read_b32 v235, a189
v_accvgpr_read_b32 v236, a190
v_accvgpr_read_b32 v237, a191
v_mul_f32 v234, v234, v233
v_mul_f32 v235, v235, v233
v_mul_f32 v236, v236, v233
v_mul_f32 v237, v237, v233
v_accvgpr_write_b32 a188, v234
v_accvgpr_write_b32 a189, v235
v_accvgpr_write_b32 a190, v236
v_accvgpr_write_b32 a191, v237
s_cmp_eq_u32 s36, 1
s_cbranch_scc1 L1_rare1
v_exp_f32 v216, v32
v_exp_f32 v217, v33
v_exp_f32 v218, v34
v_exp_f32 v219, v35
v_add_f32 v212, v216, v217
v_cvt_pk_bf16_f32 v160, v216, v217
v_add_f32 v212, v212, v218
v_add_f32 v212, v212, v219
v_cvt_pk_bf16_f32 v161, v218, v219
v_exp_f32 v220, v36
v_exp_f32 v221, v37
v_exp_f32 v222, v38
v_exp_f32 v223, v39
v_add_f32 v213, v220, v221
v_cvt_pk_bf16_f32 v164, v220, v221
v_add_f32 v213, v213, v222
v_add_f32 v213, v213, v223
v_cvt_pk_bf16_f32 v165, v222, v223
v_exp_f32 v224, v40
v_exp_f32 v225, v41
v_exp_f32 v226, v42
v_exp_f32 v227, v43
v_add_f32 v214, v224, v225
v_cvt_pk_bf16_f32 v168, v224, v225
v_add_f32 v214, v214, v226
v_add_f32 v214, v214, v227
v_cvt_pk_bf16_f32 v169, v226, v227
v_exp_f32 v228, v44
v_exp_f32 v229, v45
v_exp_f32 v230, v46
v_exp_f32 v231, v47
v_add_f32 v215, v228, v229
v_cvt_pk_bf16_f32 v172, v228, v229
v_add_f32 v215, v215, v230
v_add_f32 v215, v215, v231
v_cvt_pk_bf16_f32 v173, v230, v231
v_exp_f32 v216, v48
v_exp_f32 v217, v49
v_exp_f32 v218, v50
v_exp_f32 v219, v51
v_add_f32 v212, v212, v216
v_add_f32 v212, v212, v217
v_cvt_pk_bf16_f32 v162, v216, v217
v_add_f32 v212, v212, v218
v_add_f32 v212, v212, v219
v_cvt_pk_bf16_f32 v163, v218, v219
v_exp_f32 v220, v52
v_exp_f32 v221, v53
v_exp_f32 v222, v54
v_exp_f32 v223, v55
v_add_f32 v213, v213, v220
v_add_f32 v213, v213, v221
v_cvt_pk_bf16_f32 v166, v220, v221
v_add_f32 v213, v213, v222
v_add_f32 v213, v213, v223
v_cvt_pk_bf16_f32 v167, v222, v223
s_nop 3
s_setpc_b64 s[38:39]
L1_rare1:
v_exp_f32 v216, v32
v_exp_f32 v217, v33
v_exp_f32 v218, v34
v_exp_f32 v219, v35
v_add_f32 v212, v216, v217
v_cvt_pk_bf16_f32 v176, v216, v217
v_add_f32 v212, v212, v218
v_add_f32 v212, v212, v219
v_cvt_pk_bf16_f32 v177, v218, v219
v_exp_f32 v220, v36
v_exp_f32 v221, v37
v_exp_f32 v222, v38
v_exp_f32 v223, v39
v_add_f32 v213, v220, v221
v_cvt_pk_bf16_f32 v180, v220, v221
v_add_f32 v213, v213, v222
v_add_f32 v213, v213, v223
v_cvt_pk_bf16_f32 v181, v222, v223
v_exp_f32 v224, v40
v_exp_f32 v225, v41
v_exp_f32 v226, v42
v_exp_f32 v227, v43
v_add_f32 v214, v224, v225
v_cvt_pk_bf16_f32 v184, v224, v225
v_add_f32 v214, v214, v226
v_add_f32 v214, v214, v227
v_cvt_pk_bf16_f32 v185, v226, v227
v_exp_f32 v228, v44
v_exp_f32 v229, v45
v_exp_f32 v230, v46
v_exp_f32 v231, v47
v_add_f32 v215, v228, v229
v_cvt_pk_bf16_f32 v188, v228, v229
v_add_f32 v215, v215, v230
v_add_f32 v215, v215, v231
v_cvt_pk_bf16_f32 v189, v230, v231
v_exp_f32 v216, v48
v_exp_f32 v217, v49
v_exp_f32 v218, v50
v_exp_f32 v219, v51
v_add_f32 v212, v212, v216
v_add_f32 v212, v212, v217
v_cvt_pk_bf16_f32 v178, v216, v217
v_add_f32 v212, v212, v218
v_add_f32 v212, v212, v219
v_cvt_pk_bf16_f32 v179, v218, v219
v_exp_f32 v220, v52
v_exp_f32 v221, v53
v_exp_f32 v222, v54
v_exp_f32 v223, v55
v_add_f32 v213, v213, v220
v_add_f32 v213, v213, v221
v_cvt_pk_bf16_f32 v182, v220, v221
v_add_f32 v213, v213, v222
v_add_f32 v213, v213, v223
v_cvt_pk_bf16_f32 v183, v222, v223
s_nop 3
s_setpc_b64 s[38:39]
L1_stubf:
s_mov_b32 s36, 0
s_call_b64 s[38:39], L1_rare
s_branch L1_backf
L1_stubp:
s_mov_b32 s36, 1
s_call_b64 s[38:39], L1_rare
s_branch L1_backp
L1_stub0:
s_mov_b32 s36, 0
s_call_b64 s[38:39], L1_rare
s_branch L1_back0
L1_stub1:
s_mov_b32 s36, 1
s_call_b64 s[38:39], L1_rare
s_branch L1_back1
L1_stub2:
s_mov_b32 s36, 0
s_call_b64 s[38:39], L1_rare
s_branch L1_back2
L1_stub3:
s_mov_b32 s36, 1
s_call_b64 s[38:39], L1_rare
s_branch L1_back3
L1_stub4:
s_mov_b32 s36, 0
s_call_b64 s[38:39], L1_rare
s_branch L1_back4
L1_stub5:
s_mov_b32 s36, 1
s_call_b64 s[38:39], L1_rare
s_branch L1_back5
L1_stubt25:
s_mov_b32 s36, 0
s_call_b64 s[38:39], L1_rare
s_branch L1_backt25
L1_stubt26:
s_mov_b32 s36, 1
s_call_b64 s[38:39], L1_rare
s_branch L1_backt26
L1_stubt27:
s_mov_b32 s36, 0
s_call_b64 s[38:39], L1_rare
s_branch L1_backt27
L1_stubt28:
s_mov_b32 s36, 1
s_call_b64 s[38:39], L1_rare
s_branch L1_backt28
L1_stubt29:
s_mov_b32 s36, 0
s_call_b64 s[38:39], L1_rare
s_branch L1_backt29
L1_stubt30:
s_mov_b32 s36, 1
s_call_b64 s[38:39], L1_rare
s_branch L1_backt30
.globl reduce_kernel
.p2align 8
.type reduce_kernel,@function
reduce_kernel:
s_cmp_ge_u32 s2, 600
s_cbranch_scc1 L3_end
s_load_dwordx2 s[16:17], s[0:1], 40
s_load_dwordx2 s[18:19], s[0:1], 56
v_lshrrev_b32 v1, 6, v0
v_lshlrev_b32 v2, 4, v0
v_readfirstlane_b32 s3, v1
s_lshl_b32 s20, s2, 12
v_add_u32 v2, s20, v2
s_lshl_b32 s20, s2, 2
s_add_u32 s20, s20, s3
s_mul_i32 s21, s20, 3496
s_lshr_b32 s21, s21, 18
s_mul_i32 s22, s21, 75
s_sub_u32 s22, s20, s22
s_mul_i32 s23, s22, 205
s_lshr_b32 s23, s23, 10
s_mul_i32 s24, s23, 5
s_sub_u32 s24, s22, s24
s_mov_b32 s6, 19660800
s_mov_b32 s7, 0x20000
s_mov_b32 s10, 2457600
s_mov_b32 s11, 0x20000
s_mov_b32 s32, 0
s_mov_b32 s33, 2457600
s_mov_b32 s34, 4915200
s_mov_b32 s35, 7372800
s_mov_b32 s36, 9830400
s_mov_b32 s37, 12288000
s_mov_b32 s38, 14745600
s_mov_b32 s39, 17203200
s_waitcnt lgkmcnt(0)
s_add_u32 s4, s18, 23592960
s_addc_u32 s5, s19, 0
s_mov_b32 s8, s16
s_mov_b32 s9, s17
buffer_load_dwordx4 v[8:11], v2, s[4:7], s32 offen nt
buffer_load_dwordx4 v[12:15], v2, s[4:7], s33 offen nt
buffer_load_dwordx4 v[16:19], v2, s[4:7], s34 offen nt
buffer_load_dwordx4 v[20:23], v2, s[4:7], s35 offen nt
buffer_load_dwordx4 v[24:27], v2, s[4:7], s36 offen nt
buffer_load_dwordx4 v[28:31], v2, s[4:7], s37 offen nt
buffer_load_dwordx4 v[32:35], v2, s[4:7], s38 offen nt
buffer_load_dwordx4 v[36:39], v2, s[4:7], s39 offen nt
s_lshr_b32 s25, s21, 2
s_and_b32 s26, s21, 3
s_mul_i32 s25, s25, 307200
s_mul_i32 s23, s23, 20480
s_add_u32 s25, s25, s23
s_mul_i32 s26, s26, 320
s_lshl_b32 s24, s24, 6
s_add_u32 s25, s25, s26
s_add_u32 s25, s25, s24
v_and_b32 v3, 15, v0
v_mul_u32_u24 v3, 1280, v3
v_bfe_u32 v4, v0, 4, 2
v_lshl_add_u32 v3, v4, 4, v3
s_mov_b32 s27, 0xffff0000
s_waitcnt vmcnt(7)
v_lshlrev_b32 v40, 16, v8
v_and_b32 v41, s27, v8
v_lshlrev_b32 v42, 16, v9
v_and_b32 v43, s27, v9
v_lshlrev_b32 v44, 16, v10
v_and_b32 v45, s27, v10
v_lshlrev_b32 v46, 16, v11
v_and_b32 v47, s27, v11
s_waitcnt vmcnt(6)
v_lshlrev_b32 v48, 16, v12
v_and_b32 v49, s27, v12
v_add_f32 v40, v40, v48
v_add_f32 v41, v41, v49
v_lshlrev_b32 v50, 16, v13
v_and_b32 v51, s27, v13
v_add_f32 v42, v42, v50
v_add_f32 v43, v43, v51
v_lshlrev_b32 v52, 16, v14
v_and_b32 v53, s27, v14
v_add_f32 v44, v44, v52
v_add_f32 v45, v45, v53
v_lshlrev_b32 v54, 16, v15
v_and_b32 v55, s27, v15
v_add_f32 v46, v46, v54
v_add_f32 v47, v47, v55
s_waitcnt vmcnt(5)
v_lshlrev_b32 v48, 16, v16
v_and_b32 v49, s27, v16
v_add_f32 v40, v40, v48
v_add_f32 v41, v41, v49
v_lshlrev_b32 v50, 16, v17
v_and_b32 v51, s27, v17
v_add_f32 v42, v42, v50
v_add_f32 v43, v43, v51
v_lshlrev_b32 v52, 16, v18
v_and_b32 v53, s27, v18
v_add_f32 v44, v44, v52
v_add_f32 v45, v45, v53
v_lshlrev_b32 v54, 16, v19
v_and_b32 v55, s27, v19
v_add_f32 v46, v46, v54
v_add_f32 v47, v47, v55
s_waitcnt vmcnt(4)
v_lshlrev_b32 v48, 16, v20
v_and_b32 v49, s27, v20
v_add_f32 v40, v40, v48
v_add_f32 v41, v41, v49
v_lshlrev_b32 v50, 16, v21
v_and_b32 v51, s27, v21
v_add_f32 v42, v42, v50
v_add_f32 v43, v43, v51
v_lshlrev_b32 v52, 16, v22
v_and_b32 v53, s27, v22
v_add_f32 v44, v44, v52
v_add_f32 v45, v45, v53
v_lshlrev_b32 v54, 16, v23
v_and_b32 v55, s27, v23
v_add_f32 v46, v46, v54
v_add_f32 v47, v47, v55
s_waitcnt vmcnt(3)
v_lshlrev_b32 v48, 16, v24
v_and_b32 v49, s27, v24
v_add_f32 v40, v40, v48
v_add_f32 v41, v41, v49
v_lshlrev_b32 v50, 16, v25
v_and_b32 v51, s27, v25
v_add_f32 v42, v42, v50
v_add_f32 v43, v43, v51
v_lshlrev_b32 v52, 16, v26
v_and_b32 v53, s27, v26
v_add_f32 v44, v44, v52
v_add_f32 v45, v45, v53
v_lshlrev_b32 v54, 16, v27
v_and_b32 v55, s27, v27
v_add_f32 v46, v46, v54
v_add_f32 v47, v47, v55
s_waitcnt vmcnt(2)
v_lshlrev_b32 v48, 16, v28
v_and_b32 v49, s27, v28
v_add_f32 v40, v40, v48
v_add_f32 v41, v41, v49
v_lshlrev_b32 v50, 16, v29
v_and_b32 v51, s27, v29
v_add_f32 v42, v42, v50
v_add_f32 v43, v43, v51
v_lshlrev_b32 v52, 16, v30
v_and_b32 v53, s27, v30
v_add_f32 v44, v44, v52
v_add_f32 v45, v45, v53
v_lshlrev_b32 v54, 16, v31
v_and_b32 v55, s27, v31
v_add_f32 v46, v46, v54
v_add_f32 v47, v47, v55
s_waitcnt vmcnt(1)
v_lshlrev_b32 v48, 16, v32
v_and_b32 v49, s27, v32
v_add_f32 v40, v40, v48
v_add_f32 v41, v41, v49
v_lshlrev_b32 v50, 16, v33
v_and_b32 v51, s27, v33
v_add_f32 v42, v42, v50
v_add_f32 v43, v43, v51
v_lshlrev_b32 v52, 16, v34
v_and_b32 v53, s27, v34
v_add_f32 v44, v44, v52
v_add_f32 v45, v45, v53
v_lshlrev_b32 v54, 16, v35
v_and_b32 v55, s27, v35
v_add_f32 v46, v46, v54
v_add_f32 v47, v47, v55
s_waitcnt vmcnt(0)
v_lshlrev_b32 v48, 16, v36
v_and_b32 v49, s27, v36
v_add_f32 v40, v40, v48
v_add_f32 v41, v41, v49
v_lshlrev_b32 v50, 16, v37
v_and_b32 v51, s27, v37
v_add_f32 v42, v42, v50
v_add_f32 v43, v43, v51
v_lshlrev_b32 v52, 16, v38
v_and_b32 v53, s27, v38
v_add_f32 v44, v44, v52
v_add_f32 v45, v45, v53
v_lshlrev_b32 v54, 16, v39
v_and_b32 v55, s27, v39
v_add_f32 v46, v46, v54
v_add_f32 v47, v47, v55
v_cvt_pk_bf16_f32 v56, v40, v41
v_cvt_pk_bf16_f32 v57, v42, v43
v_cvt_pk_bf16_f32 v58, v44, v45
v_cvt_pk_bf16_f32 v59, v46, v47
buffer_store_dwordx4 v[56:59], v3, s[8:11], s25 offen
L3_end:
s_endpgm
.section .rodata,"a"
.p2align 6
.amdhsa_kernel standalone__gqa_block_cached__near_ridge_kernel
  .amdhsa_next_free_vgpr 512
  .amdhsa_next_free_sgpr 102
  .amdhsa_accum_offset 256
  .amdhsa_group_segment_fixed_size 0
  .amdhsa_kernarg_size 64
  .amdhsa_user_sgpr_count 2
  .amdhsa_user_sgpr_kernarg_segment_ptr 1
  .amdhsa_system_sgpr_workgroup_id_x 1
.end_amdhsa_kernel
.p2align 6
.amdhsa_kernel reduce_kernel
  .amdhsa_next_free_vgpr 64
  .amdhsa_next_free_sgpr 102
  .amdhsa_accum_offset 64
  .amdhsa_group_segment_fixed_size 0
  .amdhsa_kernarg_size 64
  .amdhsa_user_sgpr_count 2
  .amdhsa_user_sgpr_kernarg_segment_ptr 1
  .amdhsa_system_sgpr_workgroup_id_x 1
.end_amdhsa_kernel
```
